```python
import torch

def _softmax(x, axis=-1):
    return torch.softmax(x, dim=axis)
def _gelu(x):
    return torch.nn.functional.gelu(x, approximate="tanh")
def _silu(x):
    return torch.nn.functional.silu(x)
def _sigmoid(x):
    return torch.sigmoid(x)
def _layernorm(x, axis=-1, eps=1e-5):
    m = x.mean(dim=axis, keepdim=True)
    v = x.var(dim=axis, keepdim=True, unbiased=False)
    return (x - m) / torch.sqrt(v + eps)
def _scatter_add(tgt, idx, src, axis=0):
    return tgt.clone().index_add_(axis, idx, src)
def _segment_sum(src, seg, n):
    out = torch.zeros((n,) + src.shape[1:], dtype=src.dtype)
    return out.index_add_(0, seg, src)
def _pad(x, pw):
    flat = tuple(v for pair in reversed(pw) for v in pair)
    return torch.nn.functional.pad(x, flat)

kernel_name = 'recurrent_scan__mha_block__mixer_channel_mlp__prompt'

def setup_inputs():

    _w = (lambda a: (lambda t: t.to(torch.bfloat16) if t.is_floating_point() else t)(torch.as_tensor(a)))
    def _A_setup():
        B, S, D, H = 1, 2048, 1024, 32
        return {
            "x": _w((lambda *s: torch.randn(*s, dtype=torch.bfloat16) * 0.05)(B, S, D)),
            "wqkv": _w((lambda *s: torch.randn(*s, dtype=torch.bfloat16) * 0.05)(D, 3 * D)),
            "wo": _w((lambda *s: torch.randn(*s, dtype=torch.bfloat16) * 0.05)(D, D)),
        }
    _A_in = _A_setup()

    def _B_setup():
        B, S, D, F = 1, 2048, 1024, 3584
        return {
            "x": _w((lambda *s: torch.randn(*s, dtype=torch.bfloat16) * 0.05)(B, S, D)),
            "w1": _w((lambda *s: torch.randn(*s, dtype=torch.bfloat16) * 1.6)(D, F) * (D ** -0.5)),
            "b1": _w((lambda *s: torch.randn(*s, dtype=torch.bfloat16) * 0.8)(F)),
            "w2": _w((lambda *s: torch.randn(*s, dtype=torch.bfloat16) * 0.05)(F, D) * (F ** -0.5)),
            "b2": _w((lambda *s: torch.randn(*s, dtype=torch.bfloat16) * 0.05)(D)),
        }
    _B_in = _B_setup()

    return {
        "A_x": _A_in["x"],
        "A_wqkv": _A_in["wqkv"],
        "A_wo": _A_in["wo"],
        "B_x": _B_in["x"],
        "B_w1": _B_in["w1"],
        "B_b1": _B_in["b1"],
        "B_w2": _B_in["w2"],
        "B_b2": _B_in["b2"],
    }

def reference(A_x, A_wqkv, A_wo, B_x, B_w1, B_b1, B_w2, B_b2):
    def _A_ref(x, wqkv, wo):
        B, S, D = x.shape
        H = 32
        Dh = D // H
        qkv = (lambda x, *d: x.permute(*d))((x @ wqkv).reshape(B, S, 3, H, Dh), 2, 0, 3, 1, 4)
        q, k, v = qkv[0], qkv[1], qkv[2]
        scores = torch.einsum("bhqd,bhkd->bhqk", q, k) * (Dh ** -0.5)
        p = _softmax(scores, axis=-1)
        o = torch.einsum("bhqk,bhkd->bhqd", p, v)
        return (lambda x, *d: x.permute(*d))(o, 0, 2, 1, 3).reshape(B, S, D) @ wo

    def _B_ref(x, w1, b1, w2, b2):
        y = _layernorm(x, axis=-1)
        h = _gelu(torch.einsum("bsd,df->bsf", y, w1) + b1)
        return torch.einsum("bsf,fd->bsd", h, w2) + b2

    x = A_x
    xn = _layernorm(x, axis=-1)
    s = _A_ref(xn, A_wqkv, A_wo)
    g = _silu(_B_ref(xn, B_w1, B_b1, B_w2, B_b2))
    return x + s * g
```

```asm
; @launch kernel=mega_kernel grid=(256,1,1) block=(256,1,1) lds=163840
.amdgcn_target "amdgcn-amd-amdhsa--gfx950"
.text
.globl mega_kernel
.p2align 8
.type mega_kernel,@function
mega_kernel:
    s_cmp_ge_u32 s2, 256
    s_cbranch_scc1 L_mega_end
    s_load_dwordx2 s[4:5], s[0:1], 80
    s_load_dwordx2 s[6:7], s[0:1], 32
    s_load_dwordx2 s[36:37], s[0:1], 8
    s_load_dwordx2 s[38:39], s[0:1], 40
    s_load_dwordx2 s[54:55], s[0:1], 48
    s_load_dwordx2 s[66:67], s[0:1], 16
    s_load_dwordx2 s[68:69], s[0:1], 0
    s_load_dwordx2 s[92:93], s[0:1], 64
    s_load_dwordx2 s[100:101], s[0:1], 56
    s_load_dwordx2 s[80:81], s[0:1], 72
    v_lshrrev_b32 v1, 6, v0
    v_and_b32 v0, 63, v0
    v_readfirstlane_b32 s3, v1
    s_and_b32 s34, s2, 7
    s_lshr_b32 s35, s2, 3
    s_and_b32 s24, s34, 1
    s_lshl_b32 s24, s24, 2
    s_and_b32 s42, s35, 3
    s_add_u32 s24, s24, s42
    s_lshr_b32 s25, s34, 1
    s_lshl_b32 s25, s25, 3
    s_lshr_b32 s42, s35, 2
    s_add_u32 s25, s25, s42
    s_waitcnt lgkmcnt(0)
    s_mov_b32 s8, s4
    s_mov_b32 s9, s5
    s_mov_b32 s10, 54525952
    s_mov_b32 s11, 0x00020000
    s_mov_b32 s84, s68
    s_mov_b32 s85, s69
    s_mov_b32 s86, 4194304
    s_mov_b32 s87, 0x00020000
    s_mov_b32 s76, s80
    s_mov_b32 s77, s81
    s_mov_b32 s78, 256
    s_mov_b32 s79, 0x00020000
    s_cmp_lg_u32 s3, 3
    s_cbranch_scc1 L_st_c
    s_getpc_b64 s[34:35]
L_st_pc:
    s_bfe_u32 s42, s2, 0x50003
    s_lshl_b32 s42, s42, 11
    v_and_b32 v12, 15, v0
    v_lshlrev_b32 v12, 7, v12
    v_add_u32 v12, s42, v12
    v_min_u32 v12, L_mega_end-L_st_pc, v12
    global_load_dword v254, v12, s[34:35]
L_st_c:
    s_cmp_ge_u32 s3, 2
    s_cbranch_scc1 L_st_a
    v_lshrrev_b32 v48, 4, v0
    v_and_b32 v49, 15, v0
    s_lshl_b32 s34, s3, 2
    v_add_u32 v50, s34, v48
    v_lshlrev_b32 v51, 11, v50
    v_lshl_add_u32 v51, v49, 4, v51
    s_lshl_b32 s34, s2, 14
    buffer_load_dwordx4 v[16:19], v51, s[84:87], s34 offen offset:0
    buffer_load_dwordx4 v[20:23], v51, s[84:87], s34 offen offset:256
    buffer_load_dwordx4 v[24:27], v51, s[84:87], s34 offen offset:512
    buffer_load_dwordx4 v[28:31], v51, s[84:87], s34 offen offset:768
    buffer_load_dwordx4 v[32:35], v51, s[84:87], s34 offen offset:1024
    buffer_load_dwordx4 v[36:39], v51, s[84:87], s34 offen offset:1280
    buffer_load_dwordx4 v[40:43], v51, s[84:87], s34 offen offset:1536
    buffer_load_dwordx4 v[44:47], v51, s[84:87], s34 offen offset:1792
    s_branch L_st_a2
L_st_a:
    s_lshl_b32 s34, s2, 14
    v_lshlrev_b32 v14, 2, v0
    buffer_load_dword v254, v14, s[84:87], s34 offen
L_st_a2:
    s_lshl_b32 s34, s2, 2
    s_add_u32 s34, s34, s3
    s_cmp_lt_u32 s34, 448
    s_cselect_b32 s72, s6, s36
    s_cselect_b32 s73, s7, s37
    s_mov_b32 s35, 6291456
    s_cselect_b32 s74, 7340032, s35
    s_mov_b32 s35, 393216
    s_cselect_b32 s90, 458752, s35
    s_cselect_b32 s35, 0, 448
    s_sub_u32 s35, s34, s35
    s_lshl_b32 s80, s35, 10
    s_cmp_lt_u32 s34, 832
    s_cselect_b32 s74, s74, 0
    s_mov_b32 s75, 0x00020000
    v_lshlrev_b32 v1, 4, v0
    s_or_b32 s34, s2, s3
    s_cmp_lg_u32 s34, 0
    s_cbranch_scc1 L_st_b
    s_memrealtime s[34:35]
    s_waitcnt lgkmcnt(0)
    s_or_b32 s34, s34, 1
    v_mov_b32 v14, s34
    v_mov_b32 v15, 0
    s_mov_b64 exec, 1
    buffer_store_dword v14, v15, s[76:79], 0 offen sc1
    s_mov_b64 exec, -1
L_st_b:
    s_lshl_b32 s57, s25, 3
    s_add_u32 s57, s57, s24
    s_lshl_b32 s57, s57, 2
    s_add_u32 s57, s57, 53477376
    s_lshl_b32 s58, s24, 5
    s_add_u32 s58, s58, s25
    s_lshl_b32 s58, s58, 2
    s_add_u32 s58, s58, 53478400
    s_mov_b32 s12, s6
    s_mov_b32 s13, s7
    s_mov_b32 s14, 7340032
    s_mov_b32 s15, 0x00020000
    s_mov_b32 s16, s36
    s_mov_b32 s17, s37
    s_mov_b32 s18, 6291456
    s_mov_b32 s19, 0x00020000
    s_mov_b32 s20, s38
    s_mov_b32 s21, s39
    s_mov_b32 s22, 7168
    s_mov_b32 s23, 0x00020000
    v_lshlrev_b32 v1, 4, v0
    v_add_u32 v2, 0, v1
    v_add_u32 v3, 32768, v1
    v_add_u32 v4, 65536, v1
    v_add_u32 v5, 98304, v1
    s_lshl_b32 s42, s24, 4
    s_lshl_b32 s43, s3, 2
    s_add_u32 s42, s42, s43
    s_lshl_b32 s26, s42, 15
    v_lshrrev_b32 v14, 2, v0
    s_lshl_b32 s43, s3, 4
    v_add_u32 v14, s43, v14
    v_bfe_u32 v15, v0, 4, 1
    v_lshlrev_b32 v15, 1, v15
    v_and_b32 v224, 3, v0
    v_xor_b32 v15, v15, v224
    v_lshlrev_b32 v15, 4, v15
    v_mul_u32_u24 v6, 7168, v14
    v_add_u32 v6, v6, v15
    v_mul_u32_u24 v7, 6144, v14
    v_add_u32 v7, v7, v15
    s_mul_i32 s27, s25, 224
    s_lshl_b32 s28, s25, 6
    s_add_u32 s29, s28, 2048
    s_add_u32 s30, s28, 4096
    s_lshl_b32 s31, s3, 10
    s_mov_b32 s32, 0
    v_lshrrev_b32 v14, 2, v0
    v_lshlrev_b32 v14, 6, v14
    v_and_b32 v15, 3, v0
    v_lshl_add_u32 v14, v15, 3, v14
    v_bfe_u32 v15, v0, 4, 1
    v_lshl_add_u32 v10, v15, 5, v14
    v_xor_b32 v15, 1, v15
    v_lshl_add_u32 v11, v15, 5, v14
    v_add_u32 v8, s32, v10
    v_add_u32 v9, s32, v11
    v_lshrrev_b32 v14, 4, v0
    v_lshlrev_b32 v14, 3, v14
    s_mul_i32 s42, s25, 224
    buffer_load_dwordx2 v[224:225], v14, s[20:23], s42 offen offset:0
    buffer_load_dwordx2 v[226:227], v14, s[20:23], s42 offen offset:32
    buffer_load_dwordx2 v[228:229], v14, s[20:23], s42 offen offset:64
    buffer_load_dwordx2 v[230:231], v14, s[20:23], s42 offen offset:96
    buffer_load_dwordx2 v[232:233], v14, s[20:23], s42 offen offset:128
    buffer_load_dwordx2 v[234:235], v14, s[20:23], s42 offen offset:160
    buffer_load_dwordx2 v[236:237], v14, s[20:23], s42 offen offset:192
    s_mov_b32 s20, s54
    s_mov_b32 s21, s55
    s_mov_b32 s22, 7340032
    s_mov_b32 s23, 0x00020000
    s_mov_b32 s36, s66
    s_mov_b32 s37, s67
    s_mov_b32 s52, s36
    s_mov_b32 s53, s37
    s_mov_b32 s54, 2097152
    s_mov_b32 s55, 0x00020000
    s_and_b32 s35, s2, 7
    s_lshr_b32 s34, s2, 3
    s_and_b32 s6, s35, 3
    s_lshr_b32 s35, s35, 2
    s_lshl_b32 s35, s35, 2
    s_and_b32 s36, s34, 3
    s_add_u32 s7, s35, s36
    s_lshr_b32 s56, s34, 2
    s_lshl_b32 s34, s7, 4
    s_lshl_b32 s35, s3, 2
    s_add_u32 s34, s34, s35
    s_mul_i32 s34, s34, 112
    s_mul_i32 s35, s6, 28
    s_add_u32 s34, s34, s35
    s_lshl_b32 s34, s34, 10
    s_add_u32 s70, s34, 17825792
    s_mul_i32 s71, s6, 1835008
    s_lshl_b32 s34, s3, 15
    s_add_u32 s71, s71, s34
    s_lshl_b32 s89, s3, 10
    s_add_u32 s89, s89, 65536
    s_mov_b32 s67, 65536
    s_lshr_b32 s34, s6, 1
    s_lshl_b32 s81, s7, 1
    s_add_u32 s81, s81, s34
    s_mov_b32 s82, s56
    s_and_b32 s83, s6, 1
    s_lshl_b32 s88, s81, 2
    s_add_u32 s88, s88, s3
    s_lshl_b32 s84, s88, 16
    s_add_u32 s84, s84, 49283072
    s_lshl_b32 s34, s82, 1
    s_add_u32 s34, s34, s83
    s_lshl_b32 s34, s34, 7
    s_lshl_b32 s85, s3, 15
    s_add_u32 s85, s85, s34
    s_lshl_b32 s86, s3, 10
    s_lshl_b32 s87, s88, 16
    s_add_u32 s87, s87, s34
    s_lshl_b32 s34, s7, 3
    s_add_u32 s34, s34, s56
    s_lshl_b32 s34, s34, 2
    s_add_u32 s34, s34, s6
    s_lshl_b32 s34, s34, 2
    s_add_u32 s60, s34, 53480448
    s_lshr_b32 s34, s81, 1
    s_lshl_b32 s35, s34, 3
    s_add_u32 s35, s35, s82
    s_lshl_b32 s35, s35, 4
    s_add_u32 s64, s35, 53480448
    s_lshl_b32 s35, s34, 7
    s_add_u32 s63, s35, 53479424
    s_lshl_b32 s35, s7, 7
    s_lshl_b32 s34, s6, 5
    s_add_u32 s35, s35, s34
    s_add_u32 s62, s35, 53478400
    s_mul_i32 s65, s2, 28672
    s_mul_i32 s34, s3, 7168
    s_add_u32 s65, s65, s34
    s_lshl_b32 s66, s2, 13
    s_lshl_b32 s34, s3, 11
    s_add_u32 s66, s66, s34
    v_lshrrev_b32 v200, 2, v0
    v_lshlrev_b32 v200, 11, v200
    v_and_b32 v201, 3, v0
    v_lshl_add_u32 v200, v201, 4, v200
    v_mov_b32 v251, v200
    s_lshl_b32 s34, s82, 8
    s_lshl_b32 s35, s83, 7
    s_add_u32 s35, s35, s34
    v_add_u32 v247, s35, v200
    s_xor_b32 s35, s35, 128
    v_add_u32 v248, s35, v200
    v_bfe_u32 v200, v0, 2, 2
    v_lshlrev_b32 v200, 6, v200
    v_and_b32 v201, 3, v0
    v_lshl_add_u32 v200, v201, 3, v200
    v_bfe_u32 v201, v0, 4, 1
    v_lshl_add_u32 v200, v201, 5, v200
    v_lshrrev_b32 v201, 5, v0
    v_lshl_add_u32 v253, v201, 8, v200
    v_lshl_add_u32 v200, v201, 9, v200
    v_add_u32 v249, 49152, v200
    v_add_u32 v250, 114688, v200
    v_lshrrev_b32 v200, 3, v0
    v_lshlrev_b32 v200, 11, v200
    v_and_b32 v201, 7, v0
    v_lshl_add_u32 v252, v201, 4, v200
    v_bfe_u32 v200, v0, 4, 1
    v_lshlrev_b32 v200, 3, v200
    v_lshrrev_b32 v201, 5, v0
    v_lshl_add_u32 v200, v201, 2, v200
    v_bfe_u32 v201, v0, 2, 2
    v_add_u32 v200, v200, v201
    v_lshlrev_b32 v200, 11, v200
    v_bfe_u32 v201, v0, 4, 1
    v_lshlrev_b32 v201, 1, v201
    v_and_b32 v202, 3, v0
    v_xor_b32 v201, v201, v202
    v_lshlrev_b32 v201, 4, v201
    v_add_u32 v200, v200, v201
    s_lshl_b32 s35, s56, 8
    s_and_b32 s34, s6, 1
    s_lshl_b32 s34, s34, 7
    s_add_u32 s35, s35, s34
    v_add_u32 v247, s35, v200
    s_xor_b32 s35, s35, 128
    v_add_u32 v248, s35, v200
    v_lshrrev_b32 v200, 5, v0
    v_lshlrev_b32 v200, 10, v200
    v_bfe_u32 v201, v0, 2, 3
    v_lshl_add_u32 v200, v201, 6, v200
    v_and_b32 v201, 3, v0
    v_lshl_add_u32 v200, v201, 3, v200
    v_bfe_u32 v201, v0, 4, 1
    v_lshl_add_u32 v249, v201, 5, v200
    v_xor_b32 v201, 1, v201
    v_lshl_add_u32 v250, v201, 5, v200
    v_mov_b32 v13, 0
    v_mov_b32 v12, 0
    s_cmp_ge_u32 s3, 2
    s_cbranch_scc1 L_st_pf
    s_mul_i32 s34, s90, 5
    s_add_u32 s80, s80, s34
    buffer_load_dword v12, v13, s[76:79], 0 offen sc1
    v_lshrrev_b32 v52, 2, v49
    v_mul_u32_u24 v52, 528, v52
    v_and_b32 v53, 1, v49
    v_lshl_add_u32 v52, v53, 8, v52
    v_lshl_add_u32 v52, v50, 4, v52
    v_bfe_u32 v53, v49, 1, 1
    v_lshl_add_u32 v52, v53, 3, v52
    v_add_u32 v52, 143360, v52
    s_waitcnt vmcnt(15)
    v_lshlrev_b32 v64, 16, v16
    v_and_b32 v65, 0xffff0000, v16
    v_lshlrev_b32 v66, 16, v17
    v_and_b32 v67, 0xffff0000, v17
    v_lshlrev_b32 v68, 16, v18
    v_and_b32 v69, 0xffff0000, v18
    v_lshlrev_b32 v70, 16, v19
    v_and_b32 v71, 0xffff0000, v19
    s_waitcnt vmcnt(14)
    v_lshlrev_b32 v72, 16, v20
    v_and_b32 v73, 0xffff0000, v20
    v_lshlrev_b32 v74, 16, v21
    v_and_b32 v75, 0xffff0000, v21
    v_lshlrev_b32 v76, 16, v22
    v_and_b32 v77, 0xffff0000, v22
    v_lshlrev_b32 v78, 16, v23
    v_and_b32 v79, 0xffff0000, v23
    s_waitcnt vmcnt(13)
    v_lshlrev_b32 v80, 16, v24
    v_and_b32 v81, 0xffff0000, v24
    v_lshlrev_b32 v82, 16, v25
    v_and_b32 v83, 0xffff0000, v25
    v_lshlrev_b32 v84, 16, v26
    v_and_b32 v85, 0xffff0000, v26
    v_lshlrev_b32 v86, 16, v27
    v_and_b32 v87, 0xffff0000, v27
    s_waitcnt vmcnt(12)
    v_lshlrev_b32 v88, 16, v28
    v_and_b32 v89, 0xffff0000, v28
    v_lshlrev_b32 v90, 16, v29
    v_and_b32 v91, 0xffff0000, v29
    v_lshlrev_b32 v92, 16, v30
    v_and_b32 v93, 0xffff0000, v30
    v_lshlrev_b32 v94, 16, v31
    v_and_b32 v95, 0xffff0000, v31
    s_waitcnt vmcnt(11)
    v_lshlrev_b32 v96, 16, v32
    v_and_b32 v97, 0xffff0000, v32
    v_lshlrev_b32 v98, 16, v33
    v_and_b32 v99, 0xffff0000, v33
    v_lshlrev_b32 v100, 16, v34
    v_and_b32 v101, 0xffff0000, v34
    v_lshlrev_b32 v102, 16, v35
    v_and_b32 v103, 0xffff0000, v35
    s_waitcnt vmcnt(10)
    v_lshlrev_b32 v104, 16, v36
    v_and_b32 v105, 0xffff0000, v36
    v_lshlrev_b32 v106, 16, v37
    v_and_b32 v107, 0xffff0000, v37
    v_lshlrev_b32 v108, 16, v38
    v_and_b32 v109, 0xffff0000, v38
    v_lshlrev_b32 v110, 16, v39
    v_and_b32 v111, 0xffff0000, v39
    s_waitcnt vmcnt(9)
    v_lshlrev_b32 v112, 16, v40
    v_and_b32 v113, 0xffff0000, v40
    v_lshlrev_b32 v114, 16, v41
    v_and_b32 v115, 0xffff0000, v41
    v_lshlrev_b32 v116, 16, v42
    v_and_b32 v117, 0xffff0000, v42
    v_lshlrev_b32 v118, 16, v43
    v_and_b32 v119, 0xffff0000, v43
    s_waitcnt vmcnt(8)
    v_lshlrev_b32 v120, 16, v44
    v_and_b32 v121, 0xffff0000, v44
    v_lshlrev_b32 v122, 16, v45
    v_and_b32 v123, 0xffff0000, v45
    v_lshlrev_b32 v124, 16, v46
    v_and_b32 v125, 0xffff0000, v46
    v_lshlrev_b32 v126, 16, v47
    v_and_b32 v127, 0xffff0000, v47
    v_pk_add_f32 v[54:55], v[64:65], v[66:67]
    v_pk_add_f32 v[54:55], v[54:55], v[68:69]
    v_pk_add_f32 v[54:55], v[54:55], v[70:71]
    v_pk_add_f32 v[54:55], v[54:55], v[72:73]
    v_pk_add_f32 v[54:55], v[54:55], v[74:75]
    v_pk_add_f32 v[54:55], v[54:55], v[76:77]
    v_pk_add_f32 v[54:55], v[54:55], v[78:79]
    v_pk_add_f32 v[54:55], v[54:55], v[80:81]
    v_pk_add_f32 v[54:55], v[54:55], v[82:83]
    v_pk_add_f32 v[54:55], v[54:55], v[84:85]
    v_pk_add_f32 v[54:55], v[54:55], v[86:87]
    v_pk_add_f32 v[54:55], v[54:55], v[88:89]
    v_pk_add_f32 v[54:55], v[54:55], v[90:91]
    v_pk_add_f32 v[54:55], v[54:55], v[92:93]
    v_pk_add_f32 v[54:55], v[54:55], v[94:95]
    v_pk_add_f32 v[54:55], v[54:55], v[96:97]
    v_pk_add_f32 v[54:55], v[54:55], v[98:99]
    v_pk_add_f32 v[54:55], v[54:55], v[100:101]
    v_pk_add_f32 v[54:55], v[54:55], v[102:103]
    v_pk_add_f32 v[54:55], v[54:55], v[104:105]
    v_pk_add_f32 v[54:55], v[54:55], v[106:107]
    v_pk_add_f32 v[54:55], v[54:55], v[108:109]
    v_pk_add_f32 v[54:55], v[54:55], v[110:111]
    v_pk_add_f32 v[54:55], v[54:55], v[112:113]
    v_pk_add_f32 v[54:55], v[54:55], v[114:115]
    v_pk_add_f32 v[54:55], v[54:55], v[116:117]
    v_pk_add_f32 v[54:55], v[54:55], v[118:119]
    v_pk_add_f32 v[54:55], v[54:55], v[120:121]
    v_pk_add_f32 v[54:55], v[54:55], v[122:123]
    v_pk_add_f32 v[54:55], v[54:55], v[124:125]
    v_pk_add_f32 v[54:55], v[54:55], v[126:127]
    v_add_f32 v54, v54, v55
    s_nop 1
    v_add_f32_dpp v54, v54, v54 row_ror:8 row_mask:0xf bank_mask:0xf
    s_nop 1
    v_add_f32_dpp v54, v54, v54 row_ror:4 row_mask:0xf bank_mask:0xf
    s_nop 1
    v_add_f32_dpp v54, v54, v54 row_ror:2 row_mask:0xf bank_mask:0xf
    s_nop 1
    v_add_f32_dpp v54, v54, v54 row_ror:1 row_mask:0xf bank_mask:0xf
    v_mul_f32 v54, 0xba800000, v54
    v_pk_add_f32 v[64:65], v[64:65], v[54:55] op_sel_hi:[1,0]
    v_pk_add_f32 v[66:67], v[66:67], v[54:55] op_sel_hi:[1,0]
    v_pk_add_f32 v[68:69], v[68:69], v[54:55] op_sel_hi:[1,0]
    v_pk_add_f32 v[70:71], v[70:71], v[54:55] op_sel_hi:[1,0]
    v_pk_add_f32 v[72:73], v[72:73], v[54:55] op_sel_hi:[1,0]
    v_pk_add_f32 v[74:75], v[74:75], v[54:55] op_sel_hi:[1,0]
    v_pk_add_f32 v[76:77], v[76:77], v[54:55] op_sel_hi:[1,0]
    v_pk_add_f32 v[78:79], v[78:79], v[54:55] op_sel_hi:[1,0]
    v_pk_add_f32 v[80:81], v[80:81], v[54:55] op_sel_hi:[1,0]
    v_pk_add_f32 v[82:83], v[82:83], v[54:55] op_sel_hi:[1,0]
    v_pk_add_f32 v[84:85], v[84:85], v[54:55] op_sel_hi:[1,0]
    v_pk_add_f32 v[86:87], v[86:87], v[54:55] op_sel_hi:[1,0]
    v_pk_add_f32 v[88:89], v[88:89], v[54:55] op_sel_hi:[1,0]
    v_pk_add_f32 v[90:91], v[90:91], v[54:55] op_sel_hi:[1,0]
    v_pk_add_f32 v[92:93], v[92:93], v[54:55] op_sel_hi:[1,0]
    v_pk_add_f32 v[94:95], v[94:95], v[54:55] op_sel_hi:[1,0]
    v_pk_add_f32 v[96:97], v[96:97], v[54:55] op_sel_hi:[1,0]
    v_pk_add_f32 v[98:99], v[98:99], v[54:55] op_sel_hi:[1,0]
    v_pk_add_f32 v[100:101], v[100:101], v[54:55] op_sel_hi:[1,0]
    v_pk_add_f32 v[102:103], v[102:103], v[54:55] op_sel_hi:[1,0]
    v_pk_add_f32 v[104:105], v[104:105], v[54:55] op_sel_hi:[1,0]
    v_pk_add_f32 v[106:107], v[106:107], v[54:55] op_sel_hi:[1,0]
    v_pk_add_f32 v[108:109], v[108:109], v[54:55] op_sel_hi:[1,0]
    v_pk_add_f32 v[110:111], v[110:111], v[54:55] op_sel_hi:[1,0]
    v_pk_add_f32 v[112:113], v[112:113], v[54:55] op_sel_hi:[1,0]
    v_pk_add_f32 v[114:115], v[114:115], v[54:55] op_sel_hi:[1,0]
    v_pk_add_f32 v[116:117], v[116:117], v[54:55] op_sel_hi:[1,0]
    v_pk_add_f32 v[118:119], v[118:119], v[54:55] op_sel_hi:[1,0]
    v_pk_add_f32 v[120:121], v[120:121], v[54:55] op_sel_hi:[1,0]
    v_pk_add_f32 v[122:123], v[122:123], v[54:55] op_sel_hi:[1,0]
    v_pk_add_f32 v[124:125], v[124:125], v[54:55] op_sel_hi:[1,0]
    v_pk_add_f32 v[126:127], v[126:127], v[54:55] op_sel_hi:[1,0]
    v_pk_mul_f32 v[56:57], v[64:65], v[64:65]
    v_pk_fma_f32 v[56:57], v[66:67], v[66:67], v[56:57]
    v_pk_fma_f32 v[56:57], v[68:69], v[68:69], v[56:57]
    v_pk_fma_f32 v[56:57], v[70:71], v[70:71], v[56:57]
    v_pk_fma_f32 v[56:57], v[72:73], v[72:73], v[56:57]
    v_pk_fma_f32 v[56:57], v[74:75], v[74:75], v[56:57]
    v_pk_fma_f32 v[56:57], v[76:77], v[76:77], v[56:57]
    v_pk_fma_f32 v[56:57], v[78:79], v[78:79], v[56:57]
    v_pk_fma_f32 v[56:57], v[80:81], v[80:81], v[56:57]
    v_pk_fma_f32 v[56:57], v[82:83], v[82:83], v[56:57]
    v_pk_fma_f32 v[56:57], v[84:85], v[84:85], v[56:57]
    v_pk_fma_f32 v[56:57], v[86:87], v[86:87], v[56:57]
    v_pk_fma_f32 v[56:57], v[88:89], v[88:89], v[56:57]
    v_pk_fma_f32 v[56:57], v[90:91], v[90:91], v[56:57]
    v_pk_fma_f32 v[56:57], v[92:93], v[92:93], v[56:57]
    v_pk_fma_f32 v[56:57], v[94:95], v[94:95], v[56:57]
    v_pk_fma_f32 v[56:57], v[96:97], v[96:97], v[56:57]
    v_pk_fma_f32 v[56:57], v[98:99], v[98:99], v[56:57]
    v_pk_fma_f32 v[56:57], v[100:101], v[100:101], v[56:57]
    v_pk_fma_f32 v[56:57], v[102:103], v[102:103], v[56:57]
    v_pk_fma_f32 v[56:57], v[104:105], v[104:105], v[56:57]
    v_pk_fma_f32 v[56:57], v[106:107], v[106:107], v[56:57]
    v_pk_fma_f32 v[56:57], v[108:109], v[108:109], v[56:57]
    v_pk_fma_f32 v[56:57], v[110:111], v[110:111], v[56:57]
    v_pk_fma_f32 v[56:57], v[112:113], v[112:113], v[56:57]
    v_pk_fma_f32 v[56:57], v[114:115], v[114:115], v[56:57]
    v_pk_fma_f32 v[56:57], v[116:117], v[116:117], v[56:57]
    v_pk_fma_f32 v[56:57], v[118:119], v[118:119], v[56:57]
    v_pk_fma_f32 v[56:57], v[120:121], v[120:121], v[56:57]
    v_pk_fma_f32 v[56:57], v[122:123], v[122:123], v[56:57]
    v_pk_fma_f32 v[56:57], v[124:125], v[124:125], v[56:57]
    v_pk_fma_f32 v[56:57], v[126:127], v[126:127], v[56:57]
    v_add_f32 v56, v56, v57
    s_nop 1
    v_add_f32_dpp v56, v56, v56 row_ror:8 row_mask:0xf bank_mask:0xf
    s_nop 1
    v_add_f32_dpp v56, v56, v56 row_ror:4 row_mask:0xf bank_mask:0xf
    s_nop 1
    v_add_f32_dpp v56, v56, v56 row_ror:2 row_mask:0xf bank_mask:0xf
    s_nop 1
    v_add_f32_dpp v56, v56, v56 row_ror:1 row_mask:0xf bank_mask:0xf
    v_mul_f32 v56, 0x3a800000, v56
    s_mov_b32 s35, 0x3727c5ac
    v_add_f32 v58, s35, v56
    v_rsq_f32 v58, v58
    s_nop 0
    v_mul_f32 v59, v58, v58
    v_mul_f32 v59, v56, v59
    v_add_f32 v59, s35, v59
    v_rsq_f32 v59, v59
    s_nop 0
    v_pk_mul_f32 v[64:65], v[64:65], v[58:59] op_sel_hi:[1,0]
    v_cvt_pk_bf16_f32 v16, v64, v65
    v_pk_mul_f32 v[66:67], v[66:67], v[58:59] op_sel_hi:[1,0]
    v_cvt_pk_bf16_f32 v17, v66, v67
    v_pk_mul_f32 v[68:69], v[68:69], v[58:59] op_sel_hi:[1,0]
    v_cvt_pk_bf16_f32 v18, v68, v69
    v_pk_mul_f32 v[70:71], v[70:71], v[58:59] op_sel_hi:[1,0]
    v_cvt_pk_bf16_f32 v19, v70, v71
    v_pk_mul_f32 v[72:73], v[72:73], v[58:59] op_sel_hi:[1,0]
    v_cvt_pk_bf16_f32 v20, v72, v73
    v_pk_mul_f32 v[74:75], v[74:75], v[58:59] op_sel_hi:[1,0]
    v_cvt_pk_bf16_f32 v21, v74, v75
    v_pk_mul_f32 v[76:77], v[76:77], v[58:59] op_sel_hi:[1,0]
    v_cvt_pk_bf16_f32 v22, v76, v77
    v_pk_mul_f32 v[78:79], v[78:79], v[58:59] op_sel_hi:[1,0]
    v_cvt_pk_bf16_f32 v23, v78, v79
    v_pk_mul_f32 v[80:81], v[80:81], v[58:59] op_sel_hi:[1,0]
    v_cvt_pk_bf16_f32 v24, v80, v81
    v_pk_mul_f32 v[82:83], v[82:83], v[58:59] op_sel_hi:[1,0]
    v_cvt_pk_bf16_f32 v25, v82, v83
    v_pk_mul_f32 v[84:85], v[84:85], v[58:59] op_sel_hi:[1,0]
    v_cvt_pk_bf16_f32 v26, v84, v85
    v_pk_mul_f32 v[86:87], v[86:87], v[58:59] op_sel_hi:[1,0]
    v_cvt_pk_bf16_f32 v27, v86, v87
    v_pk_mul_f32 v[88:89], v[88:89], v[58:59] op_sel_hi:[1,0]
    v_cvt_pk_bf16_f32 v28, v88, v89
    v_pk_mul_f32 v[90:91], v[90:91], v[58:59] op_sel_hi:[1,0]
    v_cvt_pk_bf16_f32 v29, v90, v91
    v_pk_mul_f32 v[92:93], v[92:93], v[58:59] op_sel_hi:[1,0]
    v_cvt_pk_bf16_f32 v30, v92, v93
    v_pk_mul_f32 v[94:95], v[94:95], v[58:59] op_sel_hi:[1,0]
    v_cvt_pk_bf16_f32 v31, v94, v95
    v_pk_mul_f32 v[96:97], v[96:97], v[58:59] op_sel_hi:[1,0]
    v_cvt_pk_bf16_f32 v32, v96, v97
    v_pk_mul_f32 v[98:99], v[98:99], v[58:59] op_sel_hi:[1,0]
    v_cvt_pk_bf16_f32 v33, v98, v99
    v_pk_mul_f32 v[100:101], v[100:101], v[58:59] op_sel_hi:[1,0]
    v_cvt_pk_bf16_f32 v34, v100, v101
    v_pk_mul_f32 v[102:103], v[102:103], v[58:59] op_sel_hi:[1,0]
    v_cvt_pk_bf16_f32 v35, v102, v103
    v_pk_mul_f32 v[104:105], v[104:105], v[58:59] op_sel_hi:[1,0]
    v_cvt_pk_bf16_f32 v36, v104, v105
    v_pk_mul_f32 v[106:107], v[106:107], v[58:59] op_sel_hi:[1,0]
    v_cvt_pk_bf16_f32 v37, v106, v107
    v_pk_mul_f32 v[108:109], v[108:109], v[58:59] op_sel_hi:[1,0]
    v_cvt_pk_bf16_f32 v38, v108, v109
    v_pk_mul_f32 v[110:111], v[110:111], v[58:59] op_sel_hi:[1,0]
    v_cvt_pk_bf16_f32 v39, v110, v111
    v_pk_mul_f32 v[112:113], v[112:113], v[58:59] op_sel_hi:[1,0]
    v_cvt_pk_bf16_f32 v40, v112, v113
    v_pk_mul_f32 v[114:115], v[114:115], v[58:59] op_sel_hi:[1,0]
    v_cvt_pk_bf16_f32 v41, v114, v115
    v_pk_mul_f32 v[116:117], v[116:117], v[58:59] op_sel_hi:[1,0]
    v_cvt_pk_bf16_f32 v42, v116, v117
    v_pk_mul_f32 v[118:119], v[118:119], v[58:59] op_sel_hi:[1,0]
    v_cvt_pk_bf16_f32 v43, v118, v119
    v_pk_mul_f32 v[120:121], v[120:121], v[58:59] op_sel_hi:[1,0]
    v_cvt_pk_bf16_f32 v44, v120, v121
    v_pk_mul_f32 v[122:123], v[122:123], v[58:59] op_sel_hi:[1,0]
    v_cvt_pk_bf16_f32 v45, v122, v123
    v_pk_mul_f32 v[124:125], v[124:125], v[58:59] op_sel_hi:[1,0]
    v_cvt_pk_bf16_f32 v46, v124, v125
    v_pk_mul_f32 v[126:127], v[126:127], v[58:59] op_sel_hi:[1,0]
    v_cvt_pk_bf16_f32 v47, v126, v127
    ds_write_b64 v52, v[16:17] offset:0
    ds_write_b64 v52, v[18:19] offset:128
    ds_write_b64 v52, v[20:21] offset:2112
    ds_write_b64 v52, v[22:23] offset:2240
    ds_write_b64 v52, v[24:25] offset:4224
    ds_write_b64 v52, v[26:27] offset:4352
    ds_write_b64 v52, v[28:29] offset:6336
    ds_write_b64 v52, v[30:31] offset:6464
    ds_write_b64 v52, v[32:33] offset:8448
    ds_write_b64 v52, v[34:35] offset:8576
    ds_write_b64 v52, v[36:37] offset:10560
    ds_write_b64 v52, v[38:39] offset:10688
    ds_write_b64 v52, v[40:41] offset:12672
    ds_write_b64 v52, v[42:43] offset:12800
    ds_write_b64 v52, v[44:45] offset:14784
    ds_write_b64 v52, v[46:47] offset:14912
    s_waitcnt lgkmcnt(0)
    s_barrier
    v_lshrrev_b32 v64, 5, v0
    v_bfe_u32 v65, v0, 3, 2
    v_and_b32 v66, 7, v0
    v_mul_u32_u24 v60, 528, v64
    v_lshl_add_u32 v60, v65, 7, v60
    v_lshl_add_u32 v60, v66, 4, v60
    s_mul_i32 s34, s3, 8448
    s_add_u32 s34, s34, 143360
    v_add_u32 v60, s34, v60
    v_lshlrev_b32 v61, 10, v64
    v_lshl_add_u32 v61, v65, 8, v61
    v_lshl_add_u32 v61, v66, 4, v61
    ds_read_b128 v[68:71], v60 offset:0
    ds_read_b128 v[72:75], v60 offset:1056
    ds_read_b128 v[76:79], v60 offset:2112
    ds_read_b128 v[80:83], v60 offset:3168
    ds_read_b128 v[84:87], v60 offset:4224
    ds_read_b128 v[88:91], v60 offset:5280
    ds_read_b128 v[92:95], v60 offset:6336
    ds_read_b128 v[96:99], v60 offset:7392
    s_lshr_b32 s34, s2, 1
    s_lshl_b32 s34, s34, 15
    s_and_b32 s35, s2, 1
    s_lshl_b32 s35, s35, 7
    s_add_u32 s34, s34, s35
    s_lshl_b32 s35, s3, 14
    s_add_u32 s34, s34, s35
    s_waitcnt lgkmcnt(7)
    buffer_store_dwordx4 v[68:71], v61, s[8:11], s34 offen offset:0 sc1
    s_waitcnt lgkmcnt(6)
    buffer_store_dwordx4 v[72:75], v61, s[8:11], s34 offen offset:2048 sc1
    s_add_u32 s34, s34, 4096
    s_waitcnt lgkmcnt(5)
    buffer_store_dwordx4 v[76:79], v61, s[8:11], s34 offen offset:0 sc1
    s_waitcnt lgkmcnt(4)
    buffer_store_dwordx4 v[80:83], v61, s[8:11], s34 offen offset:2048 sc1
    s_add_u32 s34, s34, 4096
    s_waitcnt lgkmcnt(3)
    buffer_store_dwordx4 v[84:87], v61, s[8:11], s34 offen offset:0 sc1
    s_waitcnt lgkmcnt(2)
    buffer_store_dwordx4 v[88:91], v61, s[8:11], s34 offen offset:2048 sc1
    s_add_u32 s34, s34, 4096
    s_waitcnt lgkmcnt(1)
    buffer_store_dwordx4 v[92:95], v61, s[8:11], s34 offen offset:0 sc1
    s_waitcnt lgkmcnt(0)
    buffer_store_dwordx4 v[96:99], v61, s[8:11], s34 offen offset:2048 sc1
    s_add_u32 s34, s34, 4096
    s_lshl_b32 s34, s2, 5
    s_add_u32 s34, s34, 4194304
    v_lshlrev_b32 v61, 2, v50
    v_cmp_eq_u32 vcc, 0, v49
    s_and_saveexec_b64 s[36:37], vcc
    buffer_store_dword v59, v61, s[8:11], s34 offen sc1
    s_mov_b64 exec, s[36:37]
    s_waitcnt vmcnt(0)
    s_branch L_st_j
L_st_pf:
    s_waitcnt vmcnt(0)
    buffer_load_dwordx4 a[240:243], v1, s[72:75], s80 offen
    s_sub_u32 s34, s80, 2048
    buffer_load_dwordx4 a[240:243], v1, s[72:75], s34 offen
    s_add_u32 s80, s80, s90
    buffer_load_dwordx4 a[240:243], v1, s[72:75], s80 offen
    s_sub_u32 s34, s80, 2048
    buffer_load_dwordx4 a[240:243], v1, s[72:75], s34 offen
    s_add_u32 s80, s80, s90
    buffer_load_dwordx4 a[240:243], v1, s[72:75], s80 offen
    s_sub_u32 s34, s80, 2048
    buffer_load_dwordx4 a[240:243], v1, s[72:75], s34 offen
    s_add_u32 s80, s80, s90
    buffer_load_dwordx4 a[240:243], v1, s[72:75], s80 offen
    s_sub_u32 s34, s80, 2048
    buffer_load_dwordx4 a[240:243], v1, s[72:75], s34 offen
    s_add_u32 s80, s80, s90
    buffer_load_dwordx4 a[240:243], v1, s[72:75], s80 offen
    s_sub_u32 s34, s80, 2048
    buffer_load_dwordx4 a[240:243], v1, s[72:75], s34 offen
    s_add_u32 s80, s80, s90
    s_barrier
L_st_j:
    s_barrier
    s_cmp_eq_u32 s3, 0
    s_cbranch_scc1 L_st_w0
    s_mov_b64 exec, 0
    s_cmp_eq_u32 s3, 1
    s_cbranch_scc1 L_pad_0
    s_cmp_eq_u32 s3, 2
    s_cbranch_scc1 L_pad_1
    s_branch L_pad_2
L_walk_done:
    s_mov_b64 exec, -1
    s_branch L_st_w
L_st_w0:
    s_mov_b32 s37, 0x40000
L_st_n:
    v_cmp_ne_u32 vcc, 0, v12
    s_sub_u32 s37, s37, 1
    s_cbranch_scc1 L_st_nd
    s_nop 0
    s_cbranch_vccnz L_st_nd
    s_sleep 1
    buffer_load_dword v12, v13, s[76:79], 0 offen sc1
    s_waitcnt vmcnt(0)
    s_branch L_st_n
L_st_nd:
    v_readfirstlane_b32 s61, v12
    s_lshl_b32 s36, s2, 2
    s_add_u32 s36, s36, 53481472
    v_mov_b32 v15, 0
    s_mov_b64 exec, 1
    buffer_store_dword v12, v15, s[8:11], s36 offen sc1
    v_mov_b32 v15, 143360
    ds_write_b32 v15, v12
    s_mov_b64 exec, -1
    s_lshl_b32 s36, s24, 7
    s_add_u32 s36, s36, 53481472
    v_min_u32 v15, 31, v0
    v_lshlrev_b32 v15, 2, v15
    s_mov_b32 s37, 0x40000
L_st_p:
    buffer_load_dword v14, v15, s[8:11], s36 offen sc1
    s_waitcnt vmcnt(0)
    v_cmp_ne_u32 vcc, s61, v14
    s_sub_u32 s37, s37, 1
    s_cbranch_scc1 L_st_w
    s_nop 0
    s_cbranch_vccz L_st_w
    s_sleep 2
    s_branch L_st_p
L_st_w:
    s_add_u32 m0, s31, 0
    s_nop 0
    buffer_load_dwordx4 v6, s[12:15], s27 offen offset:0 lds
    s_add_u32 m0, s31, 4032
    s_nop 0
    buffer_load_dwordx4 v6, s[12:15], s27 offen offset:64 lds
    s_add_u32 m0, s31, 8064
    s_nop 0
    buffer_load_dwordx4 v6, s[12:15], s27 offen offset:128 lds
    s_add_u32 m0, s31, 12096
    s_nop 0
    buffer_load_dwordx4 v6, s[12:15], s27 offen offset:192 lds
    s_add_u32 m0, s31, 16384
    s_nop 0
    buffer_load_dwordx4 v7, s[16:19], s28 offen lds
    s_add_u32 m0, s31, 20480
    s_nop 0
    buffer_load_dwordx4 v7, s[16:19], s29 offen lds
    s_add_u32 m0, s31, 24576
    s_nop 0
    buffer_load_dwordx4 v7, s[16:19], s30 offen lds
    s_add_u32 s27, s27, 458752
    s_add_u32 s28, s28, 393216
    s_add_u32 s29, s29, 393216
    s_add_u32 s30, s30, 393216
    s_add_u32 s31, s31, 28672
    s_cmp_ge_u32 s31, 143360
    s_cselect_b32 s34, 143360, 0
    s_sub_u32 s31, s31, s34
    s_add_u32 m0, s31, 0
    s_nop 0
    buffer_load_dwordx4 v6, s[12:15], s27 offen offset:0 lds
    s_add_u32 m0, s31, 4032
    s_nop 0
    buffer_load_dwordx4 v6, s[12:15], s27 offen offset:64 lds
    s_add_u32 m0, s31, 8064
    s_nop 0
    buffer_load_dwordx4 v6, s[12:15], s27 offen offset:128 lds
    s_add_u32 m0, s31, 12096
    s_nop 0
    buffer_load_dwordx4 v6, s[12:15], s27 offen offset:192 lds
    s_add_u32 m0, s31, 16384
    s_nop 0
    buffer_load_dwordx4 v7, s[16:19], s28 offen lds
    s_add_u32 m0, s31, 20480
    s_nop 0
    buffer_load_dwordx4 v7, s[16:19], s29 offen lds
    s_add_u32 m0, s31, 24576
    s_nop 0
    buffer_load_dwordx4 v7, s[16:19], s30 offen lds
    s_add_u32 s27, s27, 458752
    s_add_u32 s28, s28, 393216
    s_add_u32 s29, s29, 393216
    s_add_u32 s30, s30, 393216
    s_add_u32 s31, s31, 28672
    s_cmp_ge_u32 s31, 143360
    s_cselect_b32 s34, 143360, 0
    s_sub_u32 s31, s31, s34
    s_add_u32 m0, s31, 0
    s_nop 0
    buffer_load_dwordx4 v6, s[12:15], s27 offen offset:0 lds
    s_add_u32 m0, s31, 4032
    s_nop 0
    buffer_load_dwordx4 v6, s[12:15], s27 offen offset:64 lds
    s_add_u32 m0, s31, 8064
    s_nop 0
    buffer_load_dwordx4 v6, s[12:15], s27 offen offset:128 lds
    s_add_u32 m0, s31, 12096
    s_nop 0
    buffer_load_dwordx4 v6, s[12:15], s27 offen offset:192 lds
    s_add_u32 m0, s31, 16384
    s_nop 0
    buffer_load_dwordx4 v7, s[16:19], s28 offen lds
    s_add_u32 m0, s31, 20480
    s_nop 0
    buffer_load_dwordx4 v7, s[16:19], s29 offen lds
    s_add_u32 m0, s31, 24576
    s_nop 0
    buffer_load_dwordx4 v7, s[16:19], s30 offen lds
    s_add_u32 s27, s27, 458752
    s_add_u32 s28, s28, 393216
    s_add_u32 s29, s29, 393216
    s_add_u32 s30, s30, 393216
    s_add_u32 s31, s31, 28672
    s_cmp_ge_u32 s31, 143360
    s_cselect_b32 s34, 143360, 0
    s_sub_u32 s31, s31, s34
    s_waitcnt lgkmcnt(0)
    s_barrier
    v_mov_b32 v15, 143360
    ds_read_b32 v14, v15
    buffer_load_dwordx4 a[0:3], v2, s[8:11], s26 offen sc1
    buffer_load_dwordx4 a[4:7], v3, s[8:11], s26 offen sc1
    buffer_load_dwordx4 a[8:11], v4, s[8:11], s26 offen sc1
    buffer_load_dwordx4 a[12:15], v5, s[8:11], s26 offen sc1
    s_add_u32 s26, s26, 1024
    buffer_load_dwordx4 a[16:19], v2, s[8:11], s26 offen sc1
    buffer_load_dwordx4 a[20:23], v3, s[8:11], s26 offen sc1
    buffer_load_dwordx4 a[24:27], v4, s[8:11], s26 offen sc1
    buffer_load_dwordx4 a[28:31], v5, s[8:11], s26 offen sc1
    s_add_u32 s26, s26, 1024
    buffer_load_dwordx4 a[32:35], v2, s[8:11], s26 offen sc1
    buffer_load_dwordx4 a[36:39], v3, s[8:11], s26 offen sc1
    buffer_load_dwordx4 a[40:43], v4, s[8:11], s26 offen sc1
    buffer_load_dwordx4 a[44:47], v5, s[8:11], s26 offen sc1
    s_add_u32 s26, s26, 1024
    v_and_b32 v15, 15, v0
    v_lshlrev_b32 v15, 2, v15
    s_lshl_b32 s42, s24, 10
    s_lshl_b32 s43, s3, 8
    s_add_u32 s42, s42, s43
    s_add_u32 s42, s42, 4194304
    buffer_load_dword v238, v15, s[8:11], s42 offen offset:0 sc1
L_pad_0:
    s_cbranch_execz L_pad_3
    buffer_load_dword v239, v15, s[8:11], s42 offen offset:64 sc1
    buffer_load_dword v240, v15, s[8:11], s42 offen offset:128 sc1
    buffer_load_dword v241, v15, s[8:11], s42 offen offset:192 sc1
    s_waitcnt lgkmcnt(0)
    v_readfirstlane_b32 s61, v14
    s_waitcnt vmcnt(23)
    s_barrier
    ds_read_b64_tr_b16 a[64:65], v8 offset:0
    ds_read_b64_tr_b16 a[66:67], v8 offset:1024
    ds_read_b64_tr_b16 a[68:69], v9 offset:0
    ds_read_b64_tr_b16 a[70:71], v9 offset:1024
    ds_read_b64_tr_b16 a[72:73], v8 offset:4096
    ds_read_b64_tr_b16 a[74:75], v8 offset:5120
    ds_read_b64_tr_b16 a[76:77], v9 offset:4096
    ds_read_b64_tr_b16 a[78:79], v9 offset:5120
    s_waitcnt vmcnt(12)
    s_waitcnt lgkmcnt(6)
    v_mfma_f32_16x16x32_bf16 v[16:19], a[64:67], a[0:3], 0
    ds_read_b64_tr_b16 a[80:81], v8 offset:8192
    v_mfma_f32_16x16x32_bf16 v[20:23], a[64:67], a[4:7], 0
    ds_read_b64_tr_b16 a[82:83], v8 offset:9216
    v_mfma_f32_16x16x32_bf16 v[24:27], a[64:67], a[8:11], 0
    v_mfma_f32_16x16x32_bf16 v[28:31], a[64:67], a[12:15], 0
    s_waitcnt lgkmcnt(6)
    v_mfma_f32_16x16x32_bf16 v[32:35], a[68:71], a[0:3], 0
    ds_read_b64_tr_b16 a[84:85], v9 offset:8192
    v_mfma_f32_16x16x32_bf16 v[36:39], a[68:71], a[4:7], 0
    ds_read_b64_tr_b16 a[86:87], v9 offset:9216
    v_mfma_f32_16x16x32_bf16 v[40:43], a[68:71], a[8:11], 0
    buffer_load_dwordx4 a[48:51], v2, s[8:11], s26 offen sc1
    v_mfma_f32_16x16x32_bf16 v[44:47], a[68:71], a[12:15], 0
    s_waitcnt lgkmcnt(6)
    v_mfma_f32_16x16x32_bf16 v[48:51], a[72:75], a[0:3], 0
    ds_read_b64_tr_b16 a[88:89], v8 offset:12288
    v_mfma_f32_16x16x32_bf16 v[52:55], a[72:75], a[4:7], 0
    ds_read_b64_tr_b16 a[90:91], v8 offset:13312
    v_mfma_f32_16x16x32_bf16 v[56:59], a[72:75], a[8:11], 0
    s_add_u32 m0, s31, 0
    s_nop 0
    buffer_load_dwordx4 v6, s[12:15], s27 offen offset:0 lds
    v_mfma_f32_16x16x32_bf16 v[60:63], a[72:75], a[12:15], 0
    s_waitcnt lgkmcnt(6)
    v_mfma_f32_16x16x32_bf16 v[64:67], a[76:79], a[0:3], 0
    ds_read_b64_tr_b16 a[92:93], v8 offset:16384
    v_mfma_f32_16x16x32_bf16 v[68:71], a[76:79], a[4:7], 0
    ds_read_b64_tr_b16 a[94:95], v8 offset:17408
    v_mfma_f32_16x16x32_bf16 v[72:75], a[76:79], a[8:11], 0
    buffer_load_dwordx4 a[52:55], v3, s[8:11], s26 offen sc1
    v_mfma_f32_16x16x32_bf16 v[76:79], a[76:79], a[12:15], 0
    s_waitcnt lgkmcnt(6)
    v_mfma_f32_16x16x32_bf16 v[80:83], a[80:83], a[0:3], 0
    ds_read_b64_tr_b16 a[96:97], v9 offset:16384
    v_mfma_f32_16x16x32_bf16 v[84:87], a[80:83], a[4:7], 0
    ds_read_b64_tr_b16 a[98:99], v9 offset:17408
    v_mfma_f32_16x16x32_bf16 v[88:91], a[80:83], a[8:11], 0
    v_mfma_f32_16x16x32_bf16 v[92:95], a[80:83], a[12:15], 0
    s_waitcnt lgkmcnt(6)
    v_mfma_f32_16x16x32_bf16 v[96:99], a[84:87], a[0:3], 0
    ds_read_b64_tr_b16 a[100:101], v8 offset:20480
    v_mfma_f32_16x16x32_bf16 v[100:103], a[84:87], a[4:7], 0
    ds_read_b64_tr_b16 a[102:103], v8 offset:21504
    v_mfma_f32_16x16x32_bf16 v[104:107], a[84:87], a[8:11], 0
    s_add_u32 m0, s31, 4032
    s_nop 0
    buffer_load_dwordx4 v6, s[12:15], s27 offen offset:64 lds
    buffer_load_dwordx4 a[56:59], v4, s[8:11], s26 offen sc1
    v_mfma_f32_16x16x32_bf16 v[108:111], a[84:87], a[12:15], 0
    s_waitcnt lgkmcnt(6)
    v_mfma_f32_16x16x32_bf16 v[112:115], a[88:91], a[0:3], 0
    ds_read_b64_tr_b16 a[104:105], v9 offset:20480
    v_mfma_f32_16x16x32_bf16 v[116:119], a[88:91], a[4:7], 0
    ds_read_b64_tr_b16 a[106:107], v9 offset:21504
    v_mfma_f32_16x16x32_bf16 v[120:123], a[88:91], a[8:11], 0
    v_mfma_f32_16x16x32_bf16 v[124:127], a[88:91], a[12:15], 0
    s_waitcnt lgkmcnt(6)
    v_mfma_f32_16x16x32_bf16 v[128:131], a[92:95], a[0:3], 0
    ds_read_b64_tr_b16 a[108:109], v8 offset:24576
    v_mfma_f32_16x16x32_bf16 v[132:135], a[92:95], a[4:7], 0
    ds_read_b64_tr_b16 a[110:111], v8 offset:25600
    v_mfma_f32_16x16x32_bf16 v[136:139], a[92:95], a[8:11], 0
    buffer_load_dwordx4 a[60:63], v5, s[8:11], s26 offen sc1
    v_mfma_f32_16x16x32_bf16 v[140:143], a[92:95], a[12:15], 0
    s_waitcnt lgkmcnt(6)
    v_mfma_f32_16x16x32_bf16 v[144:147], a[96:99], a[0:3], 0
    ds_read_b64_tr_b16 a[112:113], v9 offset:24576
    v_mfma_f32_16x16x32_bf16 v[148:151], a[96:99], a[4:7], 0
    ds_read_b64_tr_b16 a[114:115], v9 offset:25600
    v_mfma_f32_16x16x32_bf16 v[152:155], a[96:99], a[8:11], 0
    s_add_u32 m0, s31, 8064
    s_nop 0
    buffer_load_dwordx4 v6, s[12:15], s27 offen offset:128 lds
    s_add_u32 s26, s26, 1024
    v_mfma_f32_16x16x32_bf16 v[156:159], a[96:99], a[12:15], 0
    s_waitcnt lgkmcnt(6)
    v_mfma_f32_16x16x32_bf16 v[160:163], a[100:103], a[0:3], 0
    ds_read_b64_tr_b16 a[64:65], v8 offset:2048
    v_mfma_f32_16x16x32_bf16 v[164:167], a[100:103], a[4:7], 0
    ds_read_b64_tr_b16 a[66:67], v8 offset:3072
    v_mfma_f32_16x16x32_bf16 v[168:171], a[100:103], a[8:11], 0
    v_mfma_f32_16x16x32_bf16 v[172:175], a[100:103], a[12:15], 0
    s_waitcnt lgkmcnt(6)
    v_mfma_f32_16x16x32_bf16 v[176:179], a[104:107], a[0:3], 0
    ds_read_b64_tr_b16 a[68:69], v9 offset:2048
    v_mfma_f32_16x16x32_bf16 v[180:183], a[104:107], a[4:7], 0
    ds_read_b64_tr_b16 a[70:71], v9 offset:3072
    v_mfma_f32_16x16x32_bf16 v[184:187], a[104:107], a[8:11], 0
    v_mfma_f32_16x16x32_bf16 v[188:191], a[104:107], a[12:15], 0
    s_waitcnt lgkmcnt(6)
    v_mfma_f32_16x16x32_bf16 v[192:195], a[0:3], a[108:111], 0
    ds_read_b64_tr_b16 a[72:73], v8 offset:6144
    v_mfma_f32_16x16x32_bf16 v[196:199], a[4:7], a[108:111], 0
    ds_read_b64_tr_b16 a[74:75], v8 offset:7168
    v_mfma_f32_16x16x32_bf16 v[200:203], a[8:11], a[108:111], 0
    s_add_u32 m0, s31, 12096
    s_nop 0
    buffer_load_dwordx4 v6, s[12:15], s27 offen offset:192 lds
    v_mfma_f32_16x16x32_bf16 v[204:207], a[12:15], a[108:111], 0
    s_waitcnt lgkmcnt(6)
    v_mfma_f32_16x16x32_bf16 v[208:211], a[0:3], a[112:115], 0
    ds_read_b64_tr_b16 a[76:77], v9 offset:6144
    v_mfma_f32_16x16x32_bf16 v[212:215], a[4:7], a[112:115], 0
    ds_read_b64_tr_b16 a[78:79], v9 offset:7168
    v_mfma_f32_16x16x32_bf16 v[216:219], a[8:11], a[112:115], 0
    v_mfma_f32_16x16x32_bf16 v[220:223], a[12:15], a[112:115], 0
    s_waitcnt vmcnt(16)
    s_waitcnt lgkmcnt(6)
    v_mfma_f32_16x16x32_bf16 v[16:19], a[64:67], a[16:19], v[16:19]
    ds_read_b64_tr_b16 a[80:81], v8 offset:10240
    v_mfma_f32_16x16x32_bf16 v[20:23], a[64:67], a[20:23], v[20:23]
    ds_read_b64_tr_b16 a[82:83], v8 offset:11264
    v_mfma_f32_16x16x32_bf16 v[24:27], a[64:67], a[24:27], v[24:27]
    v_mfma_f32_16x16x32_bf16 v[28:31], a[64:67], a[28:31], v[28:31]
    s_waitcnt lgkmcnt(6)
    v_mfma_f32_16x16x32_bf16 v[32:35], a[68:71], a[16:19], v[32:35]
    ds_read_b64_tr_b16 a[84:85], v9 offset:10240
    v_mfma_f32_16x16x32_bf16 v[36:39], a[68:71], a[20:23], v[36:39]
    ds_read_b64_tr_b16 a[86:87], v9 offset:11264
    v_mfma_f32_16x16x32_bf16 v[40:43], a[68:71], a[24:27], v[40:43]
    s_add_u32 m0, s31, 16384
    s_nop 0
    buffer_load_dwordx4 v7, s[16:19], s28 offen lds
    buffer_load_dwordx4 a[0:3], v2, s[8:11], s26 offen sc1
    v_mfma_f32_16x16x32_bf16 v[44:47], a[68:71], a[28:31], v[44:47]
    s_waitcnt lgkmcnt(6)
    v_mfma_f32_16x16x32_bf16 v[48:51], a[72:75], a[16:19], v[48:51]
    ds_read_b64_tr_b16 a[88:89], v8 offset:14336
    v_mfma_f32_16x16x32_bf16 v[52:55], a[72:75], a[20:23], v[52:55]
    ds_read_b64_tr_b16 a[90:91], v8 offset:15360
    v_mfma_f32_16x16x32_bf16 v[56:59], a[72:75], a[24:27], v[56:59]
    v_mfma_f32_16x16x32_bf16 v[60:63], a[72:75], a[28:31], v[60:63]
    s_waitcnt lgkmcnt(6)
    v_mfma_f32_16x16x32_bf16 v[64:67], a[76:79], a[16:19], v[64:67]
    ds_read_b64_tr_b16 a[92:93], v8 offset:18432
    v_mfma_f32_16x16x32_bf16 v[68:71], a[76:79], a[20:23], v[68:71]
    ds_read_b64_tr_b16 a[94:95], v8 offset:19456
    v_mfma_f32_16x16x32_bf16 v[72:75], a[76:79], a[24:27], v[72:75]
    buffer_load_dwordx4 a[4:7], v3, s[8:11], s26 offen sc1
    v_mfma_f32_16x16x32_bf16 v[76:79], a[76:79], a[28:31], v[76:79]
    s_waitcnt lgkmcnt(6)
    v_mfma_f32_16x16x32_bf16 v[80:83], a[80:83], a[16:19], v[80:83]
    ds_read_b64_tr_b16 a[96:97], v9 offset:18432
    v_mfma_f32_16x16x32_bf16 v[84:87], a[80:83], a[20:23], v[84:87]
    ds_read_b64_tr_b16 a[98:99], v9 offset:19456
    v_mfma_f32_16x16x32_bf16 v[88:91], a[80:83], a[24:27], v[88:91]
    s_add_u32 m0, s31, 20480
    s_nop 0
    buffer_load_dwordx4 v7, s[16:19], s29 offen lds
    v_mfma_f32_16x16x32_bf16 v[92:95], a[80:83], a[28:31], v[92:95]
    s_waitcnt lgkmcnt(6)
    v_mfma_f32_16x16x32_bf16 v[96:99], a[84:87], a[16:19], v[96:99]
    ds_read_b64_tr_b16 a[100:101], v8 offset:22528
    v_mfma_f32_16x16x32_bf16 v[100:103], a[84:87], a[20:23], v[100:103]
    ds_read_b64_tr_b16 a[102:103], v8 offset:23552
    v_mfma_f32_16x16x32_bf16 v[104:107], a[84:87], a[24:27], v[104:107]
    buffer_load_dwordx4 a[8:11], v4, s[8:11], s26 offen sc1
    v_mfma_f32_16x16x32_bf16 v[108:111], a[84:87], a[28:31], v[108:111]
    s_waitcnt lgkmcnt(6)
    v_mfma_f32_16x16x32_bf16 v[112:115], a[88:91], a[16:19], v[112:115]
    ds_read_b64_tr_b16 a[104:105], v9 offset:22528
    v_mfma_f32_16x16x32_bf16 v[116:119], a[88:91], a[20:23], v[116:119]
    ds_read_b64_tr_b16 a[106:107], v9 offset:23552
    v_mfma_f32_16x16x32_bf16 v[120:123], a[88:91], a[24:27], v[120:123]
    v_mfma_f32_16x16x32_bf16 v[124:127], a[88:91], a[28:31], v[124:127]
    s_add_u32 s32, s32, 28672
    s_cmp_ge_u32 s32, 143360
    s_cselect_b32 s34, 143360, 0
    s_sub_u32 s32, s32, s34
    s_waitcnt lgkmcnt(6)
    v_mfma_f32_16x16x32_bf16 v[128:131], a[92:95], a[16:19], v[128:131]
    ds_read_b64_tr_b16 a[108:109], v8 offset:26624
    v_mfma_f32_16x16x32_bf16 v[132:135], a[92:95], a[20:23], v[132:135]
    ds_read_b64_tr_b16 a[110:111], v8 offset:27648
    v_mfma_f32_16x16x32_bf16 v[136:139], a[92:95], a[24:27], v[136:139]
    s_add_u32 m0, s31, 24576
    s_nop 0
    buffer_load_dwordx4 v7, s[16:19], s30 offen lds
    buffer_load_dwordx4 a[12:15], v5, s[8:11], s26 offen sc1
    v_mfma_f32_16x16x32_bf16 v[140:143], a[92:95], a[28:31], v[140:143]
    s_waitcnt lgkmcnt(6)
    v_mfma_f32_16x16x32_bf16 v[144:147], a[96:99], a[16:19], v[144:147]
    ds_read_b64_tr_b16 a[112:113], v9 offset:26624
    v_mfma_f32_16x16x32_bf16 v[148:151], a[96:99], a[20:23], v[148:151]
    ds_read_b64_tr_b16 a[114:115], v9 offset:27648
    v_mfma_f32_16x16x32_bf16 v[152:155], a[96:99], a[24:27], v[152:155]
    s_add_u32 s27, s27, 458752
    s_add_u32 s28, s28, 393216
    s_add_u32 s29, s29, 393216
    s_add_u32 s30, s30, 393216
    s_add_u32 s31, s31, 28672
    s_cmp_ge_u32 s31, 143360
    s_cselect_b32 s34, 143360, 0
    s_sub_u32 s31, s31, s34
    s_add_u32 s26, s26, 1024
    v_mfma_f32_16x16x32_bf16 v[156:159], a[96:99], a[28:31], v[156:159]
    s_barrier
    v_add_u32 v8, s32, v10
    v_add_u32 v9, s32, v11
    s_waitcnt lgkmcnt(6)
    v_mfma_f32_16x16x32_bf16 v[160:163], a[100:103], a[16:19], v[160:163]
    ds_read_b64_tr_b16 a[64:65], v8 offset:0
    v_mfma_f32_16x16x32_bf16 v[164:167], a[100:103], a[20:23], v[164:167]
    ds_read_b64_tr_b16 a[66:67], v8 offset:1024
    v_mfma_f32_16x16x32_bf16 v[168:171], a[100:103], a[24:27], v[168:171]
    buffer_load_dwordx4 a[240:243], v1, s[72:75], s80 offen
    s_add_u32 s80, s80, s90
    v_mfma_f32_16x16x32_bf16 v[172:175], a[100:103], a[28:31], v[172:175]
    s_waitcnt lgkmcnt(6)
    v_mfma_f32_16x16x32_bf16 v[176:179], a[104:107], a[16:19], v[176:179]
    ds_read_b64_tr_b16 a[68:69], v9 offset:0
    v_mfma_f32_16x16x32_bf16 v[180:183], a[104:107], a[20:23], v[180:183]
    ds_read_b64_tr_b16 a[70:71], v9 offset:1024
    v_mfma_f32_16x16x32_bf16 v[184:187], a[104:107], a[24:27], v[184:187]
    v_mfma_f32_16x16x32_bf16 v[188:191], a[104:107], a[28:31], v[188:191]
    s_waitcnt lgkmcnt(6)
    v_mfma_f32_16x16x32_bf16 v[192:195], a[16:19], a[108:111], v[192:195]
    ds_read_b64_tr_b16 a[72:73], v8 offset:4096
    v_mfma_f32_16x16x32_bf16 v[196:199], a[20:23], a[108:111], v[196:199]
    ds_read_b64_tr_b16 a[74:75], v8 offset:5120
    v_mfma_f32_16x16x32_bf16 v[200:203], a[24:27], a[108:111], v[200:203]
    v_mfma_f32_16x16x32_bf16 v[204:207], a[28:31], a[108:111], v[204:207]
    s_waitcnt lgkmcnt(6)
    v_mfma_f32_16x16x32_bf16 v[208:211], a[16:19], a[112:115], v[208:211]
    ds_read_b64_tr_b16 a[76:77], v9 offset:4096
    v_mfma_f32_16x16x32_bf16 v[212:215], a[20:23], a[112:115], v[212:215]
    ds_read_b64_tr_b16 a[78:79], v9 offset:5120
    v_mfma_f32_16x16x32_bf16 v[216:219], a[24:27], a[112:115], v[216:219]
    v_mfma_f32_16x16x32_bf16 v[220:223], a[28:31], a[112:115], v[220:223]
    s_waitcnt vmcnt(20)
    s_waitcnt lgkmcnt(6)
    v_mfma_f32_16x16x32_bf16 v[16:19], a[64:67], a[32:35], v[16:19]
    ds_read_b64_tr_b16 a[80:81], v8 offset:8192
    v_mfma_f32_16x16x32_bf16 v[20:23], a[64:67], a[36:39], v[20:23]
    ds_read_b64_tr_b16 a[82:83], v8 offset:9216
    v_mfma_f32_16x16x32_bf16 v[24:27], a[64:67], a[40:43], v[24:27]
    v_mfma_f32_16x16x32_bf16 v[28:31], a[64:67], a[44:47], v[28:31]
    s_waitcnt lgkmcnt(6)
    v_mfma_f32_16x16x32_bf16 v[32:35], a[68:71], a[32:35], v[32:35]
    ds_read_b64_tr_b16 a[84:85], v9 offset:8192
    v_mfma_f32_16x16x32_bf16 v[36:39], a[68:71], a[36:39], v[36:39]
    ds_read_b64_tr_b16 a[86:87], v9 offset:9216
    v_mfma_f32_16x16x32_bf16 v[40:43], a[68:71], a[40:43], v[40:43]
    buffer_load_dwordx4 a[16:19], v2, s[8:11], s26 offen sc1
    v_mfma_f32_16x16x32_bf16 v[44:47], a[68:71], a[44:47], v[44:47]
    s_waitcnt lgkmcnt(6)
    v_mfma_f32_16x16x32_bf16 v[48:51], a[72:75], a[32:35], v[48:51]
    ds_read_b64_tr_b16 a[88:89], v8 offset:12288
    v_mfma_f32_16x16x32_bf16 v[52:55], a[72:75], a[36:39], v[52:55]
    ds_read_b64_tr_b16 a[90:91], v8 offset:13312
    v_mfma_f32_16x16x32_bf16 v[56:59], a[72:75], a[40:43], v[56:59]
    s_add_u32 m0, s31, 0
    s_nop 0
    buffer_load_dwordx4 v6, s[12:15], s27 offen offset:0 lds
    v_mfma_f32_16x16x32_bf16 v[60:63], a[72:75], a[44:47], v[60:63]
    s_waitcnt lgkmcnt(6)
    v_mfma_f32_16x16x32_bf16 v[64:67], a[76:79], a[32:35], v[64:67]
    ds_read_b64_tr_b16 a[92:93], v8 offset:16384
    v_mfma_f32_16x16x32_bf16 v[68:71], a[76:79], a[36:39], v[68:71]
    ds_read_b64_tr_b16 a[94:95], v8 offset:17408
    v_mfma_f32_16x16x32_bf16 v[72:75], a[76:79], a[40:43], v[72:75]
    buffer_load_dwordx4 a[20:23], v3, s[8:11], s26 offen sc1
    v_mfma_f32_16x16x32_bf16 v[76:79], a[76:79], a[44:47], v[76:79]
    s_waitcnt lgkmcnt(6)
    v_mfma_f32_16x16x32_bf16 v[80:83], a[80:83], a[32:35], v[80:83]
    ds_read_b64_tr_b16 a[96:97], v9 offset:16384
    v_mfma_f32_16x16x32_bf16 v[84:87], a[80:83], a[36:39], v[84:87]
    ds_read_b64_tr_b16 a[98:99], v9 offset:17408
    v_mfma_f32_16x16x32_bf16 v[88:91], a[80:83], a[40:43], v[88:91]
    v_mfma_f32_16x16x32_bf16 v[92:95], a[80:83], a[44:47], v[92:95]
    s_waitcnt lgkmcnt(6)
    v_mfma_f32_16x16x32_bf16 v[96:99], a[84:87], a[32:35], v[96:99]
    ds_read_b64_tr_b16 a[100:101], v8 offset:20480
    v_mfma_f32_16x16x32_bf16 v[100:103], a[84:87], a[36:39], v[100:103]
    ds_read_b64_tr_b16 a[102:103], v8 offset:21504
    v_mfma_f32_16x16x32_bf16 v[104:107], a[84:87], a[40:43], v[104:107]
    s_add_u32 m0, s31, 4032
    s_nop 0
    buffer_load_dwordx4 v6, s[12:15], s27 offen offset:64 lds
    buffer_load_dwordx4 a[24:27], v4, s[8:11], s26 offen sc1
    v_mfma_f32_16x16x32_bf16 v[108:111], a[84:87], a[44:47], v[108:111]
    s_waitcnt lgkmcnt(6)
    v_mfma_f32_16x16x32_bf16 v[112:115], a[88:91], a[32:35], v[112:115]
    ds_read_b64_tr_b16 a[104:105], v9 offset:20480
    v_mfma_f32_16x16x32_bf16 v[116:119], a[88:91], a[36:39], v[116:119]
    ds_read_b64_tr_b16 a[106:107], v9 offset:21504
    v_mfma_f32_16x16x32_bf16 v[120:123], a[88:91], a[40:43], v[120:123]
    v_mfma_f32_16x16x32_bf16 v[124:127], a[88:91], a[44:47], v[124:127]
    s_waitcnt lgkmcnt(6)
    v_mfma_f32_16x16x32_bf16 v[128:131], a[92:95], a[32:35], v[128:131]
    ds_read_b64_tr_b16 a[108:109], v8 offset:24576
    v_mfma_f32_16x16x32_bf16 v[132:135], a[92:95], a[36:39], v[132:135]
    ds_read_b64_tr_b16 a[110:111], v8 offset:25600
    v_mfma_f32_16x16x32_bf16 v[136:139], a[92:95], a[40:43], v[136:139]
    buffer_load_dwordx4 a[28:31], v5, s[8:11], s26 offen sc1
    v_mfma_f32_16x16x32_bf16 v[140:143], a[92:95], a[44:47], v[140:143]
    s_waitcnt lgkmcnt(6)
    v_mfma_f32_16x16x32_bf16 v[144:147], a[96:99], a[32:35], v[144:147]
    ds_read_b64_tr_b16 a[112:113], v9 offset:24576
    v_mfma_f32_16x16x32_bf16 v[148:151], a[96:99], a[36:39], v[148:151]
    ds_read_b64_tr_b16 a[114:115], v9 offset:25600
    v_mfma_f32_16x16x32_bf16 v[152:155], a[96:99], a[40:43], v[152:155]
    s_add_u32 m0, s31, 8064
    s_nop 0
    buffer_load_dwordx4 v6, s[12:15], s27 offen offset:128 lds
    s_add_u32 s26, s26, 1024
    v_mfma_f32_16x16x32_bf16 v[156:159], a[96:99], a[44:47], v[156:159]
    s_waitcnt lgkmcnt(6)
    v_mfma_f32_16x16x32_bf16 v[160:163], a[100:103], a[32:35], v[160:163]
    ds_read_b64_tr_b16 a[64:65], v8 offset:2048
    v_mfma_f32_16x16x32_bf16 v[164:167], a[100:103], a[36:39], v[164:167]
    ds_read_b64_tr_b16 a[66:67], v8 offset:3072
    v_mfma_f32_16x16x32_bf16 v[168:171], a[100:103], a[40:43], v[168:171]
    v_mfma_f32_16x16x32_bf16 v[172:175], a[100:103], a[44:47], v[172:175]
    s_waitcnt lgkmcnt(6)
    v_mfma_f32_16x16x32_bf16 v[176:179], a[104:107], a[32:35], v[176:179]
    ds_read_b64_tr_b16 a[68:69], v9 offset:2048
    v_mfma_f32_16x16x32_bf16 v[180:183], a[104:107], a[36:39], v[180:183]
    ds_read_b64_tr_b16 a[70:71], v9 offset:3072
    v_mfma_f32_16x16x32_bf16 v[184:187], a[104:107], a[40:43], v[184:187]
    v_mfma_f32_16x16x32_bf16 v[188:191], a[104:107], a[44:47], v[188:191]
    s_waitcnt lgkmcnt(6)
    v_mfma_f32_16x16x32_bf16 v[192:195], a[32:35], a[108:111], v[192:195]
    ds_read_b64_tr_b16 a[72:73], v8 offset:6144
    v_mfma_f32_16x16x32_bf16 v[196:199], a[36:39], a[108:111], v[196:199]
    ds_read_b64_tr_b16 a[74:75], v8 offset:7168
    v_mfma_f32_16x16x32_bf16 v[200:203], a[40:43], a[108:111], v[200:203]
    s_add_u32 m0, s31, 12096
    s_nop 0
    buffer_load_dwordx4 v6, s[12:15], s27 offen offset:192 lds
    v_mfma_f32_16x16x32_bf16 v[204:207], a[44:47], a[108:111], v[204:207]
    s_waitcnt lgkmcnt(6)
    v_mfma_f32_16x16x32_bf16 v[208:211], a[32:35], a[112:115], v[208:211]
    ds_read_b64_tr_b16 a[76:77], v9 offset:6144
    v_mfma_f32_16x16x32_bf16 v[212:215], a[36:39], a[112:115], v[212:215]
    ds_read_b64_tr_b16 a[78:79], v9 offset:7168
    v_mfma_f32_16x16x32_bf16 v[216:219], a[40:43], a[112:115], v[216:219]
    v_mfma_f32_16x16x32_bf16 v[220:223], a[44:47], a[112:115], v[220:223]
    s_waitcnt vmcnt(18)
    s_waitcnt lgkmcnt(6)
    v_mfma_f32_16x16x32_bf16 v[16:19], a[64:67], a[48:51], v[16:19]
    ds_read_b64_tr_b16 a[80:81], v8 offset:10240
    v_mfma_f32_16x16x32_bf16 v[20:23], a[64:67], a[52:55], v[20:23]
    ds_read_b64_tr_b16 a[82:83], v8 offset:11264
    v_mfma_f32_16x16x32_bf16 v[24:27], a[64:67], a[56:59], v[24:27]
    v_mfma_f32_16x16x32_bf16 v[28:31], a[64:67], a[60:63], v[28:31]
    s_waitcnt lgkmcnt(6)
    v_mfma_f32_16x16x32_bf16 v[32:35], a[68:71], a[48:51], v[32:35]
    ds_read_b64_tr_b16 a[84:85], v9 offset:10240
    v_mfma_f32_16x16x32_bf16 v[36:39], a[68:71], a[52:55], v[36:39]
    ds_read_b64_tr_b16 a[86:87], v9 offset:11264
    v_mfma_f32_16x16x32_bf16 v[40:43], a[68:71], a[56:59], v[40:43]
    s_add_u32 m0, s31, 16384
    s_nop 0
    buffer_load_dwordx4 v7, s[16:19], s28 offen lds
    buffer_load_dwordx4 a[32:35], v2, s[8:11], s26 offen sc1
    v_mfma_f32_16x16x32_bf16 v[44:47], a[68:71], a[60:63], v[44:47]
    s_waitcnt lgkmcnt(6)
    v_mfma_f32_16x16x32_bf16 v[48:51], a[72:75], a[48:51], v[48:51]
    ds_read_b64_tr_b16 a[88:89], v8 offset:14336
    v_mfma_f32_16x16x32_bf16 v[52:55], a[72:75], a[52:55], v[52:55]
    ds_read_b64_tr_b16 a[90:91], v8 offset:15360
    v_mfma_f32_16x16x32_bf16 v[56:59], a[72:75], a[56:59], v[56:59]
    v_mfma_f32_16x16x32_bf16 v[60:63], a[72:75], a[60:63], v[60:63]
    s_waitcnt lgkmcnt(6)
    v_mfma_f32_16x16x32_bf16 v[64:67], a[76:79], a[48:51], v[64:67]
    ds_read_b64_tr_b16 a[92:93], v8 offset:18432
    v_mfma_f32_16x16x32_bf16 v[68:71], a[76:79], a[52:55], v[68:71]
    ds_read_b64_tr_b16 a[94:95], v8 offset:19456
    v_mfma_f32_16x16x32_bf16 v[72:75], a[76:79], a[56:59], v[72:75]
    buffer_load_dwordx4 a[36:39], v3, s[8:11], s26 offen sc1
    v_mfma_f32_16x16x32_bf16 v[76:79], a[76:79], a[60:63], v[76:79]
    s_waitcnt lgkmcnt(6)
    v_mfma_f32_16x16x32_bf16 v[80:83], a[80:83], a[48:51], v[80:83]
    ds_read_b64_tr_b16 a[96:97], v9 offset:18432
    v_mfma_f32_16x16x32_bf16 v[84:87], a[80:83], a[52:55], v[84:87]
    ds_read_b64_tr_b16 a[98:99], v9 offset:19456
    v_mfma_f32_16x16x32_bf16 v[88:91], a[80:83], a[56:59], v[88:91]
    s_add_u32 m0, s31, 20480
    s_nop 0
    buffer_load_dwordx4 v7, s[16:19], s29 offen lds
    v_mfma_f32_16x16x32_bf16 v[92:95], a[80:83], a[60:63], v[92:95]
    s_waitcnt lgkmcnt(6)
    v_mfma_f32_16x16x32_bf16 v[96:99], a[84:87], a[48:51], v[96:99]
    ds_read_b64_tr_b16 a[100:101], v8 offset:22528
    v_mfma_f32_16x16x32_bf16 v[100:103], a[84:87], a[52:55], v[100:103]
    ds_read_b64_tr_b16 a[102:103], v8 offset:23552
    v_mfma_f32_16x16x32_bf16 v[104:107], a[84:87], a[56:59], v[104:107]
    buffer_load_dwordx4 a[40:43], v4, s[8:11], s26 offen sc1
    v_mfma_f32_16x16x32_bf16 v[108:111], a[84:87], a[60:63], v[108:111]
    s_waitcnt lgkmcnt(6)
    v_mfma_f32_16x16x32_bf16 v[112:115], a[88:91], a[48:51], v[112:115]
    ds_read_b64_tr_b16 a[104:105], v9 offset:22528
    v_mfma_f32_16x16x32_bf16 v[116:119], a[88:91], a[52:55], v[116:119]
    ds_read_b64_tr_b16 a[106:107], v9 offset:23552
    v_mfma_f32_16x16x32_bf16 v[120:123], a[88:91], a[56:59], v[120:123]
    v_mfma_f32_16x16x32_bf16 v[124:127], a[88:91], a[60:63], v[124:127]
    s_add_u32 s32, s32, 28672
    s_cmp_ge_u32 s32, 143360
    s_cselect_b32 s34, 143360, 0
    s_sub_u32 s32, s32, s34
    s_waitcnt lgkmcnt(6)
    v_mfma_f32_16x16x32_bf16 v[128:131], a[92:95], a[48:51], v[128:131]
    ds_read_b64_tr_b16 a[108:109], v8 offset:26624
    v_mfma_f32_16x16x32_bf16 v[132:135], a[92:95], a[52:55], v[132:135]
    ds_read_b64_tr_b16 a[110:111], v8 offset:27648
    v_mfma_f32_16x16x32_bf16 v[136:139], a[92:95], a[56:59], v[136:139]
    s_add_u32 m0, s31, 24576
    s_nop 0
    buffer_load_dwordx4 v7, s[16:19], s30 offen lds
    buffer_load_dwordx4 a[44:47], v5, s[8:11], s26 offen sc1
    v_mfma_f32_16x16x32_bf16 v[140:143], a[92:95], a[60:63], v[140:143]
    s_waitcnt lgkmcnt(6)
    v_mfma_f32_16x16x32_bf16 v[144:147], a[96:99], a[48:51], v[144:147]
    ds_read_b64_tr_b16 a[112:113], v9 offset:26624
    v_mfma_f32_16x16x32_bf16 v[148:151], a[96:99], a[52:55], v[148:151]
    ds_read_b64_tr_b16 a[114:115], v9 offset:27648
    v_mfma_f32_16x16x32_bf16 v[152:155], a[96:99], a[56:59], v[152:155]
    s_add_u32 s27, s27, 458752
    s_add_u32 s28, s28, 393216
    s_add_u32 s29, s29, 393216
    s_add_u32 s30, s30, 393216
    s_add_u32 s31, s31, 28672
    s_cmp_ge_u32 s31, 143360
    s_cselect_b32 s34, 143360, 0
    s_sub_u32 s31, s31, s34
    s_add_u32 s26, s26, 1024
    v_mfma_f32_16x16x32_bf16 v[156:159], a[96:99], a[60:63], v[156:159]
    s_barrier
    v_add_u32 v8, s32, v10
    v_add_u32 v9, s32, v11
    s_waitcnt lgkmcnt(6)
    v_mfma_f32_16x16x32_bf16 v[160:163], a[100:103], a[48:51], v[160:163]
    ds_read_b64_tr_b16 a[64:65], v8 offset:0
    v_mfma_f32_16x16x32_bf16 v[164:167], a[100:103], a[52:55], v[164:167]
    ds_read_b64_tr_b16 a[66:67], v8 offset:1024
    v_mfma_f32_16x16x32_bf16 v[168:171], a[100:103], a[56:59], v[168:171]
    buffer_load_dwordx4 a[240:243], v1, s[72:75], s80 offen
    s_add_u32 s80, s80, s90
    v_mfma_f32_16x16x32_bf16 v[172:175], a[100:103], a[60:63], v[172:175]
    s_waitcnt lgkmcnt(6)
    v_mfma_f32_16x16x32_bf16 v[176:179], a[104:107], a[48:51], v[176:179]
    ds_read_b64_tr_b16 a[68:69], v9 offset:0
    v_mfma_f32_16x16x32_bf16 v[180:183], a[104:107], a[52:55], v[180:183]
    ds_read_b64_tr_b16 a[70:71], v9 offset:1024
    v_mfma_f32_16x16x32_bf16 v[184:187], a[104:107], a[56:59], v[184:187]
    v_mfma_f32_16x16x32_bf16 v[188:191], a[104:107], a[60:63], v[188:191]
    s_waitcnt lgkmcnt(6)
    v_mfma_f32_16x16x32_bf16 v[192:195], a[48:51], a[108:111], v[192:195]
    ds_read_b64_tr_b16 a[72:73], v8 offset:4096
    v_mfma_f32_16x16x32_bf16 v[196:199], a[52:55], a[108:111], v[196:199]
    ds_read_b64_tr_b16 a[74:75], v8 offset:5120
    v_mfma_f32_16x16x32_bf16 v[200:203], a[56:59], a[108:111], v[200:203]
    v_mfma_f32_16x16x32_bf16 v[204:207], a[60:63], a[108:111], v[204:207]
    s_waitcnt lgkmcnt(6)
    v_mfma_f32_16x16x32_bf16 v[208:211], a[48:51], a[112:115], v[208:211]
    ds_read_b64_tr_b16 a[76:77], v9 offset:4096
    v_mfma_f32_16x16x32_bf16 v[212:215], a[52:55], a[112:115], v[212:215]
    ds_read_b64_tr_b16 a[78:79], v9 offset:5120
    v_mfma_f32_16x16x32_bf16 v[216:219], a[56:59], a[112:115], v[216:219]
    v_mfma_f32_16x16x32_bf16 v[220:223], a[60:63], a[112:115], v[220:223]
    s_mov_b32 s33, 5
.p2align 4
L_G1_loop:
    s_waitcnt vmcnt(17)
    s_waitcnt lgkmcnt(6)
    v_mfma_f32_16x16x32_bf16 v[16:19], a[64:67], a[0:3], v[16:19]
    ds_read_b64_tr_b16 a[80:81], v8 offset:8192
    v_mfma_f32_16x16x32_bf16 v[20:23], a[64:67], a[4:7], v[20:23]
    ds_read_b64_tr_b16 a[82:83], v8 offset:9216
    v_mfma_f32_16x16x32_bf16 v[24:27], a[64:67], a[8:11], v[24:27]
    v_mfma_f32_16x16x32_bf16 v[28:31], a[64:67], a[12:15], v[28:31]
    s_waitcnt lgkmcnt(6)
    v_mfma_f32_16x16x32_bf16 v[32:35], a[68:71], a[0:3], v[32:35]
    ds_read_b64_tr_b16 a[84:85], v9 offset:8192
    v_mfma_f32_16x16x32_bf16 v[36:39], a[68:71], a[4:7], v[36:39]
    ds_read_b64_tr_b16 a[86:87], v9 offset:9216
    v_mfma_f32_16x16x32_bf16 v[40:43], a[68:71], a[8:11], v[40:43]
    buffer_load_dwordx4 a[48:51], v2, s[8:11], s26 offen sc1
    v_mfma_f32_16x16x32_bf16 v[44:47], a[68:71], a[12:15], v[44:47]
    s_waitcnt lgkmcnt(6)
    v_mfma_f32_16x16x32_bf16 v[48:51], a[72:75], a[0:3], v[48:51]
    ds_read_b64_tr_b16 a[88:89], v8 offset:12288
    v_mfma_f32_16x16x32_bf16 v[52:55], a[72:75], a[4:7], v[52:55]
    ds_read_b64_tr_b16 a[90:91], v8 offset:13312
    v_mfma_f32_16x16x32_bf16 v[56:59], a[72:75], a[8:11], v[56:59]
    s_add_u32 m0, s31, 0
    s_nop 0
    buffer_load_dwordx4 v6, s[12:15], s27 offen offset:0 lds
    v_mfma_f32_16x16x32_bf16 v[60:63], a[72:75], a[12:15], v[60:63]
    s_waitcnt lgkmcnt(6)
    v_mfma_f32_16x16x32_bf16 v[64:67], a[76:79], a[0:3], v[64:67]
    ds_read_b64_tr_b16 a[92:93], v8 offset:16384
    v_mfma_f32_16x16x32_bf16 v[68:71], a[76:79], a[4:7], v[68:71]
    ds_read_b64_tr_b16 a[94:95], v8 offset:17408
    v_mfma_f32_16x16x32_bf16 v[72:75], a[76:79], a[8:11], v[72:75]
    buffer_load_dwordx4 a[52:55], v3, s[8:11], s26 offen sc1
    v_mfma_f32_16x16x32_bf16 v[76:79], a[76:79], a[12:15], v[76:79]
    s_waitcnt lgkmcnt(6)
    v_mfma_f32_16x16x32_bf16 v[80:83], a[80:83], a[0:3], v[80:83]
    ds_read_b64_tr_b16 a[96:97], v9 offset:16384
    v_mfma_f32_16x16x32_bf16 v[84:87], a[80:83], a[4:7], v[84:87]
    ds_read_b64_tr_b16 a[98:99], v9 offset:17408
    v_mfma_f32_16x16x32_bf16 v[88:91], a[80:83], a[8:11], v[88:91]
    v_mfma_f32_16x16x32_bf16 v[92:95], a[80:83], a[12:15], v[92:95]
    s_waitcnt lgkmcnt(6)
    v_mfma_f32_16x16x32_bf16 v[96:99], a[84:87], a[0:3], v[96:99]
    ds_read_b64_tr_b16 a[100:101], v8 offset:20480
    v_mfma_f32_16x16x32_bf16 v[100:103], a[84:87], a[4:7], v[100:103]
    ds_read_b64_tr_b16 a[102:103], v8 offset:21504
    v_mfma_f32_16x16x32_bf16 v[104:107], a[84:87], a[8:11], v[104:107]
    s_add_u32 m0, s31, 4032
    s_nop 0
    buffer_load_dwordx4 v6, s[12:15], s27 offen offset:64 lds
    buffer_load_dwordx4 a[56:59], v4, s[8:11], s26 offen sc1
    v_mfma_f32_16x16x32_bf16 v[108:111], a[84:87], a[12:15], v[108:111]
    s_waitcnt lgkmcnt(6)
    v_mfma_f32_16x16x32_bf16 v[112:115], a[88:91], a[0:3], v[112:115]
    ds_read_b64_tr_b16 a[104:105], v9 offset:20480
    v_mfma_f32_16x16x32_bf16 v[116:119], a[88:91], a[4:7], v[116:119]
    ds_read_b64_tr_b16 a[106:107], v9 offset:21504
    v_mfma_f32_16x16x32_bf16 v[120:123], a[88:91], a[8:11], v[120:123]
    v_mfma_f32_16x16x32_bf16 v[124:127], a[88:91], a[12:15], v[124:127]
    s_waitcnt lgkmcnt(6)
    v_mfma_f32_16x16x32_bf16 v[128:131], a[92:95], a[0:3], v[128:131]
    ds_read_b64_tr_b16 a[108:109], v8 offset:24576
    v_mfma_f32_16x16x32_bf16 v[132:135], a[92:95], a[4:7], v[132:135]
    ds_read_b64_tr_b16 a[110:111], v8 offset:25600
    v_mfma_f32_16x16x32_bf16 v[136:139], a[92:95], a[8:11], v[136:139]
    buffer_load_dwordx4 a[60:63], v5, s[8:11], s26 offen sc1
    v_mfma_f32_16x16x32_bf16 v[140:143], a[92:95], a[12:15], v[140:143]
    s_waitcnt lgkmcnt(6)
    v_mfma_f32_16x16x32_bf16 v[144:147], a[96:99], a[0:3], v[144:147]
    ds_read_b64_tr_b16 a[112:113], v9 offset:24576
    v_mfma_f32_16x16x32_bf16 v[148:151], a[96:99], a[4:7], v[148:151]
    ds_read_b64_tr_b16 a[114:115], v9 offset:25600
    v_mfma_f32_16x16x32_bf16 v[152:155], a[96:99], a[8:11], v[152:155]
    s_add_u32 m0, s31, 8064
    s_nop 0
    buffer_load_dwordx4 v6, s[12:15], s27 offen offset:128 lds
    s_add_u32 s26, s26, 1024
    v_mfma_f32_16x16x32_bf16 v[156:159], a[96:99], a[12:15], v[156:159]
    s_waitcnt lgkmcnt(6)
    v_mfma_f32_16x16x32_bf16 v[160:163], a[100:103], a[0:3], v[160:163]
    ds_read_b64_tr_b16 a[64:65], v8 offset:2048
    v_mfma_f32_16x16x32_bf16 v[164:167], a[100:103], a[4:7], v[164:167]
    ds_read_b64_tr_b16 a[66:67], v8 offset:3072
    v_mfma_f32_16x16x32_bf16 v[168:171], a[100:103], a[8:11], v[168:171]
L_pad_1:
    s_cbranch_execz L_pad_4
    v_mfma_f32_16x16x32_bf16 v[172:175], a[100:103], a[12:15], v[172:175]
    s_waitcnt lgkmcnt(6)
    v_mfma_f32_16x16x32_bf16 v[176:179], a[104:107], a[0:3], v[176:179]
    ds_read_b64_tr_b16 a[68:69], v9 offset:2048
    v_mfma_f32_16x16x32_bf16 v[180:183], a[104:107], a[4:7], v[180:183]
    ds_read_b64_tr_b16 a[70:71], v9 offset:3072
    v_mfma_f32_16x16x32_bf16 v[184:187], a[104:107], a[8:11], v[184:187]
    v_mfma_f32_16x16x32_bf16 v[188:191], a[104:107], a[12:15], v[188:191]
    s_waitcnt lgkmcnt(6)
    v_mfma_f32_16x16x32_bf16 v[192:195], a[0:3], a[108:111], v[192:195]
    ds_read_b64_tr_b16 a[72:73], v8 offset:6144
    v_mfma_f32_16x16x32_bf16 v[196:199], a[4:7], a[108:111], v[196:199]
    ds_read_b64_tr_b16 a[74:75], v8 offset:7168
    v_mfma_f32_16x16x32_bf16 v[200:203], a[8:11], a[108:111], v[200:203]
    s_add_u32 m0, s31, 12096
    s_nop 0
    buffer_load_dwordx4 v6, s[12:15], s27 offen offset:192 lds
    v_mfma_f32_16x16x32_bf16 v[204:207], a[12:15], a[108:111], v[204:207]
    s_waitcnt lgkmcnt(6)
    v_mfma_f32_16x16x32_bf16 v[208:211], a[0:3], a[112:115], v[208:211]
    ds_read_b64_tr_b16 a[76:77], v9 offset:6144
    v_mfma_f32_16x16x32_bf16 v[212:215], a[4:7], a[112:115], v[212:215]
    ds_read_b64_tr_b16 a[78:79], v9 offset:7168
    v_mfma_f32_16x16x32_bf16 v[216:219], a[8:11], a[112:115], v[216:219]
    v_mfma_f32_16x16x32_bf16 v[220:223], a[12:15], a[112:115], v[220:223]
    s_waitcnt vmcnt(18)
    s_waitcnt lgkmcnt(6)
    v_mfma_f32_16x16x32_bf16 v[16:19], a[64:67], a[16:19], v[16:19]
    ds_read_b64_tr_b16 a[80:81], v8 offset:10240
    v_mfma_f32_16x16x32_bf16 v[20:23], a[64:67], a[20:23], v[20:23]
    ds_read_b64_tr_b16 a[82:83], v8 offset:11264
    v_mfma_f32_16x16x32_bf16 v[24:27], a[64:67], a[24:27], v[24:27]
    v_mfma_f32_16x16x32_bf16 v[28:31], a[64:67], a[28:31], v[28:31]
    s_waitcnt lgkmcnt(6)
    v_mfma_f32_16x16x32_bf16 v[32:35], a[68:71], a[16:19], v[32:35]
    ds_read_b64_tr_b16 a[84:85], v9 offset:10240
    v_mfma_f32_16x16x32_bf16 v[36:39], a[68:71], a[20:23], v[36:39]
    ds_read_b64_tr_b16 a[86:87], v9 offset:11264
    v_mfma_f32_16x16x32_bf16 v[40:43], a[68:71], a[24:27], v[40:43]
    s_add_u32 m0, s31, 16384
    s_nop 0
    buffer_load_dwordx4 v7, s[16:19], s28 offen lds
    buffer_load_dwordx4 a[0:3], v2, s[8:11], s26 offen sc1
    v_mfma_f32_16x16x32_bf16 v[44:47], a[68:71], a[28:31], v[44:47]
    s_waitcnt lgkmcnt(6)
    v_mfma_f32_16x16x32_bf16 v[48:51], a[72:75], a[16:19], v[48:51]
    ds_read_b64_tr_b16 a[88:89], v8 offset:14336
    v_mfma_f32_16x16x32_bf16 v[52:55], a[72:75], a[20:23], v[52:55]
    ds_read_b64_tr_b16 a[90:91], v8 offset:15360
    v_mfma_f32_16x16x32_bf16 v[56:59], a[72:75], a[24:27], v[56:59]
    v_mfma_f32_16x16x32_bf16 v[60:63], a[72:75], a[28:31], v[60:63]
    s_waitcnt lgkmcnt(6)
    v_mfma_f32_16x16x32_bf16 v[64:67], a[76:79], a[16:19], v[64:67]
    ds_read_b64_tr_b16 a[92:93], v8 offset:18432
    v_mfma_f32_16x16x32_bf16 v[68:71], a[76:79], a[20:23], v[68:71]
    ds_read_b64_tr_b16 a[94:95], v8 offset:19456
    v_mfma_f32_16x16x32_bf16 v[72:75], a[76:79], a[24:27], v[72:75]
    buffer_load_dwordx4 a[4:7], v3, s[8:11], s26 offen sc1
    v_mfma_f32_16x16x32_bf16 v[76:79], a[76:79], a[28:31], v[76:79]
    s_waitcnt lgkmcnt(6)
    v_mfma_f32_16x16x32_bf16 v[80:83], a[80:83], a[16:19], v[80:83]
    ds_read_b64_tr_b16 a[96:97], v9 offset:18432
    v_mfma_f32_16x16x32_bf16 v[84:87], a[80:83], a[20:23], v[84:87]
    ds_read_b64_tr_b16 a[98:99], v9 offset:19456
    v_mfma_f32_16x16x32_bf16 v[88:91], a[80:83], a[24:27], v[88:91]
    s_add_u32 m0, s31, 20480
    s_nop 0
    buffer_load_dwordx4 v7, s[16:19], s29 offen lds
    v_mfma_f32_16x16x32_bf16 v[92:95], a[80:83], a[28:31], v[92:95]
    s_waitcnt lgkmcnt(6)
    v_mfma_f32_16x16x32_bf16 v[96:99], a[84:87], a[16:19], v[96:99]
    ds_read_b64_tr_b16 a[100:101], v8 offset:22528
    v_mfma_f32_16x16x32_bf16 v[100:103], a[84:87], a[20:23], v[100:103]
    ds_read_b64_tr_b16 a[102:103], v8 offset:23552
    v_mfma_f32_16x16x32_bf16 v[104:107], a[84:87], a[24:27], v[104:107]
    buffer_load_dwordx4 a[8:11], v4, s[8:11], s26 offen sc1
    v_mfma_f32_16x16x32_bf16 v[108:111], a[84:87], a[28:31], v[108:111]
    s_waitcnt lgkmcnt(6)
    v_mfma_f32_16x16x32_bf16 v[112:115], a[88:91], a[16:19], v[112:115]
    ds_read_b64_tr_b16 a[104:105], v9 offset:22528
    v_mfma_f32_16x16x32_bf16 v[116:119], a[88:91], a[20:23], v[116:119]
    ds_read_b64_tr_b16 a[106:107], v9 offset:23552
    v_mfma_f32_16x16x32_bf16 v[120:123], a[88:91], a[24:27], v[120:123]
    v_mfma_f32_16x16x32_bf16 v[124:127], a[88:91], a[28:31], v[124:127]
    s_add_u32 s32, s32, 28672
    s_cmp_ge_u32 s32, 143360
    s_cselect_b32 s34, 143360, 0
    s_sub_u32 s32, s32, s34
    s_waitcnt lgkmcnt(6)
    v_mfma_f32_16x16x32_bf16 v[128:131], a[92:95], a[16:19], v[128:131]
    ds_read_b64_tr_b16 a[108:109], v8 offset:26624
    v_mfma_f32_16x16x32_bf16 v[132:135], a[92:95], a[20:23], v[132:135]
    ds_read_b64_tr_b16 a[110:111], v8 offset:27648
    v_mfma_f32_16x16x32_bf16 v[136:139], a[92:95], a[24:27], v[136:139]
    s_add_u32 m0, s31, 24576
    s_nop 0
    buffer_load_dwordx4 v7, s[16:19], s30 offen lds
    buffer_load_dwordx4 a[12:15], v5, s[8:11], s26 offen sc1
    v_mfma_f32_16x16x32_bf16 v[140:143], a[92:95], a[28:31], v[140:143]
    s_waitcnt lgkmcnt(6)
    v_mfma_f32_16x16x32_bf16 v[144:147], a[96:99], a[16:19], v[144:147]
    ds_read_b64_tr_b16 a[112:113], v9 offset:26624
    v_mfma_f32_16x16x32_bf16 v[148:151], a[96:99], a[20:23], v[148:151]
    ds_read_b64_tr_b16 a[114:115], v9 offset:27648
    v_mfma_f32_16x16x32_bf16 v[152:155], a[96:99], a[24:27], v[152:155]
    s_add_u32 s27, s27, 458752
    s_add_u32 s28, s28, 393216
    s_add_u32 s29, s29, 393216
    s_add_u32 s30, s30, 393216
    s_add_u32 s31, s31, 28672
    s_cmp_ge_u32 s31, 143360
    s_cselect_b32 s34, 143360, 0
    s_sub_u32 s31, s31, s34
    s_add_u32 s26, s26, 1024
    v_mfma_f32_16x16x32_bf16 v[156:159], a[96:99], a[28:31], v[156:159]
    s_barrier
    v_add_u32 v8, s32, v10
    v_add_u32 v9, s32, v11
    s_waitcnt lgkmcnt(6)
    v_mfma_f32_16x16x32_bf16 v[160:163], a[100:103], a[16:19], v[160:163]
    ds_read_b64_tr_b16 a[64:65], v8 offset:0
    v_mfma_f32_16x16x32_bf16 v[164:167], a[100:103], a[20:23], v[164:167]
    ds_read_b64_tr_b16 a[66:67], v8 offset:1024
    v_mfma_f32_16x16x32_bf16 v[168:171], a[100:103], a[24:27], v[168:171]
    buffer_load_dwordx4 a[240:243], v1, s[72:75], s80 offen
    s_add_u32 s80, s80, s90
    v_mfma_f32_16x16x32_bf16 v[172:175], a[100:103], a[28:31], v[172:175]
    s_waitcnt lgkmcnt(6)
    v_mfma_f32_16x16x32_bf16 v[176:179], a[104:107], a[16:19], v[176:179]
    ds_read_b64_tr_b16 a[68:69], v9 offset:0
    v_mfma_f32_16x16x32_bf16 v[180:183], a[104:107], a[20:23], v[180:183]
    ds_read_b64_tr_b16 a[70:71], v9 offset:1024
    v_mfma_f32_16x16x32_bf16 v[184:187], a[104:107], a[24:27], v[184:187]
    v_mfma_f32_16x16x32_bf16 v[188:191], a[104:107], a[28:31], v[188:191]
    s_waitcnt lgkmcnt(6)
    v_mfma_f32_16x16x32_bf16 v[192:195], a[16:19], a[108:111], v[192:195]
    ds_read_b64_tr_b16 a[72:73], v8 offset:4096
    v_mfma_f32_16x16x32_bf16 v[196:199], a[20:23], a[108:111], v[196:199]
    ds_read_b64_tr_b16 a[74:75], v8 offset:5120
    v_mfma_f32_16x16x32_bf16 v[200:203], a[24:27], a[108:111], v[200:203]
    v_mfma_f32_16x16x32_bf16 v[204:207], a[28:31], a[108:111], v[204:207]
    s_waitcnt lgkmcnt(6)
    v_mfma_f32_16x16x32_bf16 v[208:211], a[16:19], a[112:115], v[208:211]
    ds_read_b64_tr_b16 a[76:77], v9 offset:4096
    v_mfma_f32_16x16x32_bf16 v[212:215], a[20:23], a[112:115], v[212:215]
    ds_read_b64_tr_b16 a[78:79], v9 offset:5120
    v_mfma_f32_16x16x32_bf16 v[216:219], a[24:27], a[112:115], v[216:219]
    v_mfma_f32_16x16x32_bf16 v[220:223], a[28:31], a[112:115], v[220:223]
    s_waitcnt vmcnt(17)
    s_waitcnt lgkmcnt(6)
    v_mfma_f32_16x16x32_bf16 v[16:19], a[64:67], a[32:35], v[16:19]
    ds_read_b64_tr_b16 a[80:81], v8 offset:8192
    v_mfma_f32_16x16x32_bf16 v[20:23], a[64:67], a[36:39], v[20:23]
    ds_read_b64_tr_b16 a[82:83], v8 offset:9216
    v_mfma_f32_16x16x32_bf16 v[24:27], a[64:67], a[40:43], v[24:27]
    v_mfma_f32_16x16x32_bf16 v[28:31], a[64:67], a[44:47], v[28:31]
    s_waitcnt lgkmcnt(6)
    v_mfma_f32_16x16x32_bf16 v[32:35], a[68:71], a[32:35], v[32:35]
    ds_read_b64_tr_b16 a[84:85], v9 offset:8192
    v_mfma_f32_16x16x32_bf16 v[36:39], a[68:71], a[36:39], v[36:39]
    ds_read_b64_tr_b16 a[86:87], v9 offset:9216
    v_mfma_f32_16x16x32_bf16 v[40:43], a[68:71], a[40:43], v[40:43]
    buffer_load_dwordx4 a[16:19], v2, s[8:11], s26 offen sc1
    v_mfma_f32_16x16x32_bf16 v[44:47], a[68:71], a[44:47], v[44:47]
    s_waitcnt lgkmcnt(6)
    v_mfma_f32_16x16x32_bf16 v[48:51], a[72:75], a[32:35], v[48:51]
    ds_read_b64_tr_b16 a[88:89], v8 offset:12288
    v_mfma_f32_16x16x32_bf16 v[52:55], a[72:75], a[36:39], v[52:55]
    ds_read_b64_tr_b16 a[90:91], v8 offset:13312
    v_mfma_f32_16x16x32_bf16 v[56:59], a[72:75], a[40:43], v[56:59]
    s_add_u32 m0, s31, 0
    s_nop 0
    buffer_load_dwordx4 v6, s[12:15], s27 offen offset:0 lds
    v_mfma_f32_16x16x32_bf16 v[60:63], a[72:75], a[44:47], v[60:63]
    s_waitcnt lgkmcnt(6)
    v_mfma_f32_16x16x32_bf16 v[64:67], a[76:79], a[32:35], v[64:67]
    ds_read_b64_tr_b16 a[92:93], v8 offset:16384
    v_mfma_f32_16x16x32_bf16 v[68:71], a[76:79], a[36:39], v[68:71]
    ds_read_b64_tr_b16 a[94:95], v8 offset:17408
    v_mfma_f32_16x16x32_bf16 v[72:75], a[76:79], a[40:43], v[72:75]
    buffer_load_dwordx4 a[20:23], v3, s[8:11], s26 offen sc1
    v_mfma_f32_16x16x32_bf16 v[76:79], a[76:79], a[44:47], v[76:79]
    s_waitcnt lgkmcnt(6)
    v_mfma_f32_16x16x32_bf16 v[80:83], a[80:83], a[32:35], v[80:83]
    ds_read_b64_tr_b16 a[96:97], v9 offset:16384
    v_mfma_f32_16x16x32_bf16 v[84:87], a[80:83], a[36:39], v[84:87]
    ds_read_b64_tr_b16 a[98:99], v9 offset:17408
    v_mfma_f32_16x16x32_bf16 v[88:91], a[80:83], a[40:43], v[88:91]
    v_mfma_f32_16x16x32_bf16 v[92:95], a[80:83], a[44:47], v[92:95]
    s_waitcnt lgkmcnt(6)
    v_mfma_f32_16x16x32_bf16 v[96:99], a[84:87], a[32:35], v[96:99]
    ds_read_b64_tr_b16 a[100:101], v8 offset:20480
    v_mfma_f32_16x16x32_bf16 v[100:103], a[84:87], a[36:39], v[100:103]
    ds_read_b64_tr_b16 a[102:103], v8 offset:21504
    v_mfma_f32_16x16x32_bf16 v[104:107], a[84:87], a[40:43], v[104:107]
    s_add_u32 m0, s31, 4032
    s_nop 0
    buffer_load_dwordx4 v6, s[12:15], s27 offen offset:64 lds
    buffer_load_dwordx4 a[24:27], v4, s[8:11], s26 offen sc1
    v_mfma_f32_16x16x32_bf16 v[108:111], a[84:87], a[44:47], v[108:111]
    s_waitcnt lgkmcnt(6)
    v_mfma_f32_16x16x32_bf16 v[112:115], a[88:91], a[32:35], v[112:115]
    ds_read_b64_tr_b16 a[104:105], v9 offset:20480
    v_mfma_f32_16x16x32_bf16 v[116:119], a[88:91], a[36:39], v[116:119]
    ds_read_b64_tr_b16 a[106:107], v9 offset:21504
    v_mfma_f32_16x16x32_bf16 v[120:123], a[88:91], a[40:43], v[120:123]
    v_mfma_f32_16x16x32_bf16 v[124:127], a[88:91], a[44:47], v[124:127]
    s_waitcnt lgkmcnt(6)
    v_mfma_f32_16x16x32_bf16 v[128:131], a[92:95], a[32:35], v[128:131]
    ds_read_b64_tr_b16 a[108:109], v8 offset:24576
    v_mfma_f32_16x16x32_bf16 v[132:135], a[92:95], a[36:39], v[132:135]
    ds_read_b64_tr_b16 a[110:111], v8 offset:25600
    v_mfma_f32_16x16x32_bf16 v[136:139], a[92:95], a[40:43], v[136:139]
    buffer_load_dwordx4 a[28:31], v5, s[8:11], s26 offen sc1
    v_mfma_f32_16x16x32_bf16 v[140:143], a[92:95], a[44:47], v[140:143]
    s_waitcnt lgkmcnt(6)
    v_mfma_f32_16x16x32_bf16 v[144:147], a[96:99], a[32:35], v[144:147]
    ds_read_b64_tr_b16 a[112:113], v9 offset:24576
    v_mfma_f32_16x16x32_bf16 v[148:151], a[96:99], a[36:39], v[148:151]
    ds_read_b64_tr_b16 a[114:115], v9 offset:25600
    v_mfma_f32_16x16x32_bf16 v[152:155], a[96:99], a[40:43], v[152:155]
    s_add_u32 m0, s31, 8064
    s_nop 0
    buffer_load_dwordx4 v6, s[12:15], s27 offen offset:128 lds
    s_add_u32 s26, s26, 1024
    v_mfma_f32_16x16x32_bf16 v[156:159], a[96:99], a[44:47], v[156:159]
    s_waitcnt lgkmcnt(6)
    v_mfma_f32_16x16x32_bf16 v[160:163], a[100:103], a[32:35], v[160:163]
    ds_read_b64_tr_b16 a[64:65], v8 offset:2048
    v_mfma_f32_16x16x32_bf16 v[164:167], a[100:103], a[36:39], v[164:167]
    ds_read_b64_tr_b16 a[66:67], v8 offset:3072
    v_mfma_f32_16x16x32_bf16 v[168:171], a[100:103], a[40:43], v[168:171]
    v_mfma_f32_16x16x32_bf16 v[172:175], a[100:103], a[44:47], v[172:175]
    s_waitcnt lgkmcnt(6)
    v_mfma_f32_16x16x32_bf16 v[176:179], a[104:107], a[32:35], v[176:179]
    ds_read_b64_tr_b16 a[68:69], v9 offset:2048
    v_mfma_f32_16x16x32_bf16 v[180:183], a[104:107], a[36:39], v[180:183]
    ds_read_b64_tr_b16 a[70:71], v9 offset:3072
    v_mfma_f32_16x16x32_bf16 v[184:187], a[104:107], a[40:43], v[184:187]
    v_mfma_f32_16x16x32_bf16 v[188:191], a[104:107], a[44:47], v[188:191]
    s_waitcnt lgkmcnt(6)
    v_mfma_f32_16x16x32_bf16 v[192:195], a[32:35], a[108:111], v[192:195]
    ds_read_b64_tr_b16 a[72:73], v8 offset:6144
    v_mfma_f32_16x16x32_bf16 v[196:199], a[36:39], a[108:111], v[196:199]
    ds_read_b64_tr_b16 a[74:75], v8 offset:7168
    v_mfma_f32_16x16x32_bf16 v[200:203], a[40:43], a[108:111], v[200:203]
    s_add_u32 m0, s31, 12096
    s_nop 0
    buffer_load_dwordx4 v6, s[12:15], s27 offen offset:192 lds
    v_mfma_f32_16x16x32_bf16 v[204:207], a[44:47], a[108:111], v[204:207]
    s_waitcnt lgkmcnt(6)
    v_mfma_f32_16x16x32_bf16 v[208:211], a[32:35], a[112:115], v[208:211]
    ds_read_b64_tr_b16 a[76:77], v9 offset:6144
    v_mfma_f32_16x16x32_bf16 v[212:215], a[36:39], a[112:115], v[212:215]
    ds_read_b64_tr_b16 a[78:79], v9 offset:7168
    v_mfma_f32_16x16x32_bf16 v[216:219], a[40:43], a[112:115], v[216:219]
    v_mfma_f32_16x16x32_bf16 v[220:223], a[44:47], a[112:115], v[220:223]
    s_waitcnt vmcnt(18)
    s_waitcnt lgkmcnt(6)
    v_mfma_f32_16x16x32_bf16 v[16:19], a[64:67], a[48:51], v[16:19]
    ds_read_b64_tr_b16 a[80:81], v8 offset:10240
    v_mfma_f32_16x16x32_bf16 v[20:23], a[64:67], a[52:55], v[20:23]
    ds_read_b64_tr_b16 a[82:83], v8 offset:11264
    v_mfma_f32_16x16x32_bf16 v[24:27], a[64:67], a[56:59], v[24:27]
    v_mfma_f32_16x16x32_bf16 v[28:31], a[64:67], a[60:63], v[28:31]
    s_waitcnt lgkmcnt(6)
    v_mfma_f32_16x16x32_bf16 v[32:35], a[68:71], a[48:51], v[32:35]
    ds_read_b64_tr_b16 a[84:85], v9 offset:10240
    v_mfma_f32_16x16x32_bf16 v[36:39], a[68:71], a[52:55], v[36:39]
    ds_read_b64_tr_b16 a[86:87], v9 offset:11264
    v_mfma_f32_16x16x32_bf16 v[40:43], a[68:71], a[56:59], v[40:43]
    s_add_u32 m0, s31, 16384
    s_nop 0
    buffer_load_dwordx4 v7, s[16:19], s28 offen lds
    buffer_load_dwordx4 a[32:35], v2, s[8:11], s26 offen sc1
    v_mfma_f32_16x16x32_bf16 v[44:47], a[68:71], a[60:63], v[44:47]
    s_waitcnt lgkmcnt(6)
    v_mfma_f32_16x16x32_bf16 v[48:51], a[72:75], a[48:51], v[48:51]
    ds_read_b64_tr_b16 a[88:89], v8 offset:14336
    v_mfma_f32_16x16x32_bf16 v[52:55], a[72:75], a[52:55], v[52:55]
    ds_read_b64_tr_b16 a[90:91], v8 offset:15360
    v_mfma_f32_16x16x32_bf16 v[56:59], a[72:75], a[56:59], v[56:59]
    v_mfma_f32_16x16x32_bf16 v[60:63], a[72:75], a[60:63], v[60:63]
    s_waitcnt lgkmcnt(6)
    v_mfma_f32_16x16x32_bf16 v[64:67], a[76:79], a[48:51], v[64:67]
    ds_read_b64_tr_b16 a[92:93], v8 offset:18432
    v_mfma_f32_16x16x32_bf16 v[68:71], a[76:79], a[52:55], v[68:71]
    ds_read_b64_tr_b16 a[94:95], v8 offset:19456
    v_mfma_f32_16x16x32_bf16 v[72:75], a[76:79], a[56:59], v[72:75]
    buffer_load_dwordx4 a[36:39], v3, s[8:11], s26 offen sc1
    v_mfma_f32_16x16x32_bf16 v[76:79], a[76:79], a[60:63], v[76:79]
    s_waitcnt lgkmcnt(6)
    v_mfma_f32_16x16x32_bf16 v[80:83], a[80:83], a[48:51], v[80:83]
    ds_read_b64_tr_b16 a[96:97], v9 offset:18432
    v_mfma_f32_16x16x32_bf16 v[84:87], a[80:83], a[52:55], v[84:87]
    ds_read_b64_tr_b16 a[98:99], v9 offset:19456
    v_mfma_f32_16x16x32_bf16 v[88:91], a[80:83], a[56:59], v[88:91]
    s_add_u32 m0, s31, 20480
    s_nop 0
    buffer_load_dwordx4 v7, s[16:19], s29 offen lds
    v_mfma_f32_16x16x32_bf16 v[92:95], a[80:83], a[60:63], v[92:95]
    s_waitcnt lgkmcnt(6)
    v_mfma_f32_16x16x32_bf16 v[96:99], a[84:87], a[48:51], v[96:99]
    ds_read_b64_tr_b16 a[100:101], v8 offset:22528
    v_mfma_f32_16x16x32_bf16 v[100:103], a[84:87], a[52:55], v[100:103]
    ds_read_b64_tr_b16 a[102:103], v8 offset:23552
    v_mfma_f32_16x16x32_bf16 v[104:107], a[84:87], a[56:59], v[104:107]
    buffer_load_dwordx4 a[40:43], v4, s[8:11], s26 offen sc1
    v_mfma_f32_16x16x32_bf16 v[108:111], a[84:87], a[60:63], v[108:111]
    s_waitcnt lgkmcnt(6)
    v_mfma_f32_16x16x32_bf16 v[112:115], a[88:91], a[48:51], v[112:115]
    ds_read_b64_tr_b16 a[104:105], v9 offset:22528
    v_mfma_f32_16x16x32_bf16 v[116:119], a[88:91], a[52:55], v[116:119]
    ds_read_b64_tr_b16 a[106:107], v9 offset:23552
    v_mfma_f32_16x16x32_bf16 v[120:123], a[88:91], a[56:59], v[120:123]
    v_mfma_f32_16x16x32_bf16 v[124:127], a[88:91], a[60:63], v[124:127]
    s_add_u32 s32, s32, 28672
    s_cmp_ge_u32 s32, 143360
    s_cselect_b32 s34, 143360, 0
    s_sub_u32 s32, s32, s34
    s_waitcnt lgkmcnt(6)
    v_mfma_f32_16x16x32_bf16 v[128:131], a[92:95], a[48:51], v[128:131]
    ds_read_b64_tr_b16 a[108:109], v8 offset:26624
    v_mfma_f32_16x16x32_bf16 v[132:135], a[92:95], a[52:55], v[132:135]
    ds_read_b64_tr_b16 a[110:111], v8 offset:27648
    v_mfma_f32_16x16x32_bf16 v[136:139], a[92:95], a[56:59], v[136:139]
    s_add_u32 m0, s31, 24576
    s_nop 0
    buffer_load_dwordx4 v7, s[16:19], s30 offen lds
    buffer_load_dwordx4 a[44:47], v5, s[8:11], s26 offen sc1
    v_mfma_f32_16x16x32_bf16 v[140:143], a[92:95], a[60:63], v[140:143]
    s_waitcnt lgkmcnt(6)
    v_mfma_f32_16x16x32_bf16 v[144:147], a[96:99], a[48:51], v[144:147]
    ds_read_b64_tr_b16 a[112:113], v9 offset:26624
    v_mfma_f32_16x16x32_bf16 v[148:151], a[96:99], a[52:55], v[148:151]
    ds_read_b64_tr_b16 a[114:115], v9 offset:27648
    v_mfma_f32_16x16x32_bf16 v[152:155], a[96:99], a[56:59], v[152:155]
    s_add_u32 s27, s27, 458752
    s_add_u32 s28, s28, 393216
    s_add_u32 s29, s29, 393216
    s_add_u32 s30, s30, 393216
    s_add_u32 s31, s31, 28672
    s_cmp_ge_u32 s31, 143360
    s_cselect_b32 s34, 143360, 0
    s_sub_u32 s31, s31, s34
    s_add_u32 s26, s26, 1024
    v_mfma_f32_16x16x32_bf16 v[156:159], a[96:99], a[60:63], v[156:159]
    s_barrier
    v_add_u32 v8, s32, v10
    v_add_u32 v9, s32, v11
    s_waitcnt lgkmcnt(6)
    v_mfma_f32_16x16x32_bf16 v[160:163], a[100:103], a[48:51], v[160:163]
    ds_read_b64_tr_b16 a[64:65], v8 offset:0
    v_mfma_f32_16x16x32_bf16 v[164:167], a[100:103], a[52:55], v[164:167]
    ds_read_b64_tr_b16 a[66:67], v8 offset:1024
    v_mfma_f32_16x16x32_bf16 v[168:171], a[100:103], a[56:59], v[168:171]
    buffer_load_dwordx4 a[240:243], v1, s[72:75], s80 offen
    s_add_u32 s80, s80, s90
    v_mfma_f32_16x16x32_bf16 v[172:175], a[100:103], a[60:63], v[172:175]
    s_waitcnt lgkmcnt(6)
    v_mfma_f32_16x16x32_bf16 v[176:179], a[104:107], a[48:51], v[176:179]
    ds_read_b64_tr_b16 a[68:69], v9 offset:0
    v_mfma_f32_16x16x32_bf16 v[180:183], a[104:107], a[52:55], v[180:183]
    ds_read_b64_tr_b16 a[70:71], v9 offset:1024
    v_mfma_f32_16x16x32_bf16 v[184:187], a[104:107], a[56:59], v[184:187]
    s_cmp_eq_u32 s33, 1
    s_cselect_b32 s72, s20, s72
    s_cselect_b32 s73, s21, s73
    s_cselect_b32 s74, 7340032, s74
    s_cselect_b32 s80, s65, s80
    s_cselect_b32 s90, 1024, s90
    v_mfma_f32_16x16x32_bf16 v[188:191], a[104:107], a[60:63], v[188:191]
    s_waitcnt lgkmcnt(6)
    v_mfma_f32_16x16x32_bf16 v[192:195], a[48:51], a[108:111], v[192:195]
    ds_read_b64_tr_b16 a[72:73], v8 offset:4096
    v_mfma_f32_16x16x32_bf16 v[196:199], a[52:55], a[108:111], v[196:199]
    ds_read_b64_tr_b16 a[74:75], v8 offset:5120
    v_mfma_f32_16x16x32_bf16 v[200:203], a[56:59], a[108:111], v[200:203]
    v_mfma_f32_16x16x32_bf16 v[204:207], a[60:63], a[108:111], v[204:207]
    s_waitcnt lgkmcnt(6)
    v_mfma_f32_16x16x32_bf16 v[208:211], a[48:51], a[112:115], v[208:211]
    ds_read_b64_tr_b16 a[76:77], v9 offset:4096
    v_mfma_f32_16x16x32_bf16 v[212:215], a[52:55], a[112:115], v[212:215]
    ds_read_b64_tr_b16 a[78:79], v9 offset:5120
    v_mfma_f32_16x16x32_bf16 v[216:219], a[56:59], a[112:115], v[216:219]
    v_mfma_f32_16x16x32_bf16 v[220:223], a[60:63], a[112:115], v[220:223]
    s_sub_u32 s33, s33, 1
    s_cmp_lg_u32 s33, 0
    s_cbranch_scc1 L_G1_loop
    s_waitcnt vmcnt(17)
    s_waitcnt lgkmcnt(6)
    v_mfma_f32_16x16x32_bf16 v[16:19], a[64:67], a[0:3], v[16:19]
    ds_read_b64_tr_b16 a[80:81], v8 offset:8192
    v_mfma_f32_16x16x32_bf16 v[20:23], a[64:67], a[4:7], v[20:23]
    ds_read_b64_tr_b16 a[82:83], v8 offset:9216
    v_mfma_f32_16x16x32_bf16 v[24:27], a[64:67], a[8:11], v[24:27]
    v_mfma_f32_16x16x32_bf16 v[28:31], a[64:67], a[12:15], v[28:31]
    s_waitcnt lgkmcnt(6)
    v_mfma_f32_16x16x32_bf16 v[32:35], a[68:71], a[0:3], v[32:35]
    ds_read_b64_tr_b16 a[84:85], v9 offset:8192
    v_mfma_f32_16x16x32_bf16 v[36:39], a[68:71], a[4:7], v[36:39]
    ds_read_b64_tr_b16 a[86:87], v9 offset:9216
    v_mfma_f32_16x16x32_bf16 v[40:43], a[68:71], a[8:11], v[40:43]
    buffer_load_dwordx4 a[48:51], v2, s[8:11], s26 offen sc1
    v_mfma_f32_16x16x32_bf16 v[44:47], a[68:71], a[12:15], v[44:47]
    s_waitcnt lgkmcnt(6)
    v_mfma_f32_16x16x32_bf16 v[48:51], a[72:75], a[0:3], v[48:51]
    ds_read_b64_tr_b16 a[88:89], v8 offset:12288
    v_mfma_f32_16x16x32_bf16 v[52:55], a[72:75], a[4:7], v[52:55]
    ds_read_b64_tr_b16 a[90:91], v8 offset:13312
    v_mfma_f32_16x16x32_bf16 v[56:59], a[72:75], a[8:11], v[56:59]
    s_add_u32 m0, s31, 0
    s_nop 0
    buffer_load_dwordx4 v6, s[12:15], s27 offen offset:0 lds
    v_mfma_f32_16x16x32_bf16 v[60:63], a[72:75], a[12:15], v[60:63]
    s_waitcnt lgkmcnt(6)
    v_mfma_f32_16x16x32_bf16 v[64:67], a[76:79], a[0:3], v[64:67]
    ds_read_b64_tr_b16 a[92:93], v8 offset:16384
    v_mfma_f32_16x16x32_bf16 v[68:71], a[76:79], a[4:7], v[68:71]
    ds_read_b64_tr_b16 a[94:95], v8 offset:17408
    v_mfma_f32_16x16x32_bf16 v[72:75], a[76:79], a[8:11], v[72:75]
    buffer_load_dwordx4 a[52:55], v3, s[8:11], s26 offen sc1
    v_mfma_f32_16x16x32_bf16 v[76:79], a[76:79], a[12:15], v[76:79]
    s_waitcnt lgkmcnt(6)
    v_mfma_f32_16x16x32_bf16 v[80:83], a[80:83], a[0:3], v[80:83]
    ds_read_b64_tr_b16 a[96:97], v9 offset:16384
    v_mfma_f32_16x16x32_bf16 v[84:87], a[80:83], a[4:7], v[84:87]
    ds_read_b64_tr_b16 a[98:99], v9 offset:17408
    v_mfma_f32_16x16x32_bf16 v[88:91], a[80:83], a[8:11], v[88:91]
    v_mfma_f32_16x16x32_bf16 v[92:95], a[80:83], a[12:15], v[92:95]
    s_waitcnt lgkmcnt(6)
    v_mfma_f32_16x16x32_bf16 v[96:99], a[84:87], a[0:3], v[96:99]
    ds_read_b64_tr_b16 a[100:101], v8 offset:20480
    v_mfma_f32_16x16x32_bf16 v[100:103], a[84:87], a[4:7], v[100:103]
    ds_read_b64_tr_b16 a[102:103], v8 offset:21504
    v_mfma_f32_16x16x32_bf16 v[104:107], a[84:87], a[8:11], v[104:107]
    s_add_u32 m0, s31, 4032
    s_nop 0
    buffer_load_dwordx4 v6, s[12:15], s27 offen offset:64 lds
    buffer_load_dwordx4 a[56:59], v4, s[8:11], s26 offen sc1
    v_mfma_f32_16x16x32_bf16 v[108:111], a[84:87], a[12:15], v[108:111]
    s_waitcnt lgkmcnt(6)
    v_mfma_f32_16x16x32_bf16 v[112:115], a[88:91], a[0:3], v[112:115]
    ds_read_b64_tr_b16 a[104:105], v9 offset:20480
    v_mfma_f32_16x16x32_bf16 v[116:119], a[88:91], a[4:7], v[116:119]
    ds_read_b64_tr_b16 a[106:107], v9 offset:21504
    v_mfma_f32_16x16x32_bf16 v[120:123], a[88:91], a[8:11], v[120:123]
    v_mfma_f32_16x16x32_bf16 v[124:127], a[88:91], a[12:15], v[124:127]
    s_waitcnt lgkmcnt(6)
    v_mfma_f32_16x16x32_bf16 v[128:131], a[92:95], a[0:3], v[128:131]
    ds_read_b64_tr_b16 a[108:109], v8 offset:24576
    v_mfma_f32_16x16x32_bf16 v[132:135], a[92:95], a[4:7], v[132:135]
    ds_read_b64_tr_b16 a[110:111], v8 offset:25600
    v_mfma_f32_16x16x32_bf16 v[136:139], a[92:95], a[8:11], v[136:139]
    buffer_load_dwordx4 a[60:63], v5, s[8:11], s26 offen sc1
    v_mfma_f32_16x16x32_bf16 v[140:143], a[92:95], a[12:15], v[140:143]
    s_waitcnt lgkmcnt(6)
    v_mfma_f32_16x16x32_bf16 v[144:147], a[96:99], a[0:3], v[144:147]
    ds_read_b64_tr_b16 a[112:113], v9 offset:24576
    v_mfma_f32_16x16x32_bf16 v[148:151], a[96:99], a[4:7], v[148:151]
    ds_read_b64_tr_b16 a[114:115], v9 offset:25600
    v_mfma_f32_16x16x32_bf16 v[152:155], a[96:99], a[8:11], v[152:155]
    s_add_u32 m0, s31, 8064
    s_nop 0
    buffer_load_dwordx4 v6, s[12:15], s27 offen offset:128 lds
    s_add_u32 s26, s26, 1024
    v_mfma_f32_16x16x32_bf16 v[156:159], a[96:99], a[12:15], v[156:159]
    s_waitcnt lgkmcnt(6)
    v_mfma_f32_16x16x32_bf16 v[160:163], a[100:103], a[0:3], v[160:163]
    ds_read_b64_tr_b16 a[64:65], v8 offset:2048
    v_mfma_f32_16x16x32_bf16 v[164:167], a[100:103], a[4:7], v[164:167]
    ds_read_b64_tr_b16 a[66:67], v8 offset:3072
    v_mfma_f32_16x16x32_bf16 v[168:171], a[100:103], a[8:11], v[168:171]
    v_mfma_f32_16x16x32_bf16 v[172:175], a[100:103], a[12:15], v[172:175]
    s_waitcnt lgkmcnt(6)
    v_mfma_f32_16x16x32_bf16 v[176:179], a[104:107], a[0:3], v[176:179]
    ds_read_b64_tr_b16 a[68:69], v9 offset:2048
    v_mfma_f32_16x16x32_bf16 v[180:183], a[104:107], a[4:7], v[180:183]
    ds_read_b64_tr_b16 a[70:71], v9 offset:3072
    v_mfma_f32_16x16x32_bf16 v[184:187], a[104:107], a[8:11], v[184:187]
    v_mfma_f32_16x16x32_bf16 v[188:191], a[104:107], a[12:15], v[188:191]
    s_waitcnt lgkmcnt(6)
    v_mfma_f32_16x16x32_bf16 v[192:195], a[0:3], a[108:111], v[192:195]
    ds_read_b64_tr_b16 a[72:73], v8 offset:6144
    v_mfma_f32_16x16x32_bf16 v[196:199], a[4:7], a[108:111], v[196:199]
    ds_read_b64_tr_b16 a[74:75], v8 offset:7168
    v_mfma_f32_16x16x32_bf16 v[200:203], a[8:11], a[108:111], v[200:203]
    s_add_u32 m0, s31, 12096
    s_nop 0
    buffer_load_dwordx4 v6, s[12:15], s27 offen offset:192 lds
    v_mfma_f32_16x16x32_bf16 v[204:207], a[12:15], a[108:111], v[204:207]
    s_waitcnt lgkmcnt(6)
    v_mfma_f32_16x16x32_bf16 v[208:211], a[0:3], a[112:115], v[208:211]
    ds_read_b64_tr_b16 a[76:77], v9 offset:6144
    v_mfma_f32_16x16x32_bf16 v[212:215], a[4:7], a[112:115], v[212:215]
    ds_read_b64_tr_b16 a[78:79], v9 offset:7168
    v_mfma_f32_16x16x32_bf16 v[216:219], a[8:11], a[112:115], v[216:219]
    v_mfma_f32_16x16x32_bf16 v[220:223], a[12:15], a[112:115], v[220:223]
    s_waitcnt vmcnt(18)
    s_waitcnt lgkmcnt(6)
    v_mfma_f32_16x16x32_bf16 v[16:19], a[64:67], a[16:19], v[16:19]
    ds_read_b64_tr_b16 a[80:81], v8 offset:10240
    v_mfma_f32_16x16x32_bf16 v[20:23], a[64:67], a[20:23], v[20:23]
    ds_read_b64_tr_b16 a[82:83], v8 offset:11264
    v_mfma_f32_16x16x32_bf16 v[24:27], a[64:67], a[24:27], v[24:27]
    v_mfma_f32_16x16x32_bf16 v[28:31], a[64:67], a[28:31], v[28:31]
    s_waitcnt lgkmcnt(6)
    v_mfma_f32_16x16x32_bf16 v[32:35], a[68:71], a[16:19], v[32:35]
    ds_read_b64_tr_b16 a[84:85], v9 offset:10240
    v_mfma_f32_16x16x32_bf16 v[36:39], a[68:71], a[20:23], v[36:39]
    ds_read_b64_tr_b16 a[86:87], v9 offset:11264
    v_mfma_f32_16x16x32_bf16 v[40:43], a[68:71], a[24:27], v[40:43]
    s_add_u32 m0, s31, 16384
    s_nop 0
    buffer_load_dwordx4 v7, s[16:19], s28 offen lds
    buffer_load_dwordx4 a[0:3], v2, s[8:11], s26 offen sc1
    v_mfma_f32_16x16x32_bf16 v[44:47], a[68:71], a[28:31], v[44:47]
    s_waitcnt lgkmcnt(6)
    v_mfma_f32_16x16x32_bf16 v[48:51], a[72:75], a[16:19], v[48:51]
    ds_read_b64_tr_b16 a[88:89], v8 offset:14336
    v_mfma_f32_16x16x32_bf16 v[52:55], a[72:75], a[20:23], v[52:55]
    ds_read_b64_tr_b16 a[90:91], v8 offset:15360
    v_mfma_f32_16x16x32_bf16 v[56:59], a[72:75], a[24:27], v[56:59]
    v_mfma_f32_16x16x32_bf16 v[60:63], a[72:75], a[28:31], v[60:63]
    s_waitcnt lgkmcnt(6)
    v_mfma_f32_16x16x32_bf16 v[64:67], a[76:79], a[16:19], v[64:67]
    ds_read_b64_tr_b16 a[92:93], v8 offset:18432
    v_mfma_f32_16x16x32_bf16 v[68:71], a[76:79], a[20:23], v[68:71]
    ds_read_b64_tr_b16 a[94:95], v8 offset:19456
    v_mfma_f32_16x16x32_bf16 v[72:75], a[76:79], a[24:27], v[72:75]
    buffer_load_dwordx4 a[4:7], v3, s[8:11], s26 offen sc1
    v_mfma_f32_16x16x32_bf16 v[76:79], a[76:79], a[28:31], v[76:79]
    s_waitcnt lgkmcnt(6)
    v_mfma_f32_16x16x32_bf16 v[80:83], a[80:83], a[16:19], v[80:83]
    ds_read_b64_tr_b16 a[96:97], v9 offset:18432
    v_mfma_f32_16x16x32_bf16 v[84:87], a[80:83], a[20:23], v[84:87]
    ds_read_b64_tr_b16 a[98:99], v9 offset:19456
    v_mfma_f32_16x16x32_bf16 v[88:91], a[80:83], a[24:27], v[88:91]
    s_add_u32 m0, s31, 20480
    s_nop 0
    buffer_load_dwordx4 v7, s[16:19], s29 offen lds
    v_mfma_f32_16x16x32_bf16 v[92:95], a[80:83], a[28:31], v[92:95]
    s_waitcnt lgkmcnt(6)
    v_mfma_f32_16x16x32_bf16 v[96:99], a[84:87], a[16:19], v[96:99]
    ds_read_b64_tr_b16 a[100:101], v8 offset:22528
    v_mfma_f32_16x16x32_bf16 v[100:103], a[84:87], a[20:23], v[100:103]
    ds_read_b64_tr_b16 a[102:103], v8 offset:23552
    v_mfma_f32_16x16x32_bf16 v[104:107], a[84:87], a[24:27], v[104:107]
    buffer_load_dwordx4 a[8:11], v4, s[8:11], s26 offen sc1
    v_mfma_f32_16x16x32_bf16 v[108:111], a[84:87], a[28:31], v[108:111]
    s_waitcnt lgkmcnt(6)
    v_mfma_f32_16x16x32_bf16 v[112:115], a[88:91], a[16:19], v[112:115]
    ds_read_b64_tr_b16 a[104:105], v9 offset:22528
    v_mfma_f32_16x16x32_bf16 v[116:119], a[88:91], a[20:23], v[116:119]
    ds_read_b64_tr_b16 a[106:107], v9 offset:23552
    v_mfma_f32_16x16x32_bf16 v[120:123], a[88:91], a[24:27], v[120:123]
    v_mfma_f32_16x16x32_bf16 v[124:127], a[88:91], a[28:31], v[124:127]
    s_add_u32 s32, s32, 28672
    s_cmp_ge_u32 s32, 143360
    s_cselect_b32 s34, 143360, 0
    s_sub_u32 s32, s32, s34
    s_waitcnt lgkmcnt(6)
    v_mfma_f32_16x16x32_bf16 v[128:131], a[92:95], a[16:19], v[128:131]
    ds_read_b64_tr_b16 a[108:109], v8 offset:26624
    v_mfma_f32_16x16x32_bf16 v[132:135], a[92:95], a[20:23], v[132:135]
L_pad_2:
    s_cbranch_execz L_pad_5
    ds_read_b64_tr_b16 a[110:111], v8 offset:27648
    v_mfma_f32_16x16x32_bf16 v[136:139], a[92:95], a[24:27], v[136:139]
    s_add_u32 m0, s31, 24576
    s_nop 0
    buffer_load_dwordx4 v7, s[16:19], s30 offen lds
    buffer_load_dwordx4 a[12:15], v5, s[8:11], s26 offen sc1
    v_mfma_f32_16x16x32_bf16 v[140:143], a[92:95], a[28:31], v[140:143]
    s_waitcnt lgkmcnt(6)
    v_mfma_f32_16x16x32_bf16 v[144:147], a[96:99], a[16:19], v[144:147]
    ds_read_b64_tr_b16 a[112:113], v9 offset:26624
    v_mfma_f32_16x16x32_bf16 v[148:151], a[96:99], a[20:23], v[148:151]
    ds_read_b64_tr_b16 a[114:115], v9 offset:27648
    v_mfma_f32_16x16x32_bf16 v[152:155], a[96:99], a[24:27], v[152:155]
    s_add_u32 s27, s27, 458752
    s_add_u32 s28, s28, 393216
    s_add_u32 s29, s29, 393216
    s_add_u32 s30, s30, 393216
    s_add_u32 s31, s31, 28672
    s_cmp_ge_u32 s31, 143360
    s_cselect_b32 s34, 143360, 0
    s_sub_u32 s31, s31, s34
    s_add_u32 s26, s26, 1024
    v_mfma_f32_16x16x32_bf16 v[156:159], a[96:99], a[28:31], v[156:159]
    s_barrier
    v_add_u32 v8, s32, v10
    v_add_u32 v9, s32, v11
    s_waitcnt lgkmcnt(6)
    v_mfma_f32_16x16x32_bf16 v[160:163], a[100:103], a[16:19], v[160:163]
    ds_read_b64_tr_b16 a[64:65], v8 offset:0
    v_mfma_f32_16x16x32_bf16 v[164:167], a[100:103], a[20:23], v[164:167]
    ds_read_b64_tr_b16 a[66:67], v8 offset:1024
    v_mfma_f32_16x16x32_bf16 v[168:171], a[100:103], a[24:27], v[168:171]
    buffer_load_dwordx4 a[240:243], v1, s[72:75], s80 offen
    s_add_u32 s80, s80, s90
    v_mfma_f32_16x16x32_bf16 v[172:175], a[100:103], a[28:31], v[172:175]
    s_waitcnt lgkmcnt(6)
    v_mfma_f32_16x16x32_bf16 v[176:179], a[104:107], a[16:19], v[176:179]
    ds_read_b64_tr_b16 a[68:69], v9 offset:0
    v_mfma_f32_16x16x32_bf16 v[180:183], a[104:107], a[20:23], v[180:183]
    ds_read_b64_tr_b16 a[70:71], v9 offset:1024
    v_mfma_f32_16x16x32_bf16 v[184:187], a[104:107], a[24:27], v[184:187]
    v_mfma_f32_16x16x32_bf16 v[188:191], a[104:107], a[28:31], v[188:191]
    s_waitcnt lgkmcnt(6)
    v_mfma_f32_16x16x32_bf16 v[192:195], a[16:19], a[108:111], v[192:195]
    ds_read_b64_tr_b16 a[72:73], v8 offset:4096
    v_mfma_f32_16x16x32_bf16 v[196:199], a[20:23], a[108:111], v[196:199]
    ds_read_b64_tr_b16 a[74:75], v8 offset:5120
    v_mfma_f32_16x16x32_bf16 v[200:203], a[24:27], a[108:111], v[200:203]
    v_mfma_f32_16x16x32_bf16 v[204:207], a[28:31], a[108:111], v[204:207]
    s_waitcnt lgkmcnt(6)
    v_mfma_f32_16x16x32_bf16 v[208:211], a[16:19], a[112:115], v[208:211]
    ds_read_b64_tr_b16 a[76:77], v9 offset:4096
    v_mfma_f32_16x16x32_bf16 v[212:215], a[20:23], a[112:115], v[212:215]
    ds_read_b64_tr_b16 a[78:79], v9 offset:5120
    v_mfma_f32_16x16x32_bf16 v[216:219], a[24:27], a[112:115], v[216:219]
    v_mfma_f32_16x16x32_bf16 v[220:223], a[28:31], a[112:115], v[220:223]
    s_waitcnt vmcnt(17)
    s_waitcnt lgkmcnt(6)
    v_mfma_f32_16x16x32_bf16 v[16:19], a[64:67], a[32:35], v[16:19]
    ds_read_b64_tr_b16 a[80:81], v8 offset:8192
    v_mfma_f32_16x16x32_bf16 v[20:23], a[64:67], a[36:39], v[20:23]
    ds_read_b64_tr_b16 a[82:83], v8 offset:9216
    v_mfma_f32_16x16x32_bf16 v[24:27], a[64:67], a[40:43], v[24:27]
    v_mfma_f32_16x16x32_bf16 v[28:31], a[64:67], a[44:47], v[28:31]
    s_waitcnt lgkmcnt(6)
    v_mfma_f32_16x16x32_bf16 v[32:35], a[68:71], a[32:35], v[32:35]
    ds_read_b64_tr_b16 a[84:85], v9 offset:8192
    v_mfma_f32_16x16x32_bf16 v[36:39], a[68:71], a[36:39], v[36:39]
    ds_read_b64_tr_b16 a[86:87], v9 offset:9216
    v_mfma_f32_16x16x32_bf16 v[40:43], a[68:71], a[40:43], v[40:43]
    buffer_load_dwordx4 a[16:19], v2, s[8:11], s26 offen sc1
    v_mfma_f32_16x16x32_bf16 v[44:47], a[68:71], a[44:47], v[44:47]
    s_waitcnt lgkmcnt(6)
    v_mfma_f32_16x16x32_bf16 v[48:51], a[72:75], a[32:35], v[48:51]
    ds_read_b64_tr_b16 a[88:89], v8 offset:12288
    v_mfma_f32_16x16x32_bf16 v[52:55], a[72:75], a[36:39], v[52:55]
    ds_read_b64_tr_b16 a[90:91], v8 offset:13312
    v_mfma_f32_16x16x32_bf16 v[56:59], a[72:75], a[40:43], v[56:59]
    v_mfma_f32_16x16x32_bf16 v[60:63], a[72:75], a[44:47], v[60:63]
    s_waitcnt lgkmcnt(6)
    v_mfma_f32_16x16x32_bf16 v[64:67], a[76:79], a[32:35], v[64:67]
    ds_read_b64_tr_b16 a[92:93], v8 offset:16384
    v_mfma_f32_16x16x32_bf16 v[68:71], a[76:79], a[36:39], v[68:71]
    ds_read_b64_tr_b16 a[94:95], v8 offset:17408
    v_mfma_f32_16x16x32_bf16 v[72:75], a[76:79], a[40:43], v[72:75]
    buffer_load_dwordx4 a[20:23], v3, s[8:11], s26 offen sc1
    v_mfma_f32_16x16x32_bf16 v[76:79], a[76:79], a[44:47], v[76:79]
    s_waitcnt lgkmcnt(6)
    v_mfma_f32_16x16x32_bf16 v[80:83], a[80:83], a[32:35], v[80:83]
    ds_read_b64_tr_b16 a[96:97], v9 offset:16384
    v_mfma_f32_16x16x32_bf16 v[84:87], a[80:83], a[36:39], v[84:87]
    ds_read_b64_tr_b16 a[98:99], v9 offset:17408
    v_mfma_f32_16x16x32_bf16 v[88:91], a[80:83], a[40:43], v[88:91]
    v_mfma_f32_16x16x32_bf16 v[92:95], a[80:83], a[44:47], v[92:95]
    s_waitcnt lgkmcnt(6)
    v_mfma_f32_16x16x32_bf16 v[96:99], a[84:87], a[32:35], v[96:99]
    ds_read_b64_tr_b16 a[100:101], v8 offset:20480
    v_mfma_f32_16x16x32_bf16 v[100:103], a[84:87], a[36:39], v[100:103]
    ds_read_b64_tr_b16 a[102:103], v8 offset:21504
    v_mfma_f32_16x16x32_bf16 v[104:107], a[84:87], a[40:43], v[104:107]
    buffer_load_dwordx4 a[24:27], v4, s[8:11], s26 offen sc1
    v_mfma_f32_16x16x32_bf16 v[108:111], a[84:87], a[44:47], v[108:111]
    s_waitcnt lgkmcnt(6)
    v_mfma_f32_16x16x32_bf16 v[112:115], a[88:91], a[32:35], v[112:115]
    ds_read_b64_tr_b16 a[104:105], v9 offset:20480
    v_mfma_f32_16x16x32_bf16 v[116:119], a[88:91], a[36:39], v[116:119]
    ds_read_b64_tr_b16 a[106:107], v9 offset:21504
    v_mfma_f32_16x16x32_bf16 v[120:123], a[88:91], a[40:43], v[120:123]
    v_mfma_f32_16x16x32_bf16 v[124:127], a[88:91], a[44:47], v[124:127]
    s_waitcnt lgkmcnt(6)
    v_mfma_f32_16x16x32_bf16 v[128:131], a[92:95], a[32:35], v[128:131]
    ds_read_b64_tr_b16 a[108:109], v8 offset:24576
    v_mfma_f32_16x16x32_bf16 v[132:135], a[92:95], a[36:39], v[132:135]
    ds_read_b64_tr_b16 a[110:111], v8 offset:25600
    v_mfma_f32_16x16x32_bf16 v[136:139], a[92:95], a[40:43], v[136:139]
    buffer_load_dwordx4 a[28:31], v5, s[8:11], s26 offen sc1
    v_mfma_f32_16x16x32_bf16 v[140:143], a[92:95], a[44:47], v[140:143]
    s_waitcnt lgkmcnt(6)
    v_mfma_f32_16x16x32_bf16 v[144:147], a[96:99], a[32:35], v[144:147]
    ds_read_b64_tr_b16 a[112:113], v9 offset:24576
    v_mfma_f32_16x16x32_bf16 v[148:151], a[96:99], a[36:39], v[148:151]
    ds_read_b64_tr_b16 a[114:115], v9 offset:25600
    v_mfma_f32_16x16x32_bf16 v[152:155], a[96:99], a[40:43], v[152:155]
    s_add_u32 s26, s26, 1024
    v_mfma_f32_16x16x32_bf16 v[156:159], a[96:99], a[44:47], v[156:159]
    s_waitcnt lgkmcnt(6)
    v_mfma_f32_16x16x32_bf16 v[160:163], a[100:103], a[32:35], v[160:163]
    ds_read_b64_tr_b16 a[64:65], v8 offset:2048
    v_mfma_f32_16x16x32_bf16 v[164:167], a[100:103], a[36:39], v[164:167]
    ds_read_b64_tr_b16 a[66:67], v8 offset:3072
    v_mfma_f32_16x16x32_bf16 v[168:171], a[100:103], a[40:43], v[168:171]
    v_mfma_f32_16x16x32_bf16 v[172:175], a[100:103], a[44:47], v[172:175]
    s_waitcnt lgkmcnt(6)
    v_mfma_f32_16x16x32_bf16 v[176:179], a[104:107], a[32:35], v[176:179]
    ds_read_b64_tr_b16 a[68:69], v9 offset:2048
    v_mfma_f32_16x16x32_bf16 v[180:183], a[104:107], a[36:39], v[180:183]
    ds_read_b64_tr_b16 a[70:71], v9 offset:3072
    v_mfma_f32_16x16x32_bf16 v[184:187], a[104:107], a[40:43], v[184:187]
    v_mfma_f32_16x16x32_bf16 v[188:191], a[104:107], a[44:47], v[188:191]
    s_waitcnt lgkmcnt(6)
    v_mfma_f32_16x16x32_bf16 v[192:195], a[32:35], a[108:111], v[192:195]
    ds_read_b64_tr_b16 a[72:73], v8 offset:6144
    v_mfma_f32_16x16x32_bf16 v[196:199], a[36:39], a[108:111], v[196:199]
    ds_read_b64_tr_b16 a[74:75], v8 offset:7168
    v_mfma_f32_16x16x32_bf16 v[200:203], a[40:43], a[108:111], v[200:203]
    v_mfma_f32_16x16x32_bf16 v[204:207], a[44:47], a[108:111], v[204:207]
    s_waitcnt lgkmcnt(6)
    v_mfma_f32_16x16x32_bf16 v[208:211], a[32:35], a[112:115], v[208:211]
    ds_read_b64_tr_b16 a[76:77], v9 offset:6144
    v_mfma_f32_16x16x32_bf16 v[212:215], a[36:39], a[112:115], v[212:215]
    ds_read_b64_tr_b16 a[78:79], v9 offset:7168
    v_mfma_f32_16x16x32_bf16 v[216:219], a[40:43], a[112:115], v[216:219]
    v_mfma_f32_16x16x32_bf16 v[220:223], a[44:47], a[112:115], v[220:223]
    s_waitcnt vmcnt(14)
    s_waitcnt lgkmcnt(6)
    v_mfma_f32_16x16x32_bf16 v[16:19], a[64:67], a[48:51], v[16:19]
    ds_read_b64_tr_b16 a[80:81], v8 offset:10240
    v_mfma_f32_16x16x32_bf16 v[20:23], a[64:67], a[52:55], v[20:23]
    ds_read_b64_tr_b16 a[82:83], v8 offset:11264
    v_mfma_f32_16x16x32_bf16 v[24:27], a[64:67], a[56:59], v[24:27]
    v_mfma_f32_16x16x32_bf16 v[28:31], a[64:67], a[60:63], v[28:31]
    s_waitcnt lgkmcnt(6)
    v_mfma_f32_16x16x32_bf16 v[32:35], a[68:71], a[48:51], v[32:35]
    ds_read_b64_tr_b16 a[84:85], v9 offset:10240
    v_mfma_f32_16x16x32_bf16 v[36:39], a[68:71], a[52:55], v[36:39]
    ds_read_b64_tr_b16 a[86:87], v9 offset:11264
    v_mfma_f32_16x16x32_bf16 v[40:43], a[68:71], a[56:59], v[40:43]
    buffer_load_dwordx4 a[32:35], v2, s[8:11], s26 offen sc1
    v_mfma_f32_16x16x32_bf16 v[44:47], a[68:71], a[60:63], v[44:47]
    s_waitcnt lgkmcnt(6)
    v_mfma_f32_16x16x32_bf16 v[48:51], a[72:75], a[48:51], v[48:51]
    ds_read_b64_tr_b16 a[88:89], v8 offset:14336
    v_mfma_f32_16x16x32_bf16 v[52:55], a[72:75], a[52:55], v[52:55]
    ds_read_b64_tr_b16 a[90:91], v8 offset:15360
    v_mfma_f32_16x16x32_bf16 v[56:59], a[72:75], a[56:59], v[56:59]
    v_mfma_f32_16x16x32_bf16 v[60:63], a[72:75], a[60:63], v[60:63]
    s_waitcnt lgkmcnt(6)
    v_mfma_f32_16x16x32_bf16 v[64:67], a[76:79], a[48:51], v[64:67]
    ds_read_b64_tr_b16 a[92:93], v8 offset:18432
    v_mfma_f32_16x16x32_bf16 v[68:71], a[76:79], a[52:55], v[68:71]
    ds_read_b64_tr_b16 a[94:95], v8 offset:19456
    v_mfma_f32_16x16x32_bf16 v[72:75], a[76:79], a[56:59], v[72:75]
    buffer_load_dwordx4 a[36:39], v3, s[8:11], s26 offen sc1
    v_mfma_f32_16x16x32_bf16 v[76:79], a[76:79], a[60:63], v[76:79]
    s_waitcnt lgkmcnt(6)
    v_mfma_f32_16x16x32_bf16 v[80:83], a[80:83], a[48:51], v[80:83]
    ds_read_b64_tr_b16 a[96:97], v9 offset:18432
    v_mfma_f32_16x16x32_bf16 v[84:87], a[80:83], a[52:55], v[84:87]
    ds_read_b64_tr_b16 a[98:99], v9 offset:19456
    v_mfma_f32_16x16x32_bf16 v[88:91], a[80:83], a[56:59], v[88:91]
    v_mfma_f32_16x16x32_bf16 v[92:95], a[80:83], a[60:63], v[92:95]
    s_waitcnt lgkmcnt(6)
    v_mfma_f32_16x16x32_bf16 v[96:99], a[84:87], a[48:51], v[96:99]
    ds_read_b64_tr_b16 a[100:101], v8 offset:22528
    v_mfma_f32_16x16x32_bf16 v[100:103], a[84:87], a[52:55], v[100:103]
    ds_read_b64_tr_b16 a[102:103], v8 offset:23552
    v_mfma_f32_16x16x32_bf16 v[104:107], a[84:87], a[56:59], v[104:107]
    buffer_load_dwordx4 a[40:43], v4, s[8:11], s26 offen sc1
    v_mfma_f32_16x16x32_bf16 v[108:111], a[84:87], a[60:63], v[108:111]
    s_waitcnt lgkmcnt(6)
    v_mfma_f32_16x16x32_bf16 v[112:115], a[88:91], a[48:51], v[112:115]
    ds_read_b64_tr_b16 a[104:105], v9 offset:22528
    v_mfma_f32_16x16x32_bf16 v[116:119], a[88:91], a[52:55], v[116:119]
    ds_read_b64_tr_b16 a[106:107], v9 offset:23552
    v_mfma_f32_16x16x32_bf16 v[120:123], a[88:91], a[56:59], v[120:123]
    v_mfma_f32_16x16x32_bf16 v[124:127], a[88:91], a[60:63], v[124:127]
    s_add_u32 s32, s32, 28672
    s_cmp_ge_u32 s32, 143360
    s_cselect_b32 s34, 143360, 0
    s_sub_u32 s32, s32, s34
    s_waitcnt lgkmcnt(6)
    v_mfma_f32_16x16x32_bf16 v[128:131], a[92:95], a[48:51], v[128:131]
    ds_read_b64_tr_b16 a[108:109], v8 offset:26624
    v_mfma_f32_16x16x32_bf16 v[132:135], a[92:95], a[52:55], v[132:135]
    ds_read_b64_tr_b16 a[110:111], v8 offset:27648
    v_mfma_f32_16x16x32_bf16 v[136:139], a[92:95], a[56:59], v[136:139]
    buffer_load_dwordx4 a[44:47], v5, s[8:11], s26 offen sc1
    v_mfma_f32_16x16x32_bf16 v[140:143], a[92:95], a[60:63], v[140:143]
    s_waitcnt lgkmcnt(6)
    v_mfma_f32_16x16x32_bf16 v[144:147], a[96:99], a[48:51], v[144:147]
    ds_read_b64_tr_b16 a[112:113], v9 offset:26624
    v_mfma_f32_16x16x32_bf16 v[148:151], a[96:99], a[52:55], v[148:151]
    ds_read_b64_tr_b16 a[114:115], v9 offset:27648
    v_mfma_f32_16x16x32_bf16 v[152:155], a[96:99], a[56:59], v[152:155]
    s_add_u32 s26, s26, 1024
    buffer_load_dwordx4 a[116:119], v2, s[8:11], s26 offen sc1
    v_mfma_f32_16x16x32_bf16 v[156:159], a[96:99], a[60:63], v[156:159]
    s_barrier
    v_add_u32 v8, s32, v10
    v_add_u32 v9, s32, v11
    s_waitcnt lgkmcnt(6)
    v_mfma_f32_16x16x32_bf16 v[160:163], a[100:103], a[48:51], v[160:163]
    ds_read_b64_tr_b16 a[92:93], v8 offset:16384
    v_mfma_f32_16x16x32_bf16 v[164:167], a[100:103], a[52:55], v[164:167]
    ds_read_b64_tr_b16 a[94:95], v8 offset:17408
    v_mfma_f32_16x16x32_bf16 v[168:171], a[100:103], a[56:59], v[168:171]
    buffer_load_dwordx4 a[240:243], v1, s[72:75], s80 offen
    s_add_u32 s80, s80, s90
    buffer_load_dwordx4 a[120:123], v3, s[8:11], s26 offen sc1
    v_mfma_f32_16x16x32_bf16 v[172:175], a[100:103], a[60:63], v[172:175]
    s_waitcnt lgkmcnt(6)
    v_mfma_f32_16x16x32_bf16 v[176:179], a[104:107], a[48:51], v[176:179]
    ds_read_b64_tr_b16 a[96:97], v9 offset:16384
    v_mfma_f32_16x16x32_bf16 v[180:183], a[104:107], a[52:55], v[180:183]
    ds_read_b64_tr_b16 a[98:99], v9 offset:17408
    v_mfma_f32_16x16x32_bf16 v[184:187], a[104:107], a[56:59], v[184:187]
    buffer_load_dwordx4 a[124:127], v4, s[8:11], s26 offen sc1
    v_mfma_f32_16x16x32_bf16 v[188:191], a[104:107], a[60:63], v[188:191]
    s_waitcnt lgkmcnt(6)
    v_mfma_f32_16x16x32_bf16 v[192:195], a[48:51], a[108:111], v[192:195]
    ds_read_b64_tr_b16 a[100:101], v8 offset:20480
    v_mfma_f32_16x16x32_bf16 v[196:199], a[52:55], a[108:111], v[196:199]
    ds_read_b64_tr_b16 a[102:103], v8 offset:21504
    v_mfma_f32_16x16x32_bf16 v[200:203], a[56:59], a[108:111], v[200:203]
    buffer_load_dwordx4 a[128:131], v5, s[8:11], s26 offen sc1
    v_mfma_f32_16x16x32_bf16 v[204:207], a[60:63], a[108:111], v[204:207]
    s_waitcnt lgkmcnt(6)
    v_mfma_f32_16x16x32_bf16 v[208:211], a[48:51], a[112:115], v[208:211]
    ds_read_b64_tr_b16 a[104:105], v9 offset:20480
    v_mfma_f32_16x16x32_bf16 v[212:215], a[52:55], a[112:115], v[212:215]
    ds_read_b64_tr_b16 a[106:107], v9 offset:21504
    v_mfma_f32_16x16x32_bf16 v[216:219], a[56:59], a[112:115], v[216:219]
    v_mfma_f32_16x16x32_bf16 v[220:223], a[60:63], a[112:115], v[220:223]
    s_waitcnt vmcnt(14)
    s_waitcnt lgkmcnt(6)
    v_mfma_f32_16x16x32_bf16 v[128:131], a[92:95], a[0:3], v[128:131]
    ds_read_b64_tr_b16 a[108:109], v8 offset:24576
    v_mfma_f32_16x16x32_bf16 v[132:135], a[92:95], a[4:7], v[132:135]
    ds_read_b64_tr_b16 a[110:111], v8 offset:25600
    v_mfma_f32_16x16x32_bf16 v[136:139], a[92:95], a[8:11], v[136:139]
    v_mfma_f32_16x16x32_bf16 v[140:143], a[92:95], a[12:15], v[140:143]
    s_waitcnt lgkmcnt(6)
    v_mfma_f32_16x16x32_bf16 v[144:147], a[96:99], a[0:3], v[144:147]
    ds_read_b64_tr_b16 a[112:113], v9 offset:24576
    v_mfma_f32_16x16x32_bf16 v[148:151], a[96:99], a[4:7], v[148:151]
    ds_read_b64_tr_b16 a[114:115], v9 offset:25600
    v_mfma_f32_16x16x32_bf16 v[152:155], a[96:99], a[8:11], v[152:155]
    s_mov_b32 s44, 0x3e8293ee
    s_mov_b32 s45, 0x3e8293ee
    v_and_b32 v14, 15, v0
    v_lshlrev_b32 v14, 4, v14
    v_mfma_f32_16x16x32_bf16 v[156:159], a[96:99], a[12:15], v[156:159]
    s_waitcnt lgkmcnt(6)
    v_mfma_f32_16x16x32_bf16 v[160:163], a[100:103], a[0:3], v[160:163]
    ds_read_b64_tr_b16 a[92:93], v8 offset:18432
    v_mfma_f32_16x16x32_bf16 v[164:167], a[100:103], a[4:7], v[164:167]
    ds_read_b64_tr_b16 a[94:95], v8 offset:19456
    v_mfma_f32_16x16x32_bf16 v[168:171], a[100:103], a[8:11], v[168:171]
    v_lshrrev_b32 v15, 5, v0
    v_bfe_u32 v244, v0, 4, 1
    v_lshl_add_u32 v245, v15, 9, v14
    v_lshl_add_u32 v245, v244, 10, v245
    v_mfma_f32_16x16x32_bf16 v[172:175], a[100:103], a[12:15], v[172:175]
    s_waitcnt lgkmcnt(6)
    v_mfma_f32_16x16x32_bf16 v[176:179], a[104:107], a[0:3], v[176:179]
    ds_read_b64_tr_b16 a[96:97], v9 offset:18432
    v_mfma_f32_16x16x32_bf16 v[180:183], a[104:107], a[4:7], v[180:183]
    ds_read_b64_tr_b16 a[98:99], v9 offset:19456
    v_mfma_f32_16x16x32_bf16 v[184:187], a[104:107], a[8:11], v[184:187]
    v_lshl_add_u32 v246, v244, 9, v14
    v_lshl_add_u32 v246, v15, 8, v246
    s_lshl_b32 s42, s25, 6
    s_lshl_b32 s43, s24, 3
    v_mfma_f32_16x16x32_bf16 v[188:191], a[104:107], a[12:15], v[188:191]
    s_waitcnt lgkmcnt(6)
    v_mfma_f32_16x16x32_bf16 v[192:195], a[0:3], a[108:111], v[192:195]
    ds_read_b64_tr_b16 a[100:101], v8 offset:22528
    v_mfma_f32_16x16x32_bf16 v[196:199], a[4:7], a[108:111], v[196:199]
    ds_read_b64_tr_b16 a[102:103], v8 offset:23552
    v_mfma_f32_16x16x32_bf16 v[200:203], a[8:11], a[108:111], v[200:203]
    s_add_u32 s42, s42, s43
    s_lshl_b32 s43, s3, 1
    s_add_u32 s42, s42, s43
    s_lshl_b32 s42, s42, 11
    v_mfma_f32_16x16x32_bf16 v[204:207], a[12:15], a[108:111], v[204:207]
    s_waitcnt lgkmcnt(6)
    v_mfma_f32_16x16x32_bf16 v[208:211], a[0:3], a[112:115], v[208:211]
    ds_read_b64_tr_b16 a[104:105], v9 offset:22528
    v_mfma_f32_16x16x32_bf16 v[212:215], a[4:7], a[112:115], v[212:215]
    ds_read_b64_tr_b16 a[106:107], v9 offset:23552
    v_mfma_f32_16x16x32_bf16 v[216:219], a[8:11], a[112:115], v[216:219]
    s_add_u32 s46, s42, 5242880
    s_add_u32 s47, s42, 9437184
    s_add_u32 s48, s42, 13631488
    v_mfma_f32_16x16x32_bf16 v[220:223], a[12:15], a[112:115], v[220:223]
    s_waitcnt vmcnt(9)
    s_waitcnt lgkmcnt(6)
    v_mfma_f32_16x16x32_bf16 v[128:131], a[92:95], a[16:19], v[128:131]
    ds_read_b64_tr_b16 a[108:109], v8 offset:26624
    v_mfma_f32_16x16x32_bf16 v[132:135], a[92:95], a[20:23], v[132:135]
    ds_read_b64_tr_b16 a[110:111], v8 offset:27648
    v_mfma_f32_16x16x32_bf16 v[136:139], a[92:95], a[24:27], v[136:139]
    v_mfma_f32_16x16x32_bf16 v[140:143], a[92:95], a[28:31], v[140:143]
    s_waitcnt lgkmcnt(6)
    v_mfma_f32_16x16x32_bf16 v[144:147], a[96:99], a[16:19], v[144:147]
    ds_read_b64_tr_b16 a[112:113], v9 offset:26624
    v_mfma_f32_16x16x32_bf16 v[148:151], a[96:99], a[20:23], v[148:151]
    ds_read_b64_tr_b16 a[114:115], v9 offset:27648
    v_mfma_f32_16x16x32_bf16 v[152:155], a[96:99], a[24:27], v[152:155]
    v_mfma_f32_16x16x32_bf16 v[156:159], a[96:99], a[28:31], v[156:159]
    s_add_u32 s32, s32, 28672
    s_cmp_ge_u32 s32, 143360
    s_cselect_b32 s34, 143360, 0
    s_sub_u32 s32, s32, s34
    s_barrier
    v_add_u32 v12, s32, v10
    v_add_u32 v13, s32, v11
    s_waitcnt lgkmcnt(6)
    v_mfma_f32_16x16x32_bf16 v[160:163], a[100:103], a[16:19], v[160:163]
    ds_read_b64_tr_b16 a[92:93], v12 offset:16384
    v_mfma_f32_16x16x32_bf16 v[164:167], a[100:103], a[20:23], v[164:167]
    ds_read_b64_tr_b16 a[94:95], v12 offset:17408
    v_mfma_f32_16x16x32_bf16 v[168:171], a[100:103], a[24:27], v[168:171]
    buffer_load_dwordx4 a[240:243], v1, s[72:75], s80 offen
    s_add_u32 s80, s80, s90
    v_mfma_f32_16x16x32_bf16 v[172:175], a[100:103], a[28:31], v[172:175]
    s_waitcnt lgkmcnt(6)
    v_mfma_f32_16x16x32_bf16 v[176:179], a[104:107], a[16:19], v[176:179]
    ds_read_b64_tr_b16 a[96:97], v13 offset:16384
    v_mfma_f32_16x16x32_bf16 v[180:183], a[104:107], a[20:23], v[180:183]
    ds_read_b64_tr_b16 a[98:99], v13 offset:17408
    v_mfma_f32_16x16x32_bf16 v[184:187], a[104:107], a[24:27], v[184:187]
    v_mfma_f32_16x16x32_bf16 v[188:191], a[104:107], a[28:31], v[188:191]
    s_waitcnt lgkmcnt(6)
    v_mfma_f32_16x16x32_bf16 v[192:195], a[16:19], a[108:111], v[192:195]
    ds_read_b64_tr_b16 a[100:101], v12 offset:20480
    v_mfma_f32_16x16x32_bf16 v[196:199], a[20:23], a[108:111], v[196:199]
    ds_read_b64_tr_b16 a[102:103], v12 offset:21504
    v_mfma_f32_16x16x32_bf16 v[200:203], a[24:27], a[108:111], v[200:203]
    v_mfma_f32_16x16x32_bf16 v[204:207], a[28:31], a[108:111], v[204:207]
    s_waitcnt lgkmcnt(6)
    v_mfma_f32_16x16x32_bf16 v[208:211], a[16:19], a[112:115], v[208:211]
    ds_read_b64_tr_b16 a[104:105], v13 offset:20480
    v_mfma_f32_16x16x32_bf16 v[212:215], a[20:23], a[112:115], v[212:215]
    ds_read_b64_tr_b16 a[106:107], v13 offset:21504
    v_mfma_f32_16x16x32_bf16 v[216:219], a[24:27], a[112:115], v[216:219]
    v_mfma_f32_16x16x32_bf16 v[220:223], a[28:31], a[112:115], v[220:223]
    s_waitcnt vmcnt(6)
    s_waitcnt lgkmcnt(6)
    v_mfma_f32_16x16x32_bf16 v[128:131], a[92:95], a[32:35], v[128:131]
    ds_read_b64_tr_b16 a[108:109], v12 offset:24576
    v_mfma_f32_16x16x32_bf16 v[132:135], a[92:95], a[36:39], v[132:135]
    ds_read_b64_tr_b16 a[110:111], v12 offset:25600
    v_mfma_f32_16x16x32_bf16 v[136:139], a[92:95], a[40:43], v[136:139]
    v_mfma_f32_16x16x32_bf16 v[140:143], a[92:95], a[44:47], v[140:143]
    s_waitcnt lgkmcnt(6)
    v_mfma_f32_16x16x32_bf16 v[144:147], a[96:99], a[32:35], v[144:147]
    ds_read_b64_tr_b16 a[112:113], v13 offset:24576
    v_mfma_f32_16x16x32_bf16 v[148:151], a[96:99], a[36:39], v[148:151]
    ds_read_b64_tr_b16 a[114:115], v13 offset:25600
    v_mfma_f32_16x16x32_bf16 v[152:155], a[96:99], a[40:43], v[152:155]
    v_mfma_f32_16x16x32_bf16 v[156:159], a[96:99], a[44:47], v[156:159]
    s_waitcnt lgkmcnt(6)
    v_mfma_f32_16x16x32_bf16 v[160:163], a[100:103], a[32:35], v[160:163]
    ds_read_b64_tr_b16 a[92:93], v12 offset:18432
    v_mfma_f32_16x16x32_bf16 v[164:167], a[100:103], a[36:39], v[164:167]
    ds_read_b64_tr_b16 a[94:95], v12 offset:19456
    v_mfma_f32_16x16x32_bf16 v[168:171], a[100:103], a[40:43], v[168:171]
    v_mfma_f32_16x16x32_bf16 v[172:175], a[100:103], a[44:47], v[172:175]
    s_waitcnt lgkmcnt(6)
    v_mfma_f32_16x16x32_bf16 v[176:179], a[104:107], a[32:35], v[176:179]
    ds_read_b64_tr_b16 a[96:97], v13 offset:18432
    v_mfma_f32_16x16x32_bf16 v[180:183], a[104:107], a[36:39], v[180:183]
    ds_read_b64_tr_b16 a[98:99], v13 offset:19456
    v_mfma_f32_16x16x32_bf16 v[184:187], a[104:107], a[40:43], v[184:187]
    v_mfma_f32_16x16x32_bf16 v[188:191], a[104:107], a[44:47], v[188:191]
    s_waitcnt lgkmcnt(6)
    v_mfma_f32_16x16x32_bf16 v[192:195], a[32:35], a[108:111], v[192:195]
    ds_read_b64_tr_b16 a[100:101], v12 offset:22528
    v_mfma_f32_16x16x32_bf16 v[196:199], a[36:39], a[108:111], v[196:199]
    ds_read_b64_tr_b16 a[102:103], v12 offset:23552
    v_mfma_f32_16x16x32_bf16 v[200:203], a[40:43], a[108:111], v[200:203]
    v_mfma_f32_16x16x32_bf16 v[204:207], a[44:47], a[108:111], v[204:207]
    s_waitcnt lgkmcnt(6)
    v_mfma_f32_16x16x32_bf16 v[208:211], a[32:35], a[112:115], v[208:211]
    ds_read_b64_tr_b16 a[104:105], v13 offset:22528
    v_mfma_f32_16x16x32_bf16 v[212:215], a[36:39], a[112:115], v[212:215]
    ds_read_b64_tr_b16 a[106:107], v13 offset:23552
    v_mfma_f32_16x16x32_bf16 v[216:219], a[40:43], a[112:115], v[216:219]
    v_mfma_f32_16x16x32_bf16 v[220:223], a[44:47], a[112:115], v[220:223]
    s_waitcnt vmcnt(1)
    s_waitcnt lgkmcnt(6)
    v_mfma_f32_16x16x32_bf16 v[128:131], a[92:95], a[116:119], v[128:131]
    ds_read_b64_tr_b16 a[108:109], v12 offset:26624
    v_mfma_f32_16x16x32_bf16 v[132:135], a[92:95], a[120:123], v[132:135]
    ds_read_b64_tr_b16 a[110:111], v12 offset:27648
    v_mfma_f32_16x16x32_bf16 v[136:139], a[92:95], a[124:127], v[136:139]
    v_mfma_f32_16x16x32_bf16 v[140:143], a[92:95], a[128:131], v[140:143]
    s_waitcnt lgkmcnt(6)
    v_mfma_f32_16x16x32_bf16 v[144:147], a[96:99], a[116:119], v[144:147]
    ds_read_b64_tr_b16 a[112:113], v13 offset:26624
    v_mfma_f32_16x16x32_bf16 v[148:151], a[96:99], a[120:123], v[148:151]
    ds_read_b64_tr_b16 a[114:115], v13 offset:27648
    v_mfma_f32_16x16x32_bf16 v[152:155], a[96:99], a[124:127], v[152:155]
    v_mfma_f32_16x16x32_bf16 v[156:159], a[96:99], a[128:131], v[156:159]
    s_waitcnt lgkmcnt(6)
    v_mfma_f32_16x16x32_bf16 v[160:163], a[100:103], a[116:119], v[160:163]
    ds_read_b64_tr_b16 a[64:65], v8 offset:0
    v_mfma_f32_16x16x32_bf16 v[164:167], a[100:103], a[120:123], v[164:167]
    ds_read_b64_tr_b16 a[66:67], v8 offset:1024
    v_mfma_f32_16x16x32_bf16 v[168:171], a[100:103], a[124:127], v[168:171]
    v_mfma_f32_16x16x32_bf16 v[172:175], a[100:103], a[128:131], v[172:175]
    s_waitcnt lgkmcnt(6)
    v_mfma_f32_16x16x32_bf16 v[176:179], a[104:107], a[116:119], v[176:179]
    ds_read_b64_tr_b16 a[68:69], v9 offset:0
    v_mfma_f32_16x16x32_bf16 v[180:183], a[104:107], a[120:123], v[180:183]
    ds_read_b64_tr_b16 a[70:71], v9 offset:1024
    v_mfma_f32_16x16x32_bf16 v[184:187], a[104:107], a[124:127], v[184:187]
    buffer_load_dwordx4 a[240:243], v1, s[72:75], s80 offen
    s_add_u32 s80, s80, s90
    v_mfma_f32_16x16x32_bf16 v[188:191], a[104:107], a[128:131], v[188:191]
    s_waitcnt lgkmcnt(6)
    v_mfma_f32_16x16x32_bf16 v[192:195], a[116:119], a[108:111], v[192:195]
    ds_read_b64_tr_b16 a[72:73], v8 offset:4096
    v_mfma_f32_16x16x32_bf16 v[196:199], a[120:123], a[108:111], v[196:199]
    ds_read_b64_tr_b16 a[74:75], v8 offset:5120
    v_mfma_f32_16x16x32_bf16 v[200:203], a[124:127], a[108:111], v[200:203]
    v_mfma_f32_16x16x32_bf16 v[204:207], a[128:131], a[108:111], v[204:207]
    s_waitcnt lgkmcnt(6)
    v_mfma_f32_16x16x32_bf16 v[208:211], a[116:119], a[112:115], v[208:211]
    ds_read_b64_tr_b16 a[76:77], v9 offset:4096
    v_mfma_f32_16x16x32_bf16 v[212:215], a[120:123], a[112:115], v[212:215]
    ds_read_b64_tr_b16 a[78:79], v9 offset:5120
    v_mfma_f32_16x16x32_bf16 v[216:219], a[124:127], a[112:115], v[216:219]
    v_mfma_f32_16x16x32_bf16 v[220:223], a[128:131], a[112:115], v[220:223]
    s_waitcnt lgkmcnt(6)
    v_mfma_f32_16x16x32_bf16 v[16:19], a[64:67], a[0:3], v[16:19]
    ds_read_b64_tr_b16 a[80:81], v8 offset:8192
    v_mfma_f32_16x16x32_bf16 v[20:23], a[64:67], a[4:7], v[20:23]
    ds_read_b64_tr_b16 a[82:83], v8 offset:9216
    v_mfma_f32_16x16x32_bf16 v[24:27], a[64:67], a[8:11], v[24:27]
    v_mfma_f32_16x16x32_bf16 v[28:31], a[64:67], a[12:15], v[28:31]
    s_waitcnt lgkmcnt(6)
    v_mfma_f32_16x16x32_bf16 v[32:35], a[68:71], a[0:3], v[32:35]
    ds_read_b64_tr_b16 a[84:85], v9 offset:8192
    v_mfma_f32_16x16x32_bf16 v[36:39], a[68:71], a[4:7], v[36:39]
    ds_read_b64_tr_b16 a[86:87], v9 offset:9216
    v_mfma_f32_16x16x32_bf16 v[40:43], a[68:71], a[8:11], v[40:43]
    v_pk_mul_f32 v[128:129], v[128:129], s[44:45]
    v_pk_mul_f32 v[130:131], v[130:131], s[44:45]
    v_pk_mul_f32 v[144:145], v[144:145], s[44:45]
    v_pk_mul_f32 v[146:147], v[146:147], s[44:45]
    v_cvt_pk_bf16_f32 v128, v128, v129
    v_cvt_pk_bf16_f32 v129, v130, v131
    v_cvt_pk_bf16_f32 v130, v144, v145
    v_cvt_pk_bf16_f32 v131, v146, v147
    v_mfma_f32_16x16x32_bf16 v[44:47], a[68:71], a[12:15], v[44:47]
    s_waitcnt lgkmcnt(6)
    v_mfma_f32_16x16x32_bf16 v[48:51], a[72:75], a[0:3], v[48:51]
    ds_read_b64_tr_b16 a[88:89], v8 offset:12288
    v_mfma_f32_16x16x32_bf16 v[52:55], a[72:75], a[4:7], v[52:55]
    ds_read_b64_tr_b16 a[90:91], v8 offset:13312
    v_mfma_f32_16x16x32_bf16 v[56:59], a[72:75], a[8:11], v[56:59]
    v_permlane16_swap_b32 v128, v130
    v_permlane16_swap_b32 v129, v131
    buffer_store_dwordx4 v[128:131], v245, s[8:11], s46 offen offset:0 sc1
    v_mfma_f32_16x16x32_bf16 v[60:63], a[72:75], a[12:15], v[60:63]
    s_waitcnt lgkmcnt(6)
    v_mfma_f32_16x16x32_bf16 v[64:67], a[76:79], a[0:3], v[64:67]
    ds_read_b64_tr_b16 a[64:65], v8 offset:2048
    v_mfma_f32_16x16x32_bf16 v[68:71], a[76:79], a[4:7], v[68:71]
    ds_read_b64_tr_b16 a[66:67], v8 offset:3072
    v_mfma_f32_16x16x32_bf16 v[72:75], a[76:79], a[8:11], v[72:75]
    v_mfma_f32_16x16x32_bf16 v[76:79], a[76:79], a[12:15], v[76:79]
    s_waitcnt lgkmcnt(6)
    v_mfma_f32_16x16x32_bf16 v[80:83], a[80:83], a[0:3], v[80:83]
    ds_read_b64_tr_b16 a[68:69], v9 offset:2048
    v_mfma_f32_16x16x32_bf16 v[84:87], a[80:83], a[4:7], v[84:87]
    ds_read_b64_tr_b16 a[70:71], v9 offset:3072
    v_mfma_f32_16x16x32_bf16 v[88:91], a[80:83], a[8:11], v[88:91]
    v_pk_mul_f32 v[132:133], v[132:133], s[44:45]
    v_pk_mul_f32 v[134:135], v[134:135], s[44:45]
    v_pk_mul_f32 v[148:149], v[148:149], s[44:45]
    v_pk_mul_f32 v[150:151], v[150:151], s[44:45]
    v_cvt_pk_bf16_f32 v132, v132, v133
    v_cvt_pk_bf16_f32 v133, v134, v135
    v_cvt_pk_bf16_f32 v134, v148, v149
    v_cvt_pk_bf16_f32 v135, v150, v151
    v_mfma_f32_16x16x32_bf16 v[92:95], a[80:83], a[12:15], v[92:95]
    s_waitcnt lgkmcnt(6)
    v_mfma_f32_16x16x32_bf16 v[96:99], a[84:87], a[0:3], v[96:99]
    ds_read_b64_tr_b16 a[72:73], v8 offset:6144
    v_mfma_f32_16x16x32_bf16 v[100:103], a[84:87], a[4:7], v[100:103]
    ds_read_b64_tr_b16 a[74:75], v8 offset:7168
    v_mfma_f32_16x16x32_bf16 v[104:107], a[84:87], a[8:11], v[104:107]
    v_permlane16_swap_b32 v132, v134
    v_permlane16_swap_b32 v133, v135
    buffer_store_dwordx4 v[132:135], v245, s[8:11], s46 offen offset:256 sc1
    v_mfma_f32_16x16x32_bf16 v[108:111], a[84:87], a[12:15], v[108:111]
    s_waitcnt lgkmcnt(6)
    v_mfma_f32_16x16x32_bf16 v[112:115], a[88:91], a[0:3], v[112:115]
    ds_read_b64_tr_b16 a[76:77], v9 offset:6144
    v_mfma_f32_16x16x32_bf16 v[116:119], a[88:91], a[4:7], v[116:119]
    ds_read_b64_tr_b16 a[78:79], v9 offset:7168
    v_mfma_f32_16x16x32_bf16 v[120:123], a[88:91], a[8:11], v[120:123]
    v_mfma_f32_16x16x32_bf16 v[124:127], a[88:91], a[12:15], v[124:127]
    s_waitcnt lgkmcnt(6)
    v_mfma_f32_16x16x32_bf16 v[16:19], a[64:67], a[16:19], v[16:19]
    ds_read_b64_tr_b16 a[80:81], v8 offset:10240
    v_mfma_f32_16x16x32_bf16 v[20:23], a[64:67], a[20:23], v[20:23]
    ds_read_b64_tr_b16 a[82:83], v8 offset:11264
    v_mfma_f32_16x16x32_bf16 v[24:27], a[64:67], a[24:27], v[24:27]
    v_pk_mul_f32 v[136:137], v[136:137], s[44:45]
    v_pk_mul_f32 v[138:139], v[138:139], s[44:45]
    v_pk_mul_f32 v[152:153], v[152:153], s[44:45]
    v_pk_mul_f32 v[154:155], v[154:155], s[44:45]
    v_cvt_pk_bf16_f32 v136, v136, v137
    v_cvt_pk_bf16_f32 v137, v138, v139
    v_cvt_pk_bf16_f32 v138, v152, v153
    v_cvt_pk_bf16_f32 v139, v154, v155
    v_mfma_f32_16x16x32_bf16 v[28:31], a[64:67], a[28:31], v[28:31]
    s_waitcnt lgkmcnt(6)
    v_mfma_f32_16x16x32_bf16 v[32:35], a[68:71], a[16:19], v[32:35]
    ds_read_b64_tr_b16 a[84:85], v9 offset:10240
    v_mfma_f32_16x16x32_bf16 v[36:39], a[68:71], a[20:23], v[36:39]
    ds_read_b64_tr_b16 a[86:87], v9 offset:11264
    v_mfma_f32_16x16x32_bf16 v[40:43], a[68:71], a[24:27], v[40:43]
    v_permlane16_swap_b32 v136, v138
    v_permlane16_swap_b32 v137, v139
    buffer_store_dwordx4 v[136:139], v245, s[8:11], s46 offen offset:2048 sc1
    v_mfma_f32_16x16x32_bf16 v[44:47], a[68:71], a[28:31], v[44:47]
    s_waitcnt lgkmcnt(6)
    v_mfma_f32_16x16x32_bf16 v[48:51], a[72:75], a[16:19], v[48:51]
L_pad_3:
    s_cbranch_execz L_pad_6
    ds_read_b64_tr_b16 a[88:89], v8 offset:14336
    v_mfma_f32_16x16x32_bf16 v[52:55], a[72:75], a[20:23], v[52:55]
    ds_read_b64_tr_b16 a[90:91], v8 offset:15360
    v_mfma_f32_16x16x32_bf16 v[56:59], a[72:75], a[24:27], v[56:59]
    v_mfma_f32_16x16x32_bf16 v[60:63], a[72:75], a[28:31], v[60:63]
    s_waitcnt lgkmcnt(6)
    v_mfma_f32_16x16x32_bf16 v[64:67], a[76:79], a[16:19], v[64:67]
    ds_read_b64_tr_b16 a[64:65], v12 offset:0
    v_mfma_f32_16x16x32_bf16 v[68:71], a[76:79], a[20:23], v[68:71]
    ds_read_b64_tr_b16 a[66:67], v12 offset:1024
    v_mfma_f32_16x16x32_bf16 v[72:75], a[76:79], a[24:27], v[72:75]
    v_pk_mul_f32 v[140:141], v[140:141], s[44:45]
    v_pk_mul_f32 v[142:143], v[142:143], s[44:45]
    v_pk_mul_f32 v[156:157], v[156:157], s[44:45]
    v_pk_mul_f32 v[158:159], v[158:159], s[44:45]
    v_cvt_pk_bf16_f32 v140, v140, v141
    v_cvt_pk_bf16_f32 v141, v142, v143
    v_cvt_pk_bf16_f32 v142, v156, v157
    v_cvt_pk_bf16_f32 v143, v158, v159
    v_mfma_f32_16x16x32_bf16 v[76:79], a[76:79], a[28:31], v[76:79]
    s_waitcnt lgkmcnt(6)
    v_mfma_f32_16x16x32_bf16 v[80:83], a[80:83], a[16:19], v[80:83]
    ds_read_b64_tr_b16 a[68:69], v13 offset:0
    v_mfma_f32_16x16x32_bf16 v[84:87], a[80:83], a[20:23], v[84:87]
    ds_read_b64_tr_b16 a[70:71], v13 offset:1024
    v_mfma_f32_16x16x32_bf16 v[88:91], a[80:83], a[24:27], v[88:91]
    v_permlane16_swap_b32 v140, v142
    v_permlane16_swap_b32 v141, v143
    buffer_store_dwordx4 v[140:143], v245, s[8:11], s46 offen offset:2304 sc1
    v_mfma_f32_16x16x32_bf16 v[92:95], a[80:83], a[28:31], v[92:95]
    s_waitcnt lgkmcnt(6)
    v_mfma_f32_16x16x32_bf16 v[96:99], a[84:87], a[16:19], v[96:99]
    ds_read_b64_tr_b16 a[72:73], v12 offset:4096
    v_mfma_f32_16x16x32_bf16 v[100:103], a[84:87], a[20:23], v[100:103]
    ds_read_b64_tr_b16 a[74:75], v12 offset:5120
    v_mfma_f32_16x16x32_bf16 v[104:107], a[84:87], a[24:27], v[104:107]
    v_mfma_f32_16x16x32_bf16 v[108:111], a[84:87], a[28:31], v[108:111]
    s_waitcnt lgkmcnt(6)
    v_mfma_f32_16x16x32_bf16 v[112:115], a[88:91], a[16:19], v[112:115]
    ds_read_b64_tr_b16 a[76:77], v13 offset:4096
    v_mfma_f32_16x16x32_bf16 v[116:119], a[88:91], a[20:23], v[116:119]
    ds_read_b64_tr_b16 a[78:79], v13 offset:5120
    v_mfma_f32_16x16x32_bf16 v[120:123], a[88:91], a[24:27], v[120:123]
    v_cvt_pk_bf16_f32 v160, v160, v161
    v_cvt_pk_bf16_f32 v161, v162, v163
    v_cvt_pk_bf16_f32 v162, v176, v177
    v_cvt_pk_bf16_f32 v163, v178, v179
    v_mfma_f32_16x16x32_bf16 v[124:127], a[88:91], a[28:31], v[124:127]
    s_waitcnt lgkmcnt(6)
    v_mfma_f32_16x16x32_bf16 v[16:19], a[64:67], a[32:35], v[16:19]
    ds_read_b64_tr_b16 a[80:81], v12 offset:8192
    v_mfma_f32_16x16x32_bf16 v[20:23], a[64:67], a[36:39], v[20:23]
    ds_read_b64_tr_b16 a[82:83], v12 offset:9216
    v_mfma_f32_16x16x32_bf16 v[24:27], a[64:67], a[40:43], v[24:27]
    v_permlane16_swap_b32 v160, v162
    v_permlane16_swap_b32 v161, v163
    buffer_store_dwordx4 v[160:163], v245, s[8:11], s47 offen offset:0 sc1
    v_mfma_f32_16x16x32_bf16 v[28:31], a[64:67], a[44:47], v[28:31]
    s_waitcnt lgkmcnt(6)
    v_mfma_f32_16x16x32_bf16 v[32:35], a[68:71], a[32:35], v[32:35]
    ds_read_b64_tr_b16 a[84:85], v13 offset:8192
    v_mfma_f32_16x16x32_bf16 v[36:39], a[68:71], a[36:39], v[36:39]
    ds_read_b64_tr_b16 a[86:87], v13 offset:9216
    v_mfma_f32_16x16x32_bf16 v[40:43], a[68:71], a[40:43], v[40:43]
    v_mfma_f32_16x16x32_bf16 v[44:47], a[68:71], a[44:47], v[44:47]
    s_waitcnt lgkmcnt(6)
    v_mfma_f32_16x16x32_bf16 v[48:51], a[72:75], a[32:35], v[48:51]
    ds_read_b64_tr_b16 a[88:89], v12 offset:12288
    v_mfma_f32_16x16x32_bf16 v[52:55], a[72:75], a[36:39], v[52:55]
    ds_read_b64_tr_b16 a[90:91], v12 offset:13312
    v_mfma_f32_16x16x32_bf16 v[56:59], a[72:75], a[40:43], v[56:59]
    v_cvt_pk_bf16_f32 v164, v164, v165
    v_cvt_pk_bf16_f32 v165, v166, v167
    v_cvt_pk_bf16_f32 v166, v180, v181
    v_cvt_pk_bf16_f32 v167, v182, v183
    v_mfma_f32_16x16x32_bf16 v[60:63], a[72:75], a[44:47], v[60:63]
    s_waitcnt lgkmcnt(6)
    v_mfma_f32_16x16x32_bf16 v[64:67], a[76:79], a[32:35], v[64:67]
    ds_read_b64_tr_b16 a[64:65], v12 offset:2048
    v_mfma_f32_16x16x32_bf16 v[68:71], a[76:79], a[36:39], v[68:71]
    ds_read_b64_tr_b16 a[66:67], v12 offset:3072
    v_mfma_f32_16x16x32_bf16 v[72:75], a[76:79], a[40:43], v[72:75]
    v_permlane16_swap_b32 v164, v166
    v_permlane16_swap_b32 v165, v167
    buffer_store_dwordx4 v[164:167], v245, s[8:11], s47 offen offset:256 sc1
    v_mfma_f32_16x16x32_bf16 v[76:79], a[76:79], a[44:47], v[76:79]
    s_waitcnt lgkmcnt(6)
    v_mfma_f32_16x16x32_bf16 v[80:83], a[80:83], a[32:35], v[80:83]
    ds_read_b64_tr_b16 a[68:69], v13 offset:2048
    v_mfma_f32_16x16x32_bf16 v[84:87], a[80:83], a[36:39], v[84:87]
    ds_read_b64_tr_b16 a[70:71], v13 offset:3072
    v_mfma_f32_16x16x32_bf16 v[88:91], a[80:83], a[40:43], v[88:91]
    v_mfma_f32_16x16x32_bf16 v[92:95], a[80:83], a[44:47], v[92:95]
    s_waitcnt lgkmcnt(6)
    v_mfma_f32_16x16x32_bf16 v[96:99], a[84:87], a[32:35], v[96:99]
    ds_read_b64_tr_b16 a[72:73], v12 offset:6144
    v_mfma_f32_16x16x32_bf16 v[100:103], a[84:87], a[36:39], v[100:103]
    ds_read_b64_tr_b16 a[74:75], v12 offset:7168
    v_mfma_f32_16x16x32_bf16 v[104:107], a[84:87], a[40:43], v[104:107]
    v_cvt_pk_bf16_f32 v168, v168, v169
    v_cvt_pk_bf16_f32 v169, v170, v171
    v_cvt_pk_bf16_f32 v170, v184, v185
    v_cvt_pk_bf16_f32 v171, v186, v187
    v_mfma_f32_16x16x32_bf16 v[108:111], a[84:87], a[44:47], v[108:111]
    s_waitcnt lgkmcnt(6)
    v_mfma_f32_16x16x32_bf16 v[112:115], a[88:91], a[32:35], v[112:115]
    ds_read_b64_tr_b16 a[76:77], v13 offset:6144
    v_mfma_f32_16x16x32_bf16 v[116:119], a[88:91], a[36:39], v[116:119]
    ds_read_b64_tr_b16 a[78:79], v13 offset:7168
    v_mfma_f32_16x16x32_bf16 v[120:123], a[88:91], a[40:43], v[120:123]
    v_permlane16_swap_b32 v168, v170
    v_permlane16_swap_b32 v169, v171
    buffer_store_dwordx4 v[168:171], v245, s[8:11], s47 offen offset:2048 sc1
    v_mfma_f32_16x16x32_bf16 v[124:127], a[88:91], a[44:47], v[124:127]
    s_waitcnt lgkmcnt(6)
    v_mfma_f32_16x16x32_bf16 v[16:19], a[64:67], a[116:119], v[16:19]
    ds_read_b64_tr_b16 a[80:81], v12 offset:10240
    v_mfma_f32_16x16x32_bf16 v[20:23], a[64:67], a[120:123], v[20:23]
    ds_read_b64_tr_b16 a[82:83], v12 offset:11264
    v_mfma_f32_16x16x32_bf16 v[24:27], a[64:67], a[124:127], v[24:27]
    v_mfma_f32_16x16x32_bf16 v[28:31], a[64:67], a[128:131], v[28:31]
    s_waitcnt lgkmcnt(6)
    v_mfma_f32_16x16x32_bf16 v[32:35], a[68:71], a[116:119], v[32:35]
    ds_read_b64_tr_b16 a[84:85], v13 offset:10240
    v_mfma_f32_16x16x32_bf16 v[36:39], a[68:71], a[120:123], v[36:39]
    ds_read_b64_tr_b16 a[86:87], v13 offset:11264
    v_mfma_f32_16x16x32_bf16 v[40:43], a[68:71], a[124:127], v[40:43]
    v_cvt_pk_bf16_f32 v172, v172, v173
    v_cvt_pk_bf16_f32 v173, v174, v175
    v_cvt_pk_bf16_f32 v174, v188, v189
    v_cvt_pk_bf16_f32 v175, v190, v191
    v_mfma_f32_16x16x32_bf16 v[44:47], a[68:71], a[128:131], v[44:47]
    s_waitcnt lgkmcnt(6)
    v_mfma_f32_16x16x32_bf16 v[48:51], a[72:75], a[116:119], v[48:51]
    ds_read_b64_tr_b16 a[88:89], v12 offset:14336
    v_mfma_f32_16x16x32_bf16 v[52:55], a[72:75], a[120:123], v[52:55]
    ds_read_b64_tr_b16 a[90:91], v12 offset:15360
    v_mfma_f32_16x16x32_bf16 v[56:59], a[72:75], a[124:127], v[56:59]
    v_permlane16_swap_b32 v172, v174
    v_permlane16_swap_b32 v173, v175
    buffer_store_dwordx4 v[172:175], v245, s[8:11], s47 offen offset:2304 sc1
    v_mfma_f32_16x16x32_bf16 v[60:63], a[72:75], a[128:131], v[60:63]
    s_waitcnt lgkmcnt(6)
    v_mfma_f32_16x16x32_bf16 v[64:67], a[76:79], a[116:119], v[64:67]
    v_mfma_f32_16x16x32_bf16 v[68:71], a[76:79], a[120:123], v[68:71]
    v_mfma_f32_16x16x32_bf16 v[72:75], a[76:79], a[124:127], v[72:75]
    v_mfma_f32_16x16x32_bf16 v[76:79], a[76:79], a[128:131], v[76:79]
    s_waitcnt lgkmcnt(4)
    v_mfma_f32_16x16x32_bf16 v[80:83], a[80:83], a[116:119], v[80:83]
    v_mfma_f32_16x16x32_bf16 v[84:87], a[80:83], a[120:123], v[84:87]
    v_mfma_f32_16x16x32_bf16 v[88:91], a[80:83], a[124:127], v[88:91]
    v_cvt_pk_bf16_f32 v192, v192, v193
    v_cvt_pk_bf16_f32 v193, v194, v195
    v_cvt_pk_bf16_f32 v194, v208, v209
    v_cvt_pk_bf16_f32 v195, v210, v211
    v_mfma_f32_16x16x32_bf16 v[92:95], a[80:83], a[128:131], v[92:95]
    s_waitcnt lgkmcnt(2)
    v_mfma_f32_16x16x32_bf16 v[96:99], a[84:87], a[116:119], v[96:99]
    v_mfma_f32_16x16x32_bf16 v[100:103], a[84:87], a[120:123], v[100:103]
    v_mfma_f32_16x16x32_bf16 v[104:107], a[84:87], a[124:127], v[104:107]
    v_permlane32_swap_b32 v192, v194
    v_permlane32_swap_b32 v193, v195
    buffer_store_dwordx4 v[192:195], v246, s[8:11], s48 offen offset:0 sc1
    v_mfma_f32_16x16x32_bf16 v[108:111], a[84:87], a[128:131], v[108:111]
    s_waitcnt lgkmcnt(0)
    v_mfma_f32_16x16x32_bf16 v[112:115], a[88:91], a[116:119], v[112:115]
    v_mfma_f32_16x16x32_bf16 v[116:119], a[88:91], a[120:123], v[116:119]
    v_mfma_f32_16x16x32_bf16 v[120:123], a[88:91], a[124:127], v[120:123]
    v_mfma_f32_16x16x32_bf16 v[124:127], a[88:91], a[128:131], v[124:127]
    s_mov_b32 s40, 0xbdd2d3e8
    s_mov_b32 s41, 0xbdd2d3e8
    v_mov_b32 v242, 0xc0135761
    v_mov_b32 v243, 0xc0135761
    s_lshl_b32 s42, s24, 3
    s_lshl_b32 s43, s3, 1
    s_add_u32 s42, s42, s43
    s_mul_i32 s42, s42, 224
    s_mul_i32 s43, s25, 7
    s_add_u32 s42, s42, s43
    s_lshl_b32 s50, s42, 10
    s_add_u32 s50, s50, 17825792
    v_cvt_pk_bf16_f32 v196, v196, v197
    v_cvt_pk_bf16_f32 v197, v198, v199
    v_cvt_pk_bf16_f32 v198, v212, v213
    v_cvt_pk_bf16_f32 v199, v214, v215
    v_cvt_pk_bf16_f32 v200, v200, v201
    v_cvt_pk_bf16_f32 v201, v202, v203
    v_cvt_pk_bf16_f32 v202, v216, v217
    v_cvt_pk_bf16_f32 v203, v218, v219
    v_cvt_pk_bf16_f32 v204, v204, v205
    v_cvt_pk_bf16_f32 v205, v206, v207
    v_cvt_pk_bf16_f32 v206, v220, v221
    v_cvt_pk_bf16_f32 v207, v222, v223
    v_lshlrev_b32 v136, 16, v224
    v_and_b32 v137, 0xffff0000, v224
    v_lshlrev_b32 v138, 16, v225
    v_and_b32 v139, 0xffff0000, v225
    v_lshlrev_b32 v140, 16, v226
    v_and_b32 v141, 0xffff0000, v226
    v_lshlrev_b32 v142, 16, v227
    v_and_b32 v143, 0xffff0000, v227
    v_pk_fma_f32 v[16:17], v[16:17], v[238:239], v[136:137] op_sel_hi:[1,0,1]
    v_pk_fma_f32 v[18:19], v[18:19], v[238:239], v[138:139] op_sel_hi:[1,0,1]
    v_pk_fma_f32 v[32:33], v[32:33], v[238:239], v[140:141] op_sel_hi:[1,0,1]
    v_pk_fma_f32 v[34:35], v[34:35], v[238:239], v[142:143] op_sel_hi:[1,0,1]
    v_permlane32_swap_b32 v196, v198
    v_permlane32_swap_b32 v197, v199
    buffer_store_dwordx4 v[196:199], v246, s[8:11], s48 offen offset:1024 sc1
    v_pk_mul_f32 v[128:129], v[16:17], v[16:17]
    v_pk_mul_f32 v[130:131], v[18:19], v[18:19]
    v_pk_mul_f32 v[132:133], v[32:33], v[32:33]
    v_pk_mul_f32 v[134:135], v[34:35], v[34:35]
    v_pk_fma_f32 v[128:129], v[128:129], s[40:41], v[242:243]
    v_pk_fma_f32 v[130:131], v[130:131], s[40:41], v[242:243]
    v_pk_fma_f32 v[132:133], v[132:133], s[40:41], v[242:243]
    v_pk_fma_f32 v[134:135], v[134:135], s[40:41], v[242:243]
    v_pk_mul_f32 v[128:129], v[128:129], v[16:17]
    v_pk_mul_f32 v[130:131], v[130:131], v[18:19]
    v_pk_mul_f32 v[132:133], v[132:133], v[32:33]
    v_pk_mul_f32 v[134:135], v[134:135], v[34:35]
    v_exp_f32 v128, v128
    v_exp_f32 v129, v129
    v_exp_f32 v130, v130
    v_exp_f32 v131, v131
    v_exp_f32 v132, v132
    v_exp_f32 v133, v133
    v_exp_f32 v134, v134
    v_exp_f32 v135, v135
    v_pk_add_f32 v[128:129], v[128:129], 1.0 op_sel_hi:[1,0]
    v_pk_add_f32 v[130:131], v[130:131], 1.0 op_sel_hi:[1,0]
    v_pk_add_f32 v[132:133], v[132:133], 1.0 op_sel_hi:[1,0]
    v_pk_add_f32 v[134:135], v[134:135], 1.0 op_sel_hi:[1,0]
    v_rcp_f32 v128, v128
    v_rcp_f32 v129, v129
    v_rcp_f32 v130, v130
    v_rcp_f32 v131, v131
    v_rcp_f32 v132, v132
    v_rcp_f32 v133, v133
    v_rcp_f32 v134, v134
    v_rcp_f32 v135, v135
    v_pk_mul_f32 v[16:17], v[16:17], v[128:129]
    v_pk_mul_f32 v[18:19], v[18:19], v[130:131]
    v_pk_mul_f32 v[32:33], v[32:33], v[132:133]
    v_pk_mul_f32 v[34:35], v[34:35], v[134:135]
    v_cvt_pk_bf16_f32 v144, v16, v17
    v_cvt_pk_bf16_f32 v145, v18, v19
    v_cvt_pk_bf16_f32 v146, v32, v33
    v_cvt_pk_bf16_f32 v147, v34, v35
    v_pk_fma_f32 v[20:21], v[20:21], v[238:239], v[136:137] op_sel:[0,1,0] op_sel_hi:[1,1,1]
    v_pk_fma_f32 v[22:23], v[22:23], v[238:239], v[138:139] op_sel:[0,1,0] op_sel_hi:[1,1,1]
    v_pk_fma_f32 v[36:37], v[36:37], v[238:239], v[140:141] op_sel:[0,1,0] op_sel_hi:[1,1,1]
    v_pk_fma_f32 v[38:39], v[38:39], v[238:239], v[142:143] op_sel:[0,1,0] op_sel_hi:[1,1,1]
    v_permlane32_swap_b32 v200, v202
    v_permlane32_swap_b32 v201, v203
    buffer_store_dwordx4 v[200:203], v246, s[8:11], s48 offen offset:2048 sc1
    v_pk_mul_f32 v[128:129], v[20:21], v[20:21]
    v_pk_mul_f32 v[130:131], v[22:23], v[22:23]
    v_pk_mul_f32 v[132:133], v[36:37], v[36:37]
    v_pk_mul_f32 v[134:135], v[38:39], v[38:39]
    v_pk_fma_f32 v[128:129], v[128:129], s[40:41], v[242:243]
    v_pk_fma_f32 v[130:131], v[130:131], s[40:41], v[242:243]
    v_pk_fma_f32 v[132:133], v[132:133], s[40:41], v[242:243]
    v_pk_fma_f32 v[134:135], v[134:135], s[40:41], v[242:243]
    v_pk_mul_f32 v[128:129], v[128:129], v[20:21]
    v_pk_mul_f32 v[130:131], v[130:131], v[22:23]
    v_pk_mul_f32 v[132:133], v[132:133], v[36:37]
    v_pk_mul_f32 v[134:135], v[134:135], v[38:39]
    v_exp_f32 v128, v128
    v_exp_f32 v129, v129
    v_exp_f32 v130, v130
    v_exp_f32 v131, v131
    v_exp_f32 v132, v132
    v_exp_f32 v133, v133
    v_exp_f32 v134, v134
    v_exp_f32 v135, v135
    v_pk_add_f32 v[128:129], v[128:129], 1.0 op_sel_hi:[1,0]
    v_pk_add_f32 v[130:131], v[130:131], 1.0 op_sel_hi:[1,0]
    v_pk_add_f32 v[132:133], v[132:133], 1.0 op_sel_hi:[1,0]
    v_pk_add_f32 v[134:135], v[134:135], 1.0 op_sel_hi:[1,0]
    v_rcp_f32 v128, v128
    v_rcp_f32 v129, v129
    v_rcp_f32 v130, v130
    v_rcp_f32 v131, v131
    v_rcp_f32 v132, v132
    v_rcp_f32 v133, v133
    v_rcp_f32 v134, v134
    v_rcp_f32 v135, v135
    v_pk_mul_f32 v[20:21], v[20:21], v[128:129]
    v_pk_mul_f32 v[22:23], v[22:23], v[130:131]
    v_pk_mul_f32 v[36:37], v[36:37], v[132:133]
    v_pk_mul_f32 v[38:39], v[38:39], v[134:135]
    v_cvt_pk_bf16_f32 v148, v20, v21
    v_cvt_pk_bf16_f32 v149, v22, v23
    v_cvt_pk_bf16_f32 v150, v36, v37
    v_cvt_pk_bf16_f32 v151, v38, v39
    v_permlane16_swap_b32 v144, v146
    v_permlane16_swap_b32 v145, v147
    v_pk_fma_f32 v[24:25], v[24:25], v[240:241], v[136:137] op_sel_hi:[1,0,1]
    v_pk_fma_f32 v[26:27], v[26:27], v[240:241], v[138:139] op_sel_hi:[1,0,1]
    v_pk_fma_f32 v[40:41], v[40:41], v[240:241], v[140:141] op_sel_hi:[1,0,1]
    v_pk_fma_f32 v[42:43], v[42:43], v[240:241], v[142:143] op_sel_hi:[1,0,1]
    v_permlane32_swap_b32 v204, v206
    v_permlane32_swap_b32 v205, v207
    buffer_store_dwordx4 v[204:207], v246, s[8:11], s48 offen offset:3072 sc1
    v_pk_mul_f32 v[128:129], v[24:25], v[24:25]
    v_pk_mul_f32 v[130:131], v[26:27], v[26:27]
    v_pk_mul_f32 v[132:133], v[40:41], v[40:41]
    v_pk_mul_f32 v[134:135], v[42:43], v[42:43]
    v_pk_fma_f32 v[128:129], v[128:129], s[40:41], v[242:243]
    v_pk_fma_f32 v[130:131], v[130:131], s[40:41], v[242:243]
    v_pk_fma_f32 v[132:133], v[132:133], s[40:41], v[242:243]
    v_pk_fma_f32 v[134:135], v[134:135], s[40:41], v[242:243]
    v_pk_mul_f32 v[128:129], v[128:129], v[24:25]
    v_pk_mul_f32 v[130:131], v[130:131], v[26:27]
    v_pk_mul_f32 v[132:133], v[132:133], v[40:41]
    v_pk_mul_f32 v[134:135], v[134:135], v[42:43]
    v_exp_f32 v128, v128
    v_exp_f32 v129, v129
    v_exp_f32 v130, v130
    v_exp_f32 v131, v131
    v_exp_f32 v132, v132
    v_exp_f32 v133, v133
    v_exp_f32 v134, v134
    v_exp_f32 v135, v135
    v_pk_add_f32 v[128:129], v[128:129], 1.0 op_sel_hi:[1,0]
    v_pk_add_f32 v[130:131], v[130:131], 1.0 op_sel_hi:[1,0]
    v_pk_add_f32 v[132:133], v[132:133], 1.0 op_sel_hi:[1,0]
    v_pk_add_f32 v[134:135], v[134:135], 1.0 op_sel_hi:[1,0]
    v_rcp_f32 v128, v128
    v_rcp_f32 v129, v129
    v_rcp_f32 v130, v130
    v_rcp_f32 v131, v131
    v_rcp_f32 v132, v132
    v_rcp_f32 v133, v133
    v_rcp_f32 v134, v134
    v_rcp_f32 v135, v135
    v_pk_mul_f32 v[24:25], v[24:25], v[128:129]
    v_pk_mul_f32 v[26:27], v[26:27], v[130:131]
    v_pk_mul_f32 v[40:41], v[40:41], v[132:133]
    v_pk_mul_f32 v[42:43], v[42:43], v[134:135]
    v_cvt_pk_bf16_f32 v152, v24, v25
    v_cvt_pk_bf16_f32 v153, v26, v27
    v_cvt_pk_bf16_f32 v154, v40, v41
    v_cvt_pk_bf16_f32 v155, v42, v43
    v_permlane16_swap_b32 v148, v150
    v_permlane16_swap_b32 v149, v151
    v_pk_fma_f32 v[28:29], v[28:29], v[240:241], v[136:137] op_sel:[0,1,0] op_sel_hi:[1,1,1]
    v_pk_fma_f32 v[30:31], v[30:31], v[240:241], v[138:139] op_sel:[0,1,0] op_sel_hi:[1,1,1]
    v_pk_fma_f32 v[44:45], v[44:45], v[240:241], v[140:141] op_sel:[0,1,0] op_sel_hi:[1,1,1]
    v_pk_fma_f32 v[46:47], v[46:47], v[240:241], v[142:143] op_sel:[0,1,0] op_sel_hi:[1,1,1]
    s_lshl_b32 s42, s24, 4
    s_lshl_b32 s43, s3, 2
    s_add_u32 s42, s42, s43
    s_mul_i32 s42, s42, 114688
    s_mul_i32 s43, s25, 3584
    s_add_u32 s42, s42, s43
    s_add_u32 s50, s42, 17825792
    s_add_u32 s51, s50, 114688
    s_add_u32 s46, s50, 229376
    s_add_u32 s47, s50, 344064
    v_and_b32 v14, 15, v0
    v_lshrrev_b32 v15, 5, v0
    v_lshl_add_u32 v14, v15, 4, v14
    v_lshlrev_b32 v14, 4, v14
    v_bfe_u32 v15, v0, 4, 1
    v_lshl_add_u32 v244, v15, 9, v14
    v_lshl_add_u32 v245, v15, 3, v14
    s_and_b32 s34, s2, 7
    s_lshl_b32 s34, s34, 2
    s_bfe_u32 s35, s2, 0x20003
    s_add_u32 s24, s34, s35
    s_lshr_b32 s25, s2, 5
    s_lshl_b32 s59, s25, 5
    s_add_u32 s59, s59, s24
    s_lshl_b32 s59, s59, 2
    s_add_u32 s59, s59, 53479424
    v_lshlrev_b32 v1, 4, v0
    s_lshl_b32 s34, s24, 6
    s_lshr_b32 s35, s3, 1
    s_lshl_b32 s35, s35, 5
    s_add_u32 s34, s34, s35
    s_lshl_b32 s34, s34, 11
    s_add_u32 s26, s34, 9437184
    s_add_u32 s27, s34, 13631488
    s_lshl_b32 s34, s24, 6
    s_lshl_b32 s35, s25, 3
    s_add_u32 s34, s34, s35
    s_and_b32 s35, s3, 1
    s_lshl_b32 s35, s35, 2
    s_add_u32 s34, s34, s35
    s_lshl_b32 s34, s34, 11
    s_add_u32 s32, s34, 5242880
    v_pk_mul_f32 v[128:129], v[28:29], v[28:29]
    v_pk_mul_f32 v[130:131], v[30:31], v[30:31]
    v_pk_mul_f32 v[132:133], v[44:45], v[44:45]
    v_pk_mul_f32 v[134:135], v[46:47], v[46:47]
    v_pk_fma_f32 v[128:129], v[128:129], s[40:41], v[242:243]
    v_pk_fma_f32 v[130:131], v[130:131], s[40:41], v[242:243]
    v_pk_fma_f32 v[132:133], v[132:133], s[40:41], v[242:243]
    v_pk_fma_f32 v[134:135], v[134:135], s[40:41], v[242:243]
    v_pk_mul_f32 v[128:129], v[128:129], v[28:29]
    v_pk_mul_f32 v[130:131], v[130:131], v[30:31]
    v_pk_mul_f32 v[132:133], v[132:133], v[44:45]
    v_pk_mul_f32 v[134:135], v[134:135], v[46:47]
    v_exp_f32 v128, v128
    v_exp_f32 v129, v129
    v_exp_f32 v130, v130
    v_exp_f32 v131, v131
    v_exp_f32 v132, v132
    v_exp_f32 v133, v133
    v_exp_f32 v134, v134
    v_exp_f32 v135, v135
    v_pk_add_f32 v[128:129], v[128:129], 1.0 op_sel_hi:[1,0]
    v_pk_add_f32 v[130:131], v[130:131], 1.0 op_sel_hi:[1,0]
    v_pk_add_f32 v[132:133], v[132:133], 1.0 op_sel_hi:[1,0]
    v_pk_add_f32 v[134:135], v[134:135], 1.0 op_sel_hi:[1,0]
    v_rcp_f32 v128, v128
    v_rcp_f32 v129, v129
    v_rcp_f32 v130, v130
    v_rcp_f32 v131, v131
    v_rcp_f32 v132, v132
    v_rcp_f32 v133, v133
    v_rcp_f32 v134, v134
    v_rcp_f32 v135, v135
    v_pk_mul_f32 v[28:29], v[28:29], v[128:129]
    v_pk_mul_f32 v[30:31], v[30:31], v[130:131]
    v_pk_mul_f32 v[44:45], v[44:45], v[132:133]
    v_pk_mul_f32 v[46:47], v[46:47], v[134:135]
    v_cvt_pk_bf16_f32 v156, v28, v29
    v_cvt_pk_bf16_f32 v157, v30, v31
    v_cvt_pk_bf16_f32 v158, v44, v45
    v_cvt_pk_bf16_f32 v159, v46, v47
    v_permlane16_swap_b32 v152, v154
    v_permlane16_swap_b32 v153, v155
    s_waitcnt vmcnt(0)
    s_barrier
    s_cmp_lg_u32 s3, 0
    s_cbranch_scc1 L_sig1
    v_mov_b32 v14, s61
    v_mov_b32 v15, 0
    s_mov_b64 exec, 1
    buffer_store_dword v14, v15, s[8:11], s57 offen sc1
    s_mov_b64 exec, -1
L_sig1:
    v_lshlrev_b32 v136, 16, v228
    v_and_b32 v137, 0xffff0000, v228
    v_lshlrev_b32 v138, 16, v229
    v_and_b32 v139, 0xffff0000, v229
    v_lshlrev_b32 v140, 16, v230
    v_and_b32 v141, 0xffff0000, v230
    v_lshlrev_b32 v142, 16, v231
    v_and_b32 v143, 0xffff0000, v231
    v_pk_fma_f32 v[48:49], v[48:49], v[238:239], v[136:137] op_sel_hi:[1,0,1]
    v_pk_fma_f32 v[50:51], v[50:51], v[238:239], v[138:139] op_sel_hi:[1,0,1]
    v_pk_fma_f32 v[64:65], v[64:65], v[238:239], v[140:141] op_sel_hi:[1,0,1]
    v_pk_fma_f32 v[66:67], v[66:67], v[238:239], v[142:143] op_sel_hi:[1,0,1]
    v_pk_mul_f32 v[128:129], v[48:49], v[48:49]
    v_pk_mul_f32 v[130:131], v[50:51], v[50:51]
    v_pk_mul_f32 v[132:133], v[64:65], v[64:65]
    v_pk_mul_f32 v[134:135], v[66:67], v[66:67]
    v_pk_fma_f32 v[128:129], v[128:129], s[40:41], v[242:243]
    v_pk_fma_f32 v[130:131], v[130:131], s[40:41], v[242:243]
    v_pk_fma_f32 v[132:133], v[132:133], s[40:41], v[242:243]
    v_pk_fma_f32 v[134:135], v[134:135], s[40:41], v[242:243]
    v_pk_mul_f32 v[128:129], v[128:129], v[48:49]
    v_pk_mul_f32 v[130:131], v[130:131], v[50:51]
    v_pk_mul_f32 v[132:133], v[132:133], v[64:65]
    v_pk_mul_f32 v[134:135], v[134:135], v[66:67]
    v_exp_f32 v128, v128
    v_exp_f32 v129, v129
    v_exp_f32 v130, v130
    v_exp_f32 v131, v131
    v_exp_f32 v132, v132
    v_exp_f32 v133, v133
    v_exp_f32 v134, v134
    v_exp_f32 v135, v135
    v_pk_add_f32 v[128:129], v[128:129], 1.0 op_sel_hi:[1,0]
    v_pk_add_f32 v[130:131], v[130:131], 1.0 op_sel_hi:[1,0]
    v_pk_add_f32 v[132:133], v[132:133], 1.0 op_sel_hi:[1,0]
    v_pk_add_f32 v[134:135], v[134:135], 1.0 op_sel_hi:[1,0]
    v_rcp_f32 v128, v128
    v_rcp_f32 v129, v129
    v_rcp_f32 v130, v130
    v_rcp_f32 v131, v131
    v_rcp_f32 v132, v132
    v_rcp_f32 v133, v133
    v_rcp_f32 v134, v134
    v_rcp_f32 v135, v135
    v_pk_mul_f32 v[48:49], v[48:49], v[128:129]
    v_pk_mul_f32 v[50:51], v[50:51], v[130:131]
    v_pk_mul_f32 v[64:65], v[64:65], v[132:133]
    v_pk_mul_f32 v[66:67], v[66:67], v[134:135]
    v_cvt_pk_bf16_f32 v160, v48, v49
    v_cvt_pk_bf16_f32 v161, v50, v51
    v_cvt_pk_bf16_f32 v162, v64, v65
    v_cvt_pk_bf16_f32 v163, v66, v67
    v_permlane16_swap_b32 v156, v158
    v_permlane16_swap_b32 v157, v159
    v_pk_fma_f32 v[52:53], v[52:53], v[238:239], v[136:137] op_sel:[0,1,0] op_sel_hi:[1,1,1]
    v_pk_fma_f32 v[54:55], v[54:55], v[238:239], v[138:139] op_sel:[0,1,0] op_sel_hi:[1,1,1]
    v_pk_fma_f32 v[68:69], v[68:69], v[238:239], v[140:141] op_sel:[0,1,0] op_sel_hi:[1,1,1]
    v_pk_fma_f32 v[70:71], v[70:71], v[238:239], v[142:143] op_sel:[0,1,0] op_sel_hi:[1,1,1]
    v_pk_mul_f32 v[128:129], v[52:53], v[52:53]
    v_pk_mul_f32 v[130:131], v[54:55], v[54:55]
    v_pk_mul_f32 v[132:133], v[68:69], v[68:69]
    v_pk_mul_f32 v[134:135], v[70:71], v[70:71]
    v_pk_fma_f32 v[128:129], v[128:129], s[40:41], v[242:243]
    v_pk_fma_f32 v[130:131], v[130:131], s[40:41], v[242:243]
    v_pk_fma_f32 v[132:133], v[132:133], s[40:41], v[242:243]
    v_pk_fma_f32 v[134:135], v[134:135], s[40:41], v[242:243]
    v_pk_mul_f32 v[128:129], v[128:129], v[52:53]
    v_pk_mul_f32 v[130:131], v[130:131], v[54:55]
    v_pk_mul_f32 v[132:133], v[132:133], v[68:69]
    v_pk_mul_f32 v[134:135], v[134:135], v[70:71]
    v_exp_f32 v128, v128
    v_exp_f32 v129, v129
    v_exp_f32 v130, v130
    v_exp_f32 v131, v131
    v_exp_f32 v132, v132
    v_exp_f32 v133, v133
    v_exp_f32 v134, v134
    v_exp_f32 v135, v135
    v_pk_add_f32 v[128:129], v[128:129], 1.0 op_sel_hi:[1,0]
    v_pk_add_f32 v[130:131], v[130:131], 1.0 op_sel_hi:[1,0]
    v_pk_add_f32 v[132:133], v[132:133], 1.0 op_sel_hi:[1,0]
    v_pk_add_f32 v[134:135], v[134:135], 1.0 op_sel_hi:[1,0]
    v_rcp_f32 v128, v128
    v_rcp_f32 v129, v129
    v_rcp_f32 v130, v130
    v_rcp_f32 v131, v131
    v_rcp_f32 v132, v132
    v_rcp_f32 v133, v133
    v_rcp_f32 v134, v134
    v_rcp_f32 v135, v135
    v_pk_mul_f32 v[52:53], v[52:53], v[128:129]
    v_pk_mul_f32 v[54:55], v[54:55], v[130:131]
    v_pk_mul_f32 v[68:69], v[68:69], v[132:133]
    v_pk_mul_f32 v[70:71], v[70:71], v[134:135]
    v_cvt_pk_bf16_f32 v164, v52, v53
    v_cvt_pk_bf16_f32 v165, v54, v55
    v_cvt_pk_bf16_f32 v166, v68, v69
    v_cvt_pk_bf16_f32 v167, v70, v71
    v_permlane16_swap_b32 v160, v162
    v_permlane16_swap_b32 v161, v163
    v_pk_fma_f32 v[56:57], v[56:57], v[240:241], v[136:137] op_sel_hi:[1,0,1]
    v_pk_fma_f32 v[58:59], v[58:59], v[240:241], v[138:139] op_sel_hi:[1,0,1]
    v_pk_fma_f32 v[72:73], v[72:73], v[240:241], v[140:141] op_sel_hi:[1,0,1]
    v_pk_fma_f32 v[74:75], v[74:75], v[240:241], v[142:143] op_sel_hi:[1,0,1]
    v_pk_mul_f32 v[128:129], v[56:57], v[56:57]
    v_pk_mul_f32 v[130:131], v[58:59], v[58:59]
    v_pk_mul_f32 v[132:133], v[72:73], v[72:73]
    v_pk_mul_f32 v[134:135], v[74:75], v[74:75]
    v_pk_fma_f32 v[128:129], v[128:129], s[40:41], v[242:243]
    v_pk_fma_f32 v[130:131], v[130:131], s[40:41], v[242:243]
    v_pk_fma_f32 v[132:133], v[132:133], s[40:41], v[242:243]
    v_pk_fma_f32 v[134:135], v[134:135], s[40:41], v[242:243]
    v_pk_mul_f32 v[128:129], v[128:129], v[56:57]
    v_pk_mul_f32 v[130:131], v[130:131], v[58:59]
    v_pk_mul_f32 v[132:133], v[132:133], v[72:73]
    v_pk_mul_f32 v[134:135], v[134:135], v[74:75]
    v_exp_f32 v128, v128
    v_exp_f32 v129, v129
    v_exp_f32 v130, v130
    v_exp_f32 v131, v131
    v_exp_f32 v132, v132
    v_exp_f32 v133, v133
    v_exp_f32 v134, v134
    v_exp_f32 v135, v135
    v_pk_add_f32 v[128:129], v[128:129], 1.0 op_sel_hi:[1,0]
    v_pk_add_f32 v[130:131], v[130:131], 1.0 op_sel_hi:[1,0]
    v_pk_add_f32 v[132:133], v[132:133], 1.0 op_sel_hi:[1,0]
    v_pk_add_f32 v[134:135], v[134:135], 1.0 op_sel_hi:[1,0]
    v_rcp_f32 v128, v128
    v_rcp_f32 v129, v129
    v_rcp_f32 v130, v130
    v_rcp_f32 v131, v131
    v_rcp_f32 v132, v132
    v_rcp_f32 v133, v133
    v_rcp_f32 v134, v134
    v_rcp_f32 v135, v135
    v_pk_mul_f32 v[56:57], v[56:57], v[128:129]
    v_pk_mul_f32 v[58:59], v[58:59], v[130:131]
    v_pk_mul_f32 v[72:73], v[72:73], v[132:133]
    v_pk_mul_f32 v[74:75], v[74:75], v[134:135]
    v_cvt_pk_bf16_f32 v168, v56, v57
    v_cvt_pk_bf16_f32 v169, v58, v59
    v_cvt_pk_bf16_f32 v170, v72, v73
    v_cvt_pk_bf16_f32 v171, v74, v75
    v_permlane16_swap_b32 v164, v166
    v_permlane16_swap_b32 v165, v167
    v_pk_fma_f32 v[60:61], v[60:61], v[240:241], v[136:137] op_sel:[0,1,0] op_sel_hi:[1,1,1]
    v_pk_fma_f32 v[62:63], v[62:63], v[240:241], v[138:139] op_sel:[0,1,0] op_sel_hi:[1,1,1]
    v_pk_fma_f32 v[76:77], v[76:77], v[240:241], v[140:141] op_sel:[0,1,0] op_sel_hi:[1,1,1]
    v_pk_fma_f32 v[78:79], v[78:79], v[240:241], v[142:143] op_sel:[0,1,0] op_sel_hi:[1,1,1]
    v_pk_mul_f32 v[128:129], v[60:61], v[60:61]
    v_pk_mul_f32 v[130:131], v[62:63], v[62:63]
    v_pk_mul_f32 v[132:133], v[76:77], v[76:77]
    v_pk_mul_f32 v[134:135], v[78:79], v[78:79]
    v_pk_fma_f32 v[128:129], v[128:129], s[40:41], v[242:243]
    v_pk_fma_f32 v[130:131], v[130:131], s[40:41], v[242:243]
    v_pk_fma_f32 v[132:133], v[132:133], s[40:41], v[242:243]
    v_pk_fma_f32 v[134:135], v[134:135], s[40:41], v[242:243]
    v_pk_mul_f32 v[128:129], v[128:129], v[60:61]
    v_pk_mul_f32 v[130:131], v[130:131], v[62:63]
    v_pk_mul_f32 v[132:133], v[132:133], v[76:77]
    v_pk_mul_f32 v[134:135], v[134:135], v[78:79]
    v_exp_f32 v128, v128
    v_exp_f32 v129, v129
    v_exp_f32 v130, v130
    v_exp_f32 v131, v131
    v_exp_f32 v132, v132
    v_exp_f32 v133, v133
    v_exp_f32 v134, v134
    v_exp_f32 v135, v135
    v_pk_add_f32 v[128:129], v[128:129], 1.0 op_sel_hi:[1,0]
    v_pk_add_f32 v[130:131], v[130:131], 1.0 op_sel_hi:[1,0]
    v_pk_add_f32 v[132:133], v[132:133], 1.0 op_sel_hi:[1,0]
    v_pk_add_f32 v[134:135], v[134:135], 1.0 op_sel_hi:[1,0]
    v_rcp_f32 v128, v128
    v_rcp_f32 v129, v129
    v_rcp_f32 v130, v130
    v_rcp_f32 v131, v131
    v_rcp_f32 v132, v132
L_pad_4:
    s_cbranch_execz L_pad_7
    v_rcp_f32 v133, v133
    v_rcp_f32 v134, v134
    v_rcp_f32 v135, v135
    v_pk_mul_f32 v[60:61], v[60:61], v[128:129]
    v_pk_mul_f32 v[62:63], v[62:63], v[130:131]
    v_pk_mul_f32 v[76:77], v[76:77], v[132:133]
    v_pk_mul_f32 v[78:79], v[78:79], v[134:135]
    v_cvt_pk_bf16_f32 v172, v60, v61
    v_cvt_pk_bf16_f32 v173, v62, v63
    v_cvt_pk_bf16_f32 v174, v76, v77
    v_cvt_pk_bf16_f32 v175, v78, v79
    v_permlane16_swap_b32 v168, v170
    v_permlane16_swap_b32 v169, v171
    s_lshl_b32 s36, s24, 5
    s_add_u32 s36, s36, 53477376
    v_min_u32 v15, 7, v0
    v_lshlrev_b32 v15, 2, v15
    buffer_load_dword v14, v15, s[8:11], s36 offen sc1
    v_lshlrev_b32 v136, 16, v232
    v_and_b32 v137, 0xffff0000, v232
    v_lshlrev_b32 v138, 16, v233
    v_and_b32 v139, 0xffff0000, v233
    v_lshlrev_b32 v140, 16, v234
    v_and_b32 v141, 0xffff0000, v234
    v_lshlrev_b32 v142, 16, v235
    v_and_b32 v143, 0xffff0000, v235
    v_pk_fma_f32 v[80:81], v[80:81], v[238:239], v[136:137] op_sel_hi:[1,0,1]
    v_pk_fma_f32 v[82:83], v[82:83], v[238:239], v[138:139] op_sel_hi:[1,0,1]
    v_pk_fma_f32 v[96:97], v[96:97], v[238:239], v[140:141] op_sel_hi:[1,0,1]
    v_pk_fma_f32 v[98:99], v[98:99], v[238:239], v[142:143] op_sel_hi:[1,0,1]
    v_pk_mul_f32 v[128:129], v[80:81], v[80:81]
    v_pk_mul_f32 v[130:131], v[82:83], v[82:83]
    v_pk_mul_f32 v[132:133], v[96:97], v[96:97]
    v_pk_mul_f32 v[134:135], v[98:99], v[98:99]
    v_pk_fma_f32 v[128:129], v[128:129], s[40:41], v[242:243]
    v_pk_fma_f32 v[130:131], v[130:131], s[40:41], v[242:243]
    v_pk_fma_f32 v[132:133], v[132:133], s[40:41], v[242:243]
    v_pk_fma_f32 v[134:135], v[134:135], s[40:41], v[242:243]
    v_pk_mul_f32 v[128:129], v[128:129], v[80:81]
    v_pk_mul_f32 v[130:131], v[130:131], v[82:83]
    v_pk_mul_f32 v[132:133], v[132:133], v[96:97]
    v_pk_mul_f32 v[134:135], v[134:135], v[98:99]
    v_exp_f32 v128, v128
    v_exp_f32 v129, v129
    v_exp_f32 v130, v130
    v_exp_f32 v131, v131
    v_exp_f32 v132, v132
    v_exp_f32 v133, v133
    v_exp_f32 v134, v134
    v_exp_f32 v135, v135
    v_pk_add_f32 v[128:129], v[128:129], 1.0 op_sel_hi:[1,0]
    v_pk_add_f32 v[130:131], v[130:131], 1.0 op_sel_hi:[1,0]
    v_pk_add_f32 v[132:133], v[132:133], 1.0 op_sel_hi:[1,0]
    v_pk_add_f32 v[134:135], v[134:135], 1.0 op_sel_hi:[1,0]
    v_rcp_f32 v128, v128
    v_rcp_f32 v129, v129
    v_rcp_f32 v130, v130
    v_rcp_f32 v131, v131
    v_rcp_f32 v132, v132
    v_rcp_f32 v133, v133
    v_rcp_f32 v134, v134
    v_rcp_f32 v135, v135
    v_pk_mul_f32 v[80:81], v[80:81], v[128:129]
    v_pk_mul_f32 v[82:83], v[82:83], v[130:131]
    v_pk_mul_f32 v[96:97], v[96:97], v[132:133]
    v_pk_mul_f32 v[98:99], v[98:99], v[134:135]
    v_cvt_pk_bf16_f32 v176, v80, v81
    v_cvt_pk_bf16_f32 v177, v82, v83
    v_cvt_pk_bf16_f32 v178, v96, v97
    v_cvt_pk_bf16_f32 v179, v98, v99
    v_permlane16_swap_b32 v172, v174
    v_permlane16_swap_b32 v173, v175
    v_pk_fma_f32 v[84:85], v[84:85], v[238:239], v[136:137] op_sel:[0,1,0] op_sel_hi:[1,1,1]
    v_pk_fma_f32 v[86:87], v[86:87], v[238:239], v[138:139] op_sel:[0,1,0] op_sel_hi:[1,1,1]
    v_pk_fma_f32 v[100:101], v[100:101], v[238:239], v[140:141] op_sel:[0,1,0] op_sel_hi:[1,1,1]
    v_pk_fma_f32 v[102:103], v[102:103], v[238:239], v[142:143] op_sel:[0,1,0] op_sel_hi:[1,1,1]
    v_pk_mul_f32 v[128:129], v[84:85], v[84:85]
    v_pk_mul_f32 v[130:131], v[86:87], v[86:87]
    v_pk_mul_f32 v[132:133], v[100:101], v[100:101]
    v_pk_mul_f32 v[134:135], v[102:103], v[102:103]
    v_pk_fma_f32 v[128:129], v[128:129], s[40:41], v[242:243]
    v_pk_fma_f32 v[130:131], v[130:131], s[40:41], v[242:243]
    v_pk_fma_f32 v[132:133], v[132:133], s[40:41], v[242:243]
    v_pk_fma_f32 v[134:135], v[134:135], s[40:41], v[242:243]
    v_pk_mul_f32 v[128:129], v[128:129], v[84:85]
    v_pk_mul_f32 v[130:131], v[130:131], v[86:87]
    v_pk_mul_f32 v[132:133], v[132:133], v[100:101]
    v_pk_mul_f32 v[134:135], v[134:135], v[102:103]
    v_exp_f32 v128, v128
    v_exp_f32 v129, v129
    v_exp_f32 v130, v130
    v_exp_f32 v131, v131
    v_exp_f32 v132, v132
    v_exp_f32 v133, v133
    v_exp_f32 v134, v134
    v_exp_f32 v135, v135
    v_pk_add_f32 v[128:129], v[128:129], 1.0 op_sel_hi:[1,0]
    v_pk_add_f32 v[130:131], v[130:131], 1.0 op_sel_hi:[1,0]
    v_pk_add_f32 v[132:133], v[132:133], 1.0 op_sel_hi:[1,0]
    v_pk_add_f32 v[134:135], v[134:135], 1.0 op_sel_hi:[1,0]
    v_rcp_f32 v128, v128
    v_rcp_f32 v129, v129
    v_rcp_f32 v130, v130
    v_rcp_f32 v131, v131
    v_rcp_f32 v132, v132
    v_rcp_f32 v133, v133
    v_rcp_f32 v134, v134
    v_rcp_f32 v135, v135
    v_pk_mul_f32 v[84:85], v[84:85], v[128:129]
    v_pk_mul_f32 v[86:87], v[86:87], v[130:131]
    v_pk_mul_f32 v[100:101], v[100:101], v[132:133]
    v_pk_mul_f32 v[102:103], v[102:103], v[134:135]
    v_cvt_pk_bf16_f32 v180, v84, v85
    v_cvt_pk_bf16_f32 v181, v86, v87
    v_cvt_pk_bf16_f32 v182, v100, v101
    v_cvt_pk_bf16_f32 v183, v102, v103
    v_permlane16_swap_b32 v176, v178
    v_permlane16_swap_b32 v177, v179
    v_pk_fma_f32 v[88:89], v[88:89], v[240:241], v[136:137] op_sel_hi:[1,0,1]
    v_pk_fma_f32 v[90:91], v[90:91], v[240:241], v[138:139] op_sel_hi:[1,0,1]
    v_pk_fma_f32 v[104:105], v[104:105], v[240:241], v[140:141] op_sel_hi:[1,0,1]
    v_pk_fma_f32 v[106:107], v[106:107], v[240:241], v[142:143] op_sel_hi:[1,0,1]
    v_pk_mul_f32 v[128:129], v[88:89], v[88:89]
    v_pk_mul_f32 v[130:131], v[90:91], v[90:91]
    v_pk_mul_f32 v[132:133], v[104:105], v[104:105]
    v_pk_mul_f32 v[134:135], v[106:107], v[106:107]
    v_pk_fma_f32 v[128:129], v[128:129], s[40:41], v[242:243]
    v_pk_fma_f32 v[130:131], v[130:131], s[40:41], v[242:243]
    v_pk_fma_f32 v[132:133], v[132:133], s[40:41], v[242:243]
    v_pk_fma_f32 v[134:135], v[134:135], s[40:41], v[242:243]
    v_pk_mul_f32 v[128:129], v[128:129], v[88:89]
    v_pk_mul_f32 v[130:131], v[130:131], v[90:91]
    v_pk_mul_f32 v[132:133], v[132:133], v[104:105]
    v_pk_mul_f32 v[134:135], v[134:135], v[106:107]
    v_exp_f32 v128, v128
    v_exp_f32 v129, v129
    v_exp_f32 v130, v130
    v_exp_f32 v131, v131
    v_exp_f32 v132, v132
    v_exp_f32 v133, v133
    v_exp_f32 v134, v134
    v_exp_f32 v135, v135
    v_pk_add_f32 v[128:129], v[128:129], 1.0 op_sel_hi:[1,0]
    v_pk_add_f32 v[130:131], v[130:131], 1.0 op_sel_hi:[1,0]
    v_pk_add_f32 v[132:133], v[132:133], 1.0 op_sel_hi:[1,0]
    v_pk_add_f32 v[134:135], v[134:135], 1.0 op_sel_hi:[1,0]
    v_rcp_f32 v128, v128
    v_rcp_f32 v129, v129
    v_rcp_f32 v130, v130
    v_rcp_f32 v131, v131
    v_rcp_f32 v132, v132
    v_rcp_f32 v133, v133
    v_rcp_f32 v134, v134
    v_rcp_f32 v135, v135
    v_pk_mul_f32 v[88:89], v[88:89], v[128:129]
    v_pk_mul_f32 v[90:91], v[90:91], v[130:131]
    v_pk_mul_f32 v[104:105], v[104:105], v[132:133]
    v_pk_mul_f32 v[106:107], v[106:107], v[134:135]
    v_cvt_pk_bf16_f32 v184, v88, v89
    v_cvt_pk_bf16_f32 v185, v90, v91
    v_cvt_pk_bf16_f32 v186, v104, v105
    v_cvt_pk_bf16_f32 v187, v106, v107
    v_permlane16_swap_b32 v180, v182
    v_permlane16_swap_b32 v181, v183
    v_pk_fma_f32 v[92:93], v[92:93], v[240:241], v[136:137] op_sel:[0,1,0] op_sel_hi:[1,1,1]
    v_pk_fma_f32 v[94:95], v[94:95], v[240:241], v[138:139] op_sel:[0,1,0] op_sel_hi:[1,1,1]
    v_pk_fma_f32 v[108:109], v[108:109], v[240:241], v[140:141] op_sel:[0,1,0] op_sel_hi:[1,1,1]
    v_pk_fma_f32 v[110:111], v[110:111], v[240:241], v[142:143] op_sel:[0,1,0] op_sel_hi:[1,1,1]
    v_pk_mul_f32 v[128:129], v[92:93], v[92:93]
    v_pk_mul_f32 v[130:131], v[94:95], v[94:95]
    v_pk_mul_f32 v[132:133], v[108:109], v[108:109]
    v_pk_mul_f32 v[134:135], v[110:111], v[110:111]
    v_pk_fma_f32 v[128:129], v[128:129], s[40:41], v[242:243]
    v_pk_fma_f32 v[130:131], v[130:131], s[40:41], v[242:243]
    v_pk_fma_f32 v[132:133], v[132:133], s[40:41], v[242:243]
    v_pk_fma_f32 v[134:135], v[134:135], s[40:41], v[242:243]
    v_pk_mul_f32 v[128:129], v[128:129], v[92:93]
    v_pk_mul_f32 v[130:131], v[130:131], v[94:95]
    v_pk_mul_f32 v[132:133], v[132:133], v[108:109]
    v_pk_mul_f32 v[134:135], v[134:135], v[110:111]
    v_exp_f32 v128, v128
    v_exp_f32 v129, v129
    v_exp_f32 v130, v130
    v_exp_f32 v131, v131
    v_exp_f32 v132, v132
    v_exp_f32 v133, v133
    v_exp_f32 v134, v134
    v_exp_f32 v135, v135
    v_pk_add_f32 v[128:129], v[128:129], 1.0 op_sel_hi:[1,0]
    v_pk_add_f32 v[130:131], v[130:131], 1.0 op_sel_hi:[1,0]
    v_pk_add_f32 v[132:133], v[132:133], 1.0 op_sel_hi:[1,0]
    v_pk_add_f32 v[134:135], v[134:135], 1.0 op_sel_hi:[1,0]
    v_rcp_f32 v128, v128
    v_rcp_f32 v129, v129
    v_rcp_f32 v130, v130
    v_rcp_f32 v131, v131
    v_rcp_f32 v132, v132
    v_rcp_f32 v133, v133
    v_rcp_f32 v134, v134
    v_rcp_f32 v135, v135
    v_pk_mul_f32 v[92:93], v[92:93], v[128:129]
    v_pk_mul_f32 v[94:95], v[94:95], v[130:131]
    v_pk_mul_f32 v[108:109], v[108:109], v[132:133]
    v_pk_mul_f32 v[110:111], v[110:111], v[134:135]
    v_cvt_pk_bf16_f32 v188, v92, v93
    v_cvt_pk_bf16_f32 v189, v94, v95
    v_cvt_pk_bf16_f32 v190, v108, v109
    v_cvt_pk_bf16_f32 v191, v110, v111
    v_permlane16_swap_b32 v184, v186
    v_permlane16_swap_b32 v185, v187
    s_nop 1
    v_permlane16_swap_b32 v188, v190
    v_permlane16_swap_b32 v189, v191
    s_waitcnt vmcnt(0)
    v_cmp_ne_u32 vcc, s61, v14
    s_nop 0
    s_cbranch_vccz L_apoll2_ok
    s_mov_b32 s37, 0x40000
L_apoll2:
    s_sleep 1
    buffer_load_dword v14, v15, s[8:11], s36 offen sc1
    s_waitcnt vmcnt(0)
    v_cmp_ne_u32 vcc, s61, v14
    s_sub_u32 s37, s37, 1
    s_cbranch_scc1 L_apoll2_ok
    s_nop 0
    s_cbranch_vccnz L_apoll2
L_apoll2_ok:
    buffer_load_dwordx4 a[96:99], v1, s[8:11], s26 offen offset:0 sc1
    buffer_load_dwordx4 a[100:103], v1, s[8:11], s26 offen offset:1024 sc1
    s_and_b32 s35, s3, 2
    s_add_u32 s35, s35, 0
    s_and_b32 s35, s35, 3
    s_lshl_b32 s35, s35, 11
    s_add_u32 s38, s35, s32
    buffer_load_dwordx4 a[64:67], v1, s[8:11], s38 offen offset:0 sc1
    buffer_load_dwordx4 a[68:71], v1, s[8:11], s38 offen offset:1024 sc1
    s_and_b32 s35, s3, 2
    s_add_u32 s35, s35, 1
    s_and_b32 s35, s35, 3
    s_lshl_b32 s35, s35, 11
    s_add_u32 s38, s35, s32
    buffer_load_dwordx4 a[72:75], v1, s[8:11], s38 offen offset:0 sc1
    buffer_load_dwordx4 a[76:79], v1, s[8:11], s38 offen offset:1024 sc1
    buffer_load_dwordx4 a[104:107], v1, s[8:11], s27 offen offset:0 sc1
    buffer_load_dwordx4 a[108:111], v1, s[8:11], s27 offen offset:1024 sc1
    v_lshlrev_b32 v136, 16, v236
    v_and_b32 v137, 0xffff0000, v236
    v_lshlrev_b32 v138, 16, v237
    v_and_b32 v139, 0xffff0000, v237
    v_pk_fma_f32 v[112:113], v[112:113], v[238:239], v[136:137] op_sel_hi:[1,0,1]
    v_pk_fma_f32 v[114:115], v[114:115], v[238:239], v[138:139] op_sel_hi:[1,0,1]
    s_and_b32 s35, s3, 2
    s_add_u32 s35, s35, 2
    s_and_b32 s35, s35, 3
    s_lshl_b32 s35, s35, 11
    s_add_u32 s38, s35, s32
    buffer_load_dwordx4 a[80:83], v1, s[8:11], s38 offen offset:0 sc1
    v_pk_mul_f32 v[128:129], v[112:113], v[112:113]
    v_pk_mul_f32 v[130:131], v[114:115], v[114:115]
    v_pk_fma_f32 v[128:129], v[128:129], s[40:41], v[242:243]
    v_pk_fma_f32 v[130:131], v[130:131], s[40:41], v[242:243]
    v_pk_mul_f32 v[128:129], v[128:129], v[112:113]
    v_pk_mul_f32 v[130:131], v[130:131], v[114:115]
    v_exp_f32 v128, v128
    v_exp_f32 v129, v129
    v_exp_f32 v130, v130
    v_exp_f32 v131, v131
    v_pk_add_f32 v[128:129], v[128:129], 1.0 op_sel_hi:[1,0]
    v_pk_add_f32 v[130:131], v[130:131], 1.0 op_sel_hi:[1,0]
    v_rcp_f32 v128, v128
    v_rcp_f32 v129, v129
    v_rcp_f32 v130, v130
    v_rcp_f32 v131, v131
    v_pk_mul_f32 v[112:113], v[112:113], v[128:129]
    v_pk_mul_f32 v[114:115], v[114:115], v[130:131]
    buffer_load_dwordx4 a[84:87], v1, s[8:11], s38 offen offset:1024 sc1
    s_and_b32 s35, s3, 2
    s_add_u32 s35, s35, 3
    s_and_b32 s35, s35, 3
    s_lshl_b32 s35, s35, 11
    s_add_u32 s38, s35, s32
    buffer_load_dwordx4 a[88:91], v1, s[8:11], s38 offen offset:0 sc1
    v_cvt_pk_bf16_f32 v192, v112, v113
    v_cvt_pk_bf16_f32 v193, v114, v115
    v_pk_fma_f32 v[116:117], v[116:117], v[238:239], v[136:137] op_sel:[0,1,0] op_sel_hi:[1,1,1]
    v_pk_fma_f32 v[118:119], v[118:119], v[238:239], v[138:139] op_sel:[0,1,0] op_sel_hi:[1,1,1]
    buffer_load_dwordx4 a[92:95], v1, s[8:11], s38 offen offset:1024 sc1
    v_pk_mul_f32 v[128:129], v[116:117], v[116:117]
    v_pk_mul_f32 v[130:131], v[118:119], v[118:119]
    v_pk_fma_f32 v[128:129], v[128:129], s[40:41], v[242:243]
    v_pk_fma_f32 v[130:131], v[130:131], s[40:41], v[242:243]
    v_pk_mul_f32 v[128:129], v[128:129], v[116:117]
    v_pk_mul_f32 v[130:131], v[130:131], v[118:119]
    v_exp_f32 v128, v128
    v_exp_f32 v129, v129
    v_exp_f32 v130, v130
    v_exp_f32 v131, v131
    v_pk_add_f32 v[128:129], v[128:129], 1.0 op_sel_hi:[1,0]
    v_pk_add_f32 v[130:131], v[130:131], 1.0 op_sel_hi:[1,0]
    v_rcp_f32 v128, v128
    v_rcp_f32 v129, v129
    v_rcp_f32 v130, v130
    v_rcp_f32 v131, v131
    v_pk_mul_f32 v[116:117], v[116:117], v[128:129]
    v_pk_mul_f32 v[118:119], v[118:119], v[130:131]
    buffer_load_dwordx4 a[112:115], v1, s[8:11], s26 offen offset:2048 sc1
    buffer_load_dwordx4 a[116:119], v1, s[8:11], s26 offen offset:3072 sc1
    v_cvt_pk_bf16_f32 v194, v116, v117
    v_cvt_pk_bf16_f32 v195, v118, v119
    v_pk_fma_f32 v[120:121], v[120:121], v[240:241], v[136:137] op_sel_hi:[1,0,1]
    v_pk_fma_f32 v[122:123], v[122:123], v[240:241], v[138:139] op_sel_hi:[1,0,1]
    buffer_load_dwordx4 a[120:123], v1, s[8:11], s27 offen offset:2048 sc1
    v_pk_mul_f32 v[128:129], v[120:121], v[120:121]
    v_pk_mul_f32 v[130:131], v[122:123], v[122:123]
    v_pk_fma_f32 v[128:129], v[128:129], s[40:41], v[242:243]
    v_pk_fma_f32 v[130:131], v[130:131], s[40:41], v[242:243]
    v_pk_mul_f32 v[128:129], v[128:129], v[120:121]
    v_pk_mul_f32 v[130:131], v[130:131], v[122:123]
    v_exp_f32 v128, v128
    v_exp_f32 v129, v129
    v_exp_f32 v130, v130
    v_exp_f32 v131, v131
    v_pk_add_f32 v[128:129], v[128:129], 1.0 op_sel_hi:[1,0]
    v_pk_add_f32 v[130:131], v[130:131], 1.0 op_sel_hi:[1,0]
    v_rcp_f32 v128, v128
    v_rcp_f32 v129, v129
    v_rcp_f32 v130, v130
    v_rcp_f32 v131, v131
    v_pk_mul_f32 v[120:121], v[120:121], v[128:129]
    v_pk_mul_f32 v[122:123], v[122:123], v[130:131]
    buffer_load_dwordx4 a[124:127], v1, s[8:11], s27 offen offset:3072 sc1
    s_add_u32 s26, s26, 4096
    s_add_u32 s27, s27, 4096
    buffer_load_dwordx4 a[128:131], v1, s[8:11], s26 offen offset:0 sc1
    v_cvt_pk_bf16_f32 v196, v120, v121
    v_cvt_pk_bf16_f32 v197, v122, v123
    v_pk_fma_f32 v[124:125], v[124:125], v[240:241], v[136:137] op_sel:[0,1,0] op_sel_hi:[1,1,1]
    v_pk_fma_f32 v[126:127], v[126:127], v[240:241], v[138:139] op_sel:[0,1,0] op_sel_hi:[1,1,1]
    buffer_load_dwordx4 a[132:135], v1, s[8:11], s26 offen offset:1024 sc1
    v_pk_mul_f32 v[128:129], v[124:125], v[124:125]
    v_pk_mul_f32 v[130:131], v[126:127], v[126:127]
    v_pk_fma_f32 v[128:129], v[128:129], s[40:41], v[242:243]
    v_pk_fma_f32 v[130:131], v[130:131], s[40:41], v[242:243]
    v_pk_mul_f32 v[128:129], v[128:129], v[124:125]
    v_pk_mul_f32 v[130:131], v[130:131], v[126:127]
    v_exp_f32 v128, v128
    v_exp_f32 v129, v129
    v_exp_f32 v130, v130
    v_exp_f32 v131, v131
    v_pk_add_f32 v[128:129], v[128:129], 1.0 op_sel_hi:[1,0]
    v_pk_add_f32 v[130:131], v[130:131], 1.0 op_sel_hi:[1,0]
    v_rcp_f32 v128, v128
    v_rcp_f32 v129, v129
    v_rcp_f32 v130, v130
    v_rcp_f32 v131, v131
    v_pk_mul_f32 v[124:125], v[124:125], v[128:129]
    v_pk_mul_f32 v[126:127], v[126:127], v[130:131]
    buffer_load_dwordx4 a[136:139], v1, s[8:11], s27 offen offset:0 sc1
    buffer_load_dwordx4 a[140:143], v1, s[8:11], s27 offen offset:1024 sc1
    s_add_u32 s26, s26, 2048
    s_add_u32 s27, s27, 2048
    v_cvt_pk_bf16_f32 v198, v124, v125
    v_cvt_pk_bf16_f32 v199, v126, v127
    v_bfe_u32 v4, v0, 4, 1
    v_bfe_u32 v5, v0, 2, 1
    v_cmp_eq_u32 vcc, v4, v5
    v_mov_b32 v6, 0x3f803f80
    s_nop 0
    v_cndmask_b32 v80, 0, v6, vcc
    v_mov_b32 v81, v80
    v_mov_b32 v82, v80
    v_mov_b32 v83, v80
    s_mov_b32 s33, 0
    s_waitcnt vmcnt(16)
    v_mfma_f32_32x32x16_bf16 v[16:31], a[96:99], a[64:67], 0
    v_mfma_f32_32x32x16_bf16 v[16:31], a[100:103], a[68:71], v[16:31]
    s_waitcnt vmcnt(8)
    s_nop 7
    s_nop 3
    v_exp_f32 v16, v16
    v_mfma_f32_32x32x16_bf16 v[32:47], a[96:99], a[72:75], 0
    v_exp_f32 v17, v17
    v_exp_f32 v18, v18
    v_exp_f32 v19, v19
    v_cvt_pk_bf16_f32 v48, v16, v17
    v_mfma_f32_32x32x16_bf16 v[32:47], a[100:103], a[76:79], v[32:47]
    v_exp_f32 v20, v20
    v_exp_f32 v21, v21
    v_cvt_pk_bf16_f32 v49, v18, v19
    v_exp_f32 v22, v22
    v_exp_f32 v23, v23
    v_cvt_pk_bf16_f32 v50, v20, v21
    v_exp_f32 v24, v24
    v_exp_f32 v25, v25
    v_cvt_pk_bf16_f32 v51, v22, v23
    v_exp_f32 v26, v26
    v_exp_f32 v27, v27
    v_cvt_pk_bf16_f32 v52, v24, v25
    v_exp_f32 v28, v28
    v_exp_f32 v29, v29
    v_cvt_pk_bf16_f32 v53, v26, v27
    v_exp_f32 v30, v30
    v_exp_f32 v31, v31
    v_cvt_pk_bf16_f32 v54, v28, v29
    s_nop 0
    v_cvt_pk_bf16_f32 v55, v30, v31
    s_waitcnt vmcnt(12)
    v_exp_f32 v32, v32
    v_mfma_f32_32x32x16_bf16 v[16:31], a[96:99], a[80:83], 0
    v_exp_f32 v33, v33
    v_exp_f32 v34, v34
    v_exp_f32 v35, v35
    v_cvt_pk_bf16_f32 v56, v32, v33
    v_mfma_f32_32x32x16_bf16 a[0:15], a[104:107], v[48:51], 0
    buffer_load_dwordx4 a[144:147], v1, s[8:11], s26 offen offset:0 sc1
    v_exp_f32 v36, v36
    v_exp_f32 v37, v37
    v_cvt_pk_bf16_f32 v57, v34, v35
    v_exp_f32 v38, v38
    v_mfma_f32_32x32x16_bf16 v[16:31], a[100:103], a[84:87], v[16:31]
    v_exp_f32 v39, v39
    v_cvt_pk_bf16_f32 v58, v36, v37
    v_exp_f32 v40, v40
    v_exp_f32 v41, v41
    v_mfma_f32_16x16x32_bf16 v[64:67], v[80:83], v[48:51], 0
    v_cvt_pk_bf16_f32 v59, v38, v39
    v_exp_f32 v42, v42
    v_mfma_f32_32x32x16_bf16 a[0:15], a[108:111], v[52:55], a[0:15]
    v_exp_f32 v43, v43
    buffer_store_dwordx4 v[144:147], v244, s[8:11], s50 offen offset:0 sc1
    v_cvt_pk_bf16_f32 v60, v40, v41
    v_exp_f32 v44, v44
    v_exp_f32 v45, v45
    v_cvt_pk_bf16_f32 v61, v42, v43
    v_exp_f32 v46, v46
    v_exp_f32 v47, v47
    v_cvt_pk_bf16_f32 v62, v44, v45
    v_mfma_f32_16x16x32_bf16 v[64:67], v[80:83], v[52:55], v[64:67]
    v_cvt_pk_bf16_f32 v63, v46, v47
    v_exp_f32 v16, v16
    v_mfma_f32_32x32x16_bf16 v[32:47], a[96:99], a[88:91], 0
    v_exp_f32 v17, v17
    v_exp_f32 v18, v18
    v_exp_f32 v19, v19
    v_cvt_pk_bf16_f32 v48, v16, v17
    v_mfma_f32_32x32x16_bf16 a[16:31], a[104:107], v[56:59], 0
    buffer_load_dwordx4 a[148:151], v1, s[8:11], s26 offen offset:1024 sc1
    v_exp_f32 v20, v20
    v_exp_f32 v21, v21
    v_cvt_pk_bf16_f32 v49, v18, v19
    v_exp_f32 v22, v22
    v_mfma_f32_32x32x16_bf16 v[32:47], a[100:103], a[92:95], v[32:47]
    v_exp_f32 v23, v23
    v_cvt_pk_bf16_f32 v50, v20, v21
    v_exp_f32 v24, v24
    v_exp_f32 v25, v25
    v_mfma_f32_16x16x32_bf16 v[68:71], v[80:83], v[56:59], 0
    v_cvt_pk_bf16_f32 v51, v22, v23
    v_exp_f32 v26, v26
    v_mfma_f32_32x32x16_bf16 a[16:31], a[108:111], v[60:63], a[16:31]
    v_exp_f32 v27, v27
    v_cvt_pk_bf16_f32 v52, v24, v25
    v_exp_f32 v28, v28
    v_exp_f32 v29, v29
    v_cvt_pk_bf16_f32 v53, v26, v27
    v_exp_f32 v30, v30
    v_exp_f32 v31, v31
    v_cvt_pk_bf16_f32 v54, v28, v29
    v_mfma_f32_16x16x32_bf16 v[68:71], v[80:83], v[60:63], v[68:71]
    v_cvt_pk_bf16_f32 v55, v30, v31
    s_waitcnt vmcnt(9)
    v_exp_f32 v32, v32
    v_mfma_f32_32x32x16_bf16 v[16:31], a[112:115], a[64:67], 0
    v_exp_f32 v33, v33
    v_exp_f32 v34, v34
    v_exp_f32 v35, v35
    v_cvt_pk_bf16_f32 v56, v32, v33
    v_mfma_f32_32x32x16_bf16 a[32:47], a[104:107], v[48:51], 0
    buffer_load_dwordx4 a[152:155], v1, s[8:11], s27 offen offset:0 sc1
    v_exp_f32 v36, v36
    v_exp_f32 v37, v37
    v_cvt_pk_bf16_f32 v57, v34, v35
    v_exp_f32 v38, v38
    v_mfma_f32_32x32x16_bf16 v[16:31], a[116:119], a[68:71], v[16:31]
    v_exp_f32 v39, v39
    v_cvt_pk_bf16_f32 v58, v36, v37
    v_exp_f32 v40, v40
    v_exp_f32 v41, v41
    v_mfma_f32_16x16x32_bf16 v[72:75], v[80:83], v[48:51], 0
    v_cvt_pk_bf16_f32 v59, v38, v39
    v_exp_f32 v42, v42
    v_mfma_f32_32x32x16_bf16 a[32:47], a[108:111], v[52:55], a[32:47]
    v_exp_f32 v43, v43
    v_cvt_pk_bf16_f32 v60, v40, v41
    v_exp_f32 v44, v44
    v_exp_f32 v45, v45
    v_cvt_pk_bf16_f32 v61, v42, v43
    v_exp_f32 v46, v46
    v_exp_f32 v47, v47
    v_cvt_pk_bf16_f32 v62, v44, v45
    v_mfma_f32_16x16x32_bf16 v[72:75], v[80:83], v[52:55], v[72:75]
    v_cvt_pk_bf16_f32 v63, v46, v47
    v_exp_f32 v16, v16
    v_mfma_f32_32x32x16_bf16 v[32:47], a[112:115], a[72:75], 0
    v_exp_f32 v17, v17
    v_exp_f32 v18, v18
    v_exp_f32 v19, v19
    v_cvt_pk_bf16_f32 v48, v16, v17
    v_mfma_f32_32x32x16_bf16 a[48:63], a[104:107], v[56:59], 0
    buffer_load_dwordx4 a[156:159], v1, s[8:11], s27 offen offset:1024 sc1
    v_exp_f32 v20, v20
    v_exp_f32 v21, v21
    v_cvt_pk_bf16_f32 v49, v18, v19
    v_exp_f32 v22, v22
    v_mfma_f32_32x32x16_bf16 v[32:47], a[116:119], a[76:79], v[32:47]
    v_exp_f32 v23, v23
    v_cvt_pk_bf16_f32 v50, v20, v21
    v_exp_f32 v24, v24
    v_exp_f32 v25, v25
    v_mfma_f32_16x16x32_bf16 v[76:79], v[80:83], v[56:59], 0
    v_cvt_pk_bf16_f32 v51, v22, v23
    v_exp_f32 v26, v26
    v_mfma_f32_32x32x16_bf16 a[48:63], a[108:111], v[60:63], a[48:63]
    v_exp_f32 v27, v27
    buffer_store_dwordx4 v[148:151], v244, s[8:11], s51 offen offset:0 sc1
    v_cvt_pk_bf16_f32 v52, v24, v25
    v_exp_f32 v28, v28
    v_exp_f32 v29, v29
    v_cvt_pk_bf16_f32 v53, v26, v27
    v_exp_f32 v30, v30
    v_exp_f32 v31, v31
    v_cvt_pk_bf16_f32 v54, v28, v29
    v_mfma_f32_16x16x32_bf16 v[76:79], v[80:83], v[60:63], v[76:79]
    v_cvt_pk_bf16_f32 v55, v30, v31
    s_waitcnt vmcnt(10)
    v_exp_f32 v32, v32
    v_mfma_f32_32x32x16_bf16 v[16:31], a[112:115], a[80:83], 0
    v_exp_f32 v33, v33
    v_exp_f32 v34, v34
    v_exp_f32 v35, v35
    v_cvt_pk_bf16_f32 v56, v32, v33
    v_mfma_f32_32x32x16_bf16 a[0:15], a[120:123], v[48:51], a[0:15]
    buffer_load_dwordx4 a[96:99], v1, s[8:11], s26 offen offset:2048 sc1
    v_exp_f32 v36, v36
    v_exp_f32 v37, v37
    v_cvt_pk_bf16_f32 v57, v34, v35
    v_exp_f32 v38, v38
    v_mfma_f32_32x32x16_bf16 v[16:31], a[116:119], a[84:87], v[16:31]
    v_exp_f32 v39, v39
    v_cvt_pk_bf16_f32 v58, v36, v37
    v_exp_f32 v40, v40
    v_exp_f32 v41, v41
    v_mfma_f32_16x16x32_bf16 v[64:67], v[80:83], v[48:51], v[64:67]
    v_cvt_pk_bf16_f32 v59, v38, v39
    v_exp_f32 v42, v42
    v_mfma_f32_32x32x16_bf16 a[0:15], a[124:127], v[52:55], a[0:15]
    v_exp_f32 v43, v43
    v_cvt_pk_bf16_f32 v60, v40, v41
    v_exp_f32 v44, v44
    v_exp_f32 v45, v45
    v_cvt_pk_bf16_f32 v61, v42, v43
    v_exp_f32 v46, v46
    v_exp_f32 v47, v47
    v_cvt_pk_bf16_f32 v62, v44, v45
    v_mfma_f32_16x16x32_bf16 v[64:67], v[80:83], v[52:55], v[64:67]
    v_cvt_pk_bf16_f32 v63, v46, v47
    v_exp_f32 v16, v16
    v_mfma_f32_32x32x16_bf16 v[32:47], a[112:115], a[88:91], 0
    v_exp_f32 v17, v17
    v_exp_f32 v18, v18
    v_exp_f32 v19, v19
    v_cvt_pk_bf16_f32 v48, v16, v17
    v_mfma_f32_32x32x16_bf16 a[16:31], a[120:123], v[56:59], a[16:31]
    buffer_load_dwordx4 a[100:103], v1, s[8:11], s26 offen offset:3072 sc1
    s_add_u32 s26, s26, 4096
    v_exp_f32 v20, v20
    v_exp_f32 v21, v21
    v_cvt_pk_bf16_f32 v49, v18, v19
    v_exp_f32 v22, v22
    v_mfma_f32_32x32x16_bf16 v[32:47], a[116:119], a[92:95], v[32:47]
    v_exp_f32 v23, v23
    v_cvt_pk_bf16_f32 v50, v20, v21
    v_exp_f32 v24, v24
    v_exp_f32 v25, v25
    v_mfma_f32_16x16x32_bf16 v[68:71], v[80:83], v[56:59], v[68:71]
    v_cvt_pk_bf16_f32 v51, v22, v23
    v_exp_f32 v26, v26
    v_mfma_f32_32x32x16_bf16 a[16:31], a[124:127], v[60:63], a[16:31]
    v_exp_f32 v27, v27
    v_cvt_pk_bf16_f32 v52, v24, v25
    v_exp_f32 v28, v28
    v_exp_f32 v29, v29
    v_cvt_pk_bf16_f32 v53, v26, v27
    v_exp_f32 v30, v30
    v_exp_f32 v31, v31
    v_cvt_pk_bf16_f32 v54, v28, v29
    v_mfma_f32_16x16x32_bf16 v[68:71], v[80:83], v[60:63], v[68:71]
    v_cvt_pk_bf16_f32 v55, v30, v31
    s_waitcnt vmcnt(10)
    v_exp_f32 v32, v32
    v_mfma_f32_32x32x16_bf16 v[16:31], a[128:131], a[64:67], 0
    v_exp_f32 v33, v33
    v_exp_f32 v34, v34
    v_exp_f32 v35, v35
    v_cvt_pk_bf16_f32 v56, v32, v33
    v_mfma_f32_32x32x16_bf16 a[32:47], a[120:123], v[48:51], a[32:47]
    buffer_load_dwordx4 a[104:107], v1, s[8:11], s27 offen offset:2048 sc1
    v_exp_f32 v36, v36
    v_exp_f32 v37, v37
    v_cvt_pk_bf16_f32 v57, v34, v35
    v_exp_f32 v38, v38
    v_mfma_f32_32x32x16_bf16 v[16:31], a[132:135], a[68:71], v[16:31]
    v_exp_f32 v39, v39
    v_cvt_pk_bf16_f32 v58, v36, v37
    v_exp_f32 v40, v40
    v_exp_f32 v41, v41
    v_mfma_f32_16x16x32_bf16 v[72:75], v[80:83], v[48:51], v[72:75]
    v_cvt_pk_bf16_f32 v59, v38, v39
    v_exp_f32 v42, v42
    v_mfma_f32_32x32x16_bf16 a[32:47], a[124:127], v[52:55], a[32:47]
    v_exp_f32 v43, v43
    buffer_store_dwordx4 v[152:155], v244, s[8:11], s46 offen offset:0 sc1
    v_cvt_pk_bf16_f32 v60, v40, v41
    v_exp_f32 v44, v44
    v_exp_f32 v45, v45
    v_cvt_pk_bf16_f32 v61, v42, v43
    v_exp_f32 v46, v46
    v_exp_f32 v47, v47
    v_cvt_pk_bf16_f32 v62, v44, v45
    v_mfma_f32_16x16x32_bf16 v[72:75], v[80:83], v[52:55], v[72:75]
    v_cvt_pk_bf16_f32 v63, v46, v47
    v_exp_f32 v16, v16
    v_mfma_f32_32x32x16_bf16 v[32:47], a[128:131], a[72:75], 0
    v_exp_f32 v17, v17
    v_exp_f32 v18, v18
    v_exp_f32 v19, v19
    v_cvt_pk_bf16_f32 v48, v16, v17
    v_mfma_f32_32x32x16_bf16 a[48:63], a[120:123], v[56:59], a[48:63]
    buffer_load_dwordx4 a[108:111], v1, s[8:11], s27 offen offset:3072 sc1
    s_add_u32 s27, s27, 4096
    v_exp_f32 v20, v20
    v_exp_f32 v21, v21
    v_cvt_pk_bf16_f32 v49, v18, v19
    v_exp_f32 v22, v22
    v_mfma_f32_32x32x16_bf16 v[32:47], a[132:135], a[76:79], v[32:47]
    v_exp_f32 v23, v23
    v_cvt_pk_bf16_f32 v50, v20, v21
    v_exp_f32 v24, v24
    v_exp_f32 v25, v25
    v_mfma_f32_16x16x32_bf16 v[76:79], v[80:83], v[56:59], v[76:79]
    v_cvt_pk_bf16_f32 v51, v22, v23
    v_exp_f32 v26, v26
    v_mfma_f32_32x32x16_bf16 a[48:63], a[124:127], v[60:63], a[48:63]
    v_exp_f32 v27, v27
    buffer_load_dwordx4 a[240:243], v1, s[72:75], s80 offen
    s_add_u32 s80, s80, 1024
    v_cvt_pk_bf16_f32 v52, v24, v25
    v_exp_f32 v28, v28
    v_exp_f32 v29, v29
    v_cvt_pk_bf16_f32 v53, v26, v27
    v_exp_f32 v30, v30
    v_exp_f32 v31, v31
    v_cvt_pk_bf16_f32 v54, v28, v29
    v_mfma_f32_16x16x32_bf16 v[76:79], v[80:83], v[60:63], v[76:79]
    v_cvt_pk_bf16_f32 v55, v30, v31
    s_waitcnt vmcnt(12)
    v_exp_f32 v32, v32
    v_mfma_f32_32x32x16_bf16 v[16:31], a[128:131], a[80:83], 0
    v_exp_f32 v33, v33
    v_exp_f32 v34, v34
    v_exp_f32 v35, v35
L_pad_5:
    s_cbranch_execz L_pad_8
    v_cvt_pk_bf16_f32 v56, v32, v33
    v_mfma_f32_32x32x16_bf16 a[0:15], a[136:139], v[48:51], a[0:15]
    buffer_load_dwordx4 a[112:115], v1, s[8:11], s26 offen offset:0 sc1
    v_exp_f32 v36, v36
    v_exp_f32 v37, v37
    v_cvt_pk_bf16_f32 v57, v34, v35
    v_exp_f32 v38, v38
    v_mfma_f32_32x32x16_bf16 v[16:31], a[132:135], a[84:87], v[16:31]
    v_exp_f32 v39, v39
    v_cvt_pk_bf16_f32 v58, v36, v37
    v_exp_f32 v40, v40
    v_exp_f32 v41, v41
    v_mfma_f32_16x16x32_bf16 v[64:67], v[80:83], v[48:51], v[64:67]
    v_cvt_pk_bf16_f32 v59, v38, v39
    v_exp_f32 v42, v42
    v_mfma_f32_32x32x16_bf16 a[0:15], a[140:143], v[52:55], a[0:15]
    v_exp_f32 v43, v43
    v_cvt_pk_bf16_f32 v60, v40, v41
    v_exp_f32 v44, v44
    v_exp_f32 v45, v45
    v_cvt_pk_bf16_f32 v61, v42, v43
    v_exp_f32 v46, v46
    v_exp_f32 v47, v47
    v_cvt_pk_bf16_f32 v62, v44, v45
    v_mfma_f32_16x16x32_bf16 v[64:67], v[80:83], v[52:55], v[64:67]
    v_cvt_pk_bf16_f32 v63, v46, v47
    v_exp_f32 v16, v16
    v_mfma_f32_32x32x16_bf16 v[32:47], a[128:131], a[88:91], 0
    v_exp_f32 v17, v17
    v_exp_f32 v18, v18
    v_exp_f32 v19, v19
    v_cvt_pk_bf16_f32 v48, v16, v17
    v_mfma_f32_32x32x16_bf16 a[16:31], a[136:139], v[56:59], a[16:31]
    buffer_load_dwordx4 a[116:119], v1, s[8:11], s26 offen offset:1024 sc1
    v_exp_f32 v20, v20
    v_exp_f32 v21, v21
    v_cvt_pk_bf16_f32 v49, v18, v19
    v_exp_f32 v22, v22
    v_mfma_f32_32x32x16_bf16 v[32:47], a[132:135], a[92:95], v[32:47]
    v_exp_f32 v23, v23
    v_cvt_pk_bf16_f32 v50, v20, v21
    v_exp_f32 v24, v24
    v_exp_f32 v25, v25
    v_mfma_f32_16x16x32_bf16 v[68:71], v[80:83], v[56:59], v[68:71]
    v_cvt_pk_bf16_f32 v51, v22, v23
    v_exp_f32 v26, v26
    v_mfma_f32_32x32x16_bf16 a[16:31], a[140:143], v[60:63], a[16:31]
    v_exp_f32 v27, v27
    buffer_store_dwordx4 v[156:159], v244, s[8:11], s47 offen offset:0 sc1
    v_cvt_pk_bf16_f32 v52, v24, v25
    v_exp_f32 v28, v28
    v_exp_f32 v29, v29
    v_cvt_pk_bf16_f32 v53, v26, v27
    v_exp_f32 v30, v30
    v_exp_f32 v31, v31
    v_cvt_pk_bf16_f32 v54, v28, v29
    v_mfma_f32_16x16x32_bf16 v[68:71], v[80:83], v[60:63], v[68:71]
    v_cvt_pk_bf16_f32 v55, v30, v31
    s_waitcnt vmcnt(12)
    v_exp_f32 v32, v32
    v_mfma_f32_32x32x16_bf16 v[16:31], a[144:147], a[64:67], 0
    v_exp_f32 v33, v33
    v_exp_f32 v34, v34
    v_exp_f32 v35, v35
    v_cvt_pk_bf16_f32 v56, v32, v33
    v_mfma_f32_32x32x16_bf16 a[32:47], a[136:139], v[48:51], a[32:47]
    buffer_load_dwordx4 a[120:123], v1, s[8:11], s27 offen offset:0 sc1
    v_exp_f32 v36, v36
    v_exp_f32 v37, v37
    v_cvt_pk_bf16_f32 v57, v34, v35
    v_exp_f32 v38, v38
    v_mfma_f32_32x32x16_bf16 v[16:31], a[148:151], a[68:71], v[16:31]
    v_exp_f32 v39, v39
    v_cvt_pk_bf16_f32 v58, v36, v37
    v_exp_f32 v40, v40
    v_exp_f32 v41, v41
    v_mfma_f32_16x16x32_bf16 v[72:75], v[80:83], v[48:51], v[72:75]
    v_cvt_pk_bf16_f32 v59, v38, v39
    v_exp_f32 v42, v42
    v_mfma_f32_32x32x16_bf16 a[32:47], a[140:143], v[52:55], a[32:47]
    v_exp_f32 v43, v43
    v_cvt_pk_bf16_f32 v60, v40, v41
    v_exp_f32 v44, v44
    v_exp_f32 v45, v45
    v_cvt_pk_bf16_f32 v61, v42, v43
    v_exp_f32 v46, v46
    v_exp_f32 v47, v47
    v_cvt_pk_bf16_f32 v62, v44, v45
    v_mfma_f32_16x16x32_bf16 v[72:75], v[80:83], v[52:55], v[72:75]
    v_cvt_pk_bf16_f32 v63, v46, v47
    v_exp_f32 v16, v16
    v_mfma_f32_32x32x16_bf16 v[32:47], a[144:147], a[72:75], 0
    v_exp_f32 v17, v17
    v_exp_f32 v18, v18
    v_exp_f32 v19, v19
    v_cvt_pk_bf16_f32 v48, v16, v17
    v_mfma_f32_32x32x16_bf16 a[48:63], a[136:139], v[56:59], a[48:63]
    buffer_load_dwordx4 a[124:127], v1, s[8:11], s27 offen offset:1024 sc1
    v_exp_f32 v20, v20
    v_exp_f32 v21, v21
    v_cvt_pk_bf16_f32 v49, v18, v19
    v_exp_f32 v22, v22
    v_mfma_f32_32x32x16_bf16 v[32:47], a[148:151], a[76:79], v[32:47]
    v_exp_f32 v23, v23
    v_cvt_pk_bf16_f32 v50, v20, v21
    v_exp_f32 v24, v24
    v_exp_f32 v25, v25
    v_mfma_f32_16x16x32_bf16 v[76:79], v[80:83], v[56:59], v[76:79]
    v_cvt_pk_bf16_f32 v51, v22, v23
    v_exp_f32 v26, v26
    v_mfma_f32_32x32x16_bf16 a[48:63], a[140:143], v[60:63], a[48:63]
    v_exp_f32 v27, v27
    v_cvt_pk_bf16_f32 v52, v24, v25
    v_exp_f32 v28, v28
    v_exp_f32 v29, v29
    v_cvt_pk_bf16_f32 v53, v26, v27
    v_exp_f32 v30, v30
    v_exp_f32 v31, v31
    v_cvt_pk_bf16_f32 v54, v28, v29
    v_mfma_f32_16x16x32_bf16 v[76:79], v[80:83], v[60:63], v[76:79]
    v_cvt_pk_bf16_f32 v55, v30, v31
    s_waitcnt vmcnt(12)
    v_exp_f32 v32, v32
    v_mfma_f32_32x32x16_bf16 v[16:31], a[144:147], a[80:83], 0
    v_exp_f32 v33, v33
    v_exp_f32 v34, v34
    v_exp_f32 v35, v35
    v_cvt_pk_bf16_f32 v56, v32, v33
    v_mfma_f32_32x32x16_bf16 a[0:15], a[152:155], v[48:51], a[0:15]
    buffer_load_dwordx4 a[128:131], v1, s[8:11], s26 offen offset:2048 sc1
    v_exp_f32 v36, v36
    v_exp_f32 v37, v37
    v_cvt_pk_bf16_f32 v57, v34, v35
    v_exp_f32 v38, v38
    v_mfma_f32_32x32x16_bf16 v[16:31], a[148:151], a[84:87], v[16:31]
    v_exp_f32 v39, v39
    v_cvt_pk_bf16_f32 v58, v36, v37
    v_exp_f32 v40, v40
    v_exp_f32 v41, v41
    v_mfma_f32_16x16x32_bf16 v[64:67], v[80:83], v[48:51], v[64:67]
    v_cvt_pk_bf16_f32 v59, v38, v39
    v_exp_f32 v42, v42
    v_mfma_f32_32x32x16_bf16 a[0:15], a[156:159], v[52:55], a[0:15]
    v_exp_f32 v43, v43
    buffer_store_dwordx4 v[160:163], v244, s[8:11], s50 offen offset:1024 sc1
    v_cvt_pk_bf16_f32 v60, v40, v41
    v_exp_f32 v44, v44
    v_exp_f32 v45, v45
    v_cvt_pk_bf16_f32 v61, v42, v43
    v_exp_f32 v46, v46
    v_exp_f32 v47, v47
    v_cvt_pk_bf16_f32 v62, v44, v45
    v_mfma_f32_16x16x32_bf16 v[64:67], v[80:83], v[52:55], v[64:67]
    v_cvt_pk_bf16_f32 v63, v46, v47
    v_exp_f32 v16, v16
    v_mfma_f32_32x32x16_bf16 v[32:47], a[144:147], a[88:91], 0
    v_exp_f32 v17, v17
    v_exp_f32 v18, v18
    v_exp_f32 v19, v19
    v_cvt_pk_bf16_f32 v48, v16, v17
    v_mfma_f32_32x32x16_bf16 a[16:31], a[152:155], v[56:59], a[16:31]
    buffer_load_dwordx4 a[132:135], v1, s[8:11], s26 offen offset:3072 sc1
    s_add_u32 s26, s26, 4096
    v_exp_f32 v20, v20
    v_exp_f32 v21, v21
    v_cvt_pk_bf16_f32 v49, v18, v19
    v_exp_f32 v22, v22
    v_mfma_f32_32x32x16_bf16 v[32:47], a[148:151], a[92:95], v[32:47]
    v_exp_f32 v23, v23
    v_cvt_pk_bf16_f32 v50, v20, v21
    v_exp_f32 v24, v24
    v_exp_f32 v25, v25
    v_mfma_f32_16x16x32_bf16 v[68:71], v[80:83], v[56:59], v[68:71]
    v_cvt_pk_bf16_f32 v51, v22, v23
    v_exp_f32 v26, v26
    v_mfma_f32_32x32x16_bf16 a[16:31], a[156:159], v[60:63], a[16:31]
    v_exp_f32 v27, v27
    v_cvt_pk_bf16_f32 v52, v24, v25
    v_exp_f32 v28, v28
    v_exp_f32 v29, v29
    v_cvt_pk_bf16_f32 v53, v26, v27
    v_exp_f32 v30, v30
    v_exp_f32 v31, v31
    v_cvt_pk_bf16_f32 v54, v28, v29
    v_mfma_f32_16x16x32_bf16 v[68:71], v[80:83], v[60:63], v[68:71]
    v_cvt_pk_bf16_f32 v55, v30, v31
    s_waitcnt vmcnt(12)
    v_exp_f32 v32, v32
    v_mfma_f32_32x32x16_bf16 v[16:31], a[96:99], a[64:67], 0
    v_exp_f32 v33, v33
    v_exp_f32 v34, v34
    v_exp_f32 v35, v35
    v_cvt_pk_bf16_f32 v56, v32, v33
    v_mfma_f32_32x32x16_bf16 a[32:47], a[152:155], v[48:51], a[32:47]
    buffer_load_dwordx4 a[136:139], v1, s[8:11], s27 offen offset:2048 sc1
    v_exp_f32 v36, v36
    v_exp_f32 v37, v37
    v_cvt_pk_bf16_f32 v57, v34, v35
    v_exp_f32 v38, v38
    v_mfma_f32_32x32x16_bf16 v[16:31], a[100:103], a[68:71], v[16:31]
    v_exp_f32 v39, v39
    v_cvt_pk_bf16_f32 v58, v36, v37
    v_exp_f32 v40, v40
    v_exp_f32 v41, v41
    v_mfma_f32_16x16x32_bf16 v[72:75], v[80:83], v[48:51], v[72:75]
    v_cvt_pk_bf16_f32 v59, v38, v39
    v_exp_f32 v42, v42
    v_mfma_f32_32x32x16_bf16 a[32:47], a[156:159], v[52:55], a[32:47]
    v_exp_f32 v43, v43
    v_cvt_pk_bf16_f32 v60, v40, v41
    v_exp_f32 v44, v44
    v_exp_f32 v45, v45
    v_cvt_pk_bf16_f32 v61, v42, v43
    v_exp_f32 v46, v46
    v_exp_f32 v47, v47
    v_cvt_pk_bf16_f32 v62, v44, v45
    v_mfma_f32_16x16x32_bf16 v[72:75], v[80:83], v[52:55], v[72:75]
    v_cvt_pk_bf16_f32 v63, v46, v47
    v_exp_f32 v16, v16
    v_mfma_f32_32x32x16_bf16 v[32:47], a[96:99], a[72:75], 0
    v_exp_f32 v17, v17
    v_exp_f32 v18, v18
    v_exp_f32 v19, v19
    v_cvt_pk_bf16_f32 v48, v16, v17
    v_mfma_f32_32x32x16_bf16 a[48:63], a[152:155], v[56:59], a[48:63]
    buffer_load_dwordx4 a[140:143], v1, s[8:11], s27 offen offset:3072 sc1
    s_add_u32 s27, s27, 4096
    v_exp_f32 v20, v20
    v_exp_f32 v21, v21
    v_cvt_pk_bf16_f32 v49, v18, v19
    v_exp_f32 v22, v22
    v_mfma_f32_32x32x16_bf16 v[32:47], a[100:103], a[76:79], v[32:47]
    v_exp_f32 v23, v23
    v_cvt_pk_bf16_f32 v50, v20, v21
    v_exp_f32 v24, v24
    v_exp_f32 v25, v25
    v_mfma_f32_16x16x32_bf16 v[76:79], v[80:83], v[56:59], v[76:79]
    v_cvt_pk_bf16_f32 v51, v22, v23
    v_exp_f32 v26, v26
    v_mfma_f32_32x32x16_bf16 a[48:63], a[156:159], v[60:63], a[48:63]
    v_exp_f32 v27, v27
    buffer_store_dwordx4 v[164:167], v244, s[8:11], s51 offen offset:1024 sc1
    v_cvt_pk_bf16_f32 v52, v24, v25
    v_exp_f32 v28, v28
    v_exp_f32 v29, v29
    v_cvt_pk_bf16_f32 v53, v26, v27
    v_exp_f32 v30, v30
    v_exp_f32 v31, v31
    v_cvt_pk_bf16_f32 v54, v28, v29
    v_mfma_f32_16x16x32_bf16 v[76:79], v[80:83], v[60:63], v[76:79]
    v_cvt_pk_bf16_f32 v55, v30, v31
    s_waitcnt vmcnt(12)
    v_exp_f32 v32, v32
    v_mfma_f32_32x32x16_bf16 v[16:31], a[96:99], a[80:83], 0
    v_exp_f32 v33, v33
    v_exp_f32 v34, v34
    v_exp_f32 v35, v35
    v_cvt_pk_bf16_f32 v56, v32, v33
    v_mfma_f32_32x32x16_bf16 a[0:15], a[104:107], v[48:51], a[0:15]
    buffer_load_dwordx4 a[144:147], v1, s[8:11], s26 offen offset:0 sc1
    v_exp_f32 v36, v36
    v_exp_f32 v37, v37
    v_cvt_pk_bf16_f32 v57, v34, v35
    v_exp_f32 v38, v38
    v_mfma_f32_32x32x16_bf16 v[16:31], a[100:103], a[84:87], v[16:31]
    v_exp_f32 v39, v39
    v_cvt_pk_bf16_f32 v58, v36, v37
    v_exp_f32 v40, v40
    v_exp_f32 v41, v41
    v_mfma_f32_16x16x32_bf16 v[64:67], v[80:83], v[48:51], v[64:67]
    v_cvt_pk_bf16_f32 v59, v38, v39
    v_exp_f32 v42, v42
    v_mfma_f32_32x32x16_bf16 a[0:15], a[108:111], v[52:55], a[0:15]
    v_exp_f32 v43, v43
    v_cvt_pk_bf16_f32 v60, v40, v41
    v_exp_f32 v44, v44
    v_exp_f32 v45, v45
    v_cvt_pk_bf16_f32 v61, v42, v43
    v_exp_f32 v46, v46
    v_exp_f32 v47, v47
    v_cvt_pk_bf16_f32 v62, v44, v45
    v_mfma_f32_16x16x32_bf16 v[64:67], v[80:83], v[52:55], v[64:67]
    v_cvt_pk_bf16_f32 v63, v46, v47
    v_exp_f32 v16, v16
    v_mfma_f32_32x32x16_bf16 v[32:47], a[96:99], a[88:91], 0
    v_exp_f32 v17, v17
    v_exp_f32 v18, v18
    v_exp_f32 v19, v19
    v_cvt_pk_bf16_f32 v48, v16, v17
    v_mfma_f32_32x32x16_bf16 a[16:31], a[104:107], v[56:59], a[16:31]
    buffer_load_dwordx4 a[148:151], v1, s[8:11], s26 offen offset:1024 sc1
    v_exp_f32 v20, v20
    v_exp_f32 v21, v21
    v_cvt_pk_bf16_f32 v49, v18, v19
    v_exp_f32 v22, v22
    v_mfma_f32_32x32x16_bf16 v[32:47], a[100:103], a[92:95], v[32:47]
    v_exp_f32 v23, v23
    v_cvt_pk_bf16_f32 v50, v20, v21
    v_exp_f32 v24, v24
    v_exp_f32 v25, v25
    v_mfma_f32_16x16x32_bf16 v[68:71], v[80:83], v[56:59], v[68:71]
    v_cvt_pk_bf16_f32 v51, v22, v23
    v_exp_f32 v26, v26
    v_mfma_f32_32x32x16_bf16 a[16:31], a[108:111], v[60:63], a[16:31]
    v_exp_f32 v27, v27
    buffer_load_dwordx4 a[240:243], v1, s[72:75], s80 offen
    s_add_u32 s80, s80, 1024
    v_cvt_pk_bf16_f32 v52, v24, v25
    v_exp_f32 v28, v28
    v_exp_f32 v29, v29
    v_cvt_pk_bf16_f32 v53, v26, v27
    v_exp_f32 v30, v30
    v_exp_f32 v31, v31
    v_cvt_pk_bf16_f32 v54, v28, v29
    v_mfma_f32_16x16x32_bf16 v[68:71], v[80:83], v[60:63], v[68:71]
    v_cvt_pk_bf16_f32 v55, v30, v31
    s_waitcnt vmcnt(12)
    v_exp_f32 v32, v32
    v_mfma_f32_32x32x16_bf16 v[16:31], a[112:115], a[64:67], 0
    v_exp_f32 v33, v33
    v_exp_f32 v34, v34
    v_exp_f32 v35, v35
    v_cvt_pk_bf16_f32 v56, v32, v33
    v_mfma_f32_32x32x16_bf16 a[32:47], a[104:107], v[48:51], a[32:47]
    buffer_load_dwordx4 a[152:155], v1, s[8:11], s27 offen offset:0 sc1
    v_exp_f32 v36, v36
    v_exp_f32 v37, v37
    v_cvt_pk_bf16_f32 v57, v34, v35
    v_exp_f32 v38, v38
    v_mfma_f32_32x32x16_bf16 v[16:31], a[116:119], a[68:71], v[16:31]
    v_exp_f32 v39, v39
    v_cvt_pk_bf16_f32 v58, v36, v37
    v_exp_f32 v40, v40
    v_exp_f32 v41, v41
    v_mfma_f32_16x16x32_bf16 v[72:75], v[80:83], v[48:51], v[72:75]
    v_cvt_pk_bf16_f32 v59, v38, v39
    v_exp_f32 v42, v42
    v_mfma_f32_32x32x16_bf16 a[32:47], a[108:111], v[52:55], a[32:47]
    v_exp_f32 v43, v43
    buffer_store_dwordx4 v[168:171], v244, s[8:11], s46 offen offset:1024 sc1
    v_cvt_pk_bf16_f32 v60, v40, v41
    v_exp_f32 v44, v44
    v_exp_f32 v45, v45
    v_cvt_pk_bf16_f32 v61, v42, v43
    v_exp_f32 v46, v46
    v_exp_f32 v47, v47
    v_cvt_pk_bf16_f32 v62, v44, v45
    v_mfma_f32_16x16x32_bf16 v[72:75], v[80:83], v[52:55], v[72:75]
    v_cvt_pk_bf16_f32 v63, v46, v47
    v_exp_f32 v16, v16
    v_mfma_f32_32x32x16_bf16 v[32:47], a[112:115], a[72:75], 0
    v_exp_f32 v17, v17
    v_exp_f32 v18, v18
    v_exp_f32 v19, v19
    v_cvt_pk_bf16_f32 v48, v16, v17
    v_mfma_f32_32x32x16_bf16 a[48:63], a[104:107], v[56:59], a[48:63]
    buffer_load_dwordx4 a[156:159], v1, s[8:11], s27 offen offset:1024 sc1
    v_exp_f32 v20, v20
    v_exp_f32 v21, v21
    v_cvt_pk_bf16_f32 v49, v18, v19
    v_exp_f32 v22, v22
    v_mfma_f32_32x32x16_bf16 v[32:47], a[116:119], a[76:79], v[32:47]
    v_exp_f32 v23, v23
    v_cvt_pk_bf16_f32 v50, v20, v21
    v_exp_f32 v24, v24
    v_exp_f32 v25, v25
    v_mfma_f32_16x16x32_bf16 v[76:79], v[80:83], v[56:59], v[76:79]
    v_cvt_pk_bf16_f32 v51, v22, v23
    v_exp_f32 v26, v26
    v_mfma_f32_32x32x16_bf16 a[48:63], a[108:111], v[60:63], a[48:63]
    v_exp_f32 v27, v27
    v_cvt_pk_bf16_f32 v52, v24, v25
    v_exp_f32 v28, v28
    v_exp_f32 v29, v29
    v_cvt_pk_bf16_f32 v53, v26, v27
    v_exp_f32 v30, v30
    v_exp_f32 v31, v31
    v_cvt_pk_bf16_f32 v54, v28, v29
    v_mfma_f32_16x16x32_bf16 v[76:79], v[80:83], v[60:63], v[76:79]
    v_cvt_pk_bf16_f32 v55, v30, v31
    s_waitcnt vmcnt(12)
    v_exp_f32 v32, v32
    v_mfma_f32_32x32x16_bf16 v[16:31], a[112:115], a[80:83], 0
    v_exp_f32 v33, v33
    v_exp_f32 v34, v34
    v_exp_f32 v35, v35
    v_cvt_pk_bf16_f32 v56, v32, v33
    v_mfma_f32_32x32x16_bf16 a[0:15], a[120:123], v[48:51], a[0:15]
    buffer_load_dwordx4 a[96:99], v1, s[8:11], s26 offen offset:2048 sc1
    v_exp_f32 v36, v36
    v_exp_f32 v37, v37
    v_cvt_pk_bf16_f32 v57, v34, v35
    v_exp_f32 v38, v38
    v_mfma_f32_32x32x16_bf16 v[16:31], a[116:119], a[84:87], v[16:31]
    v_exp_f32 v39, v39
    v_cvt_pk_bf16_f32 v58, v36, v37
    v_exp_f32 v40, v40
    v_exp_f32 v41, v41
    v_mfma_f32_16x16x32_bf16 v[64:67], v[80:83], v[48:51], v[64:67]
    v_cvt_pk_bf16_f32 v59, v38, v39
    v_exp_f32 v42, v42
    v_mfma_f32_32x32x16_bf16 a[0:15], a[124:127], v[52:55], a[0:15]
    v_exp_f32 v43, v43
    v_cvt_pk_bf16_f32 v60, v40, v41
    v_exp_f32 v44, v44
    v_exp_f32 v45, v45
    v_cvt_pk_bf16_f32 v61, v42, v43
    v_exp_f32 v46, v46
    v_exp_f32 v47, v47
    v_cvt_pk_bf16_f32 v62, v44, v45
    v_mfma_f32_16x16x32_bf16 v[64:67], v[80:83], v[52:55], v[64:67]
    v_cvt_pk_bf16_f32 v63, v46, v47
    v_exp_f32 v16, v16
    v_mfma_f32_32x32x16_bf16 v[32:47], a[112:115], a[88:91], 0
    v_exp_f32 v17, v17
    v_exp_f32 v18, v18
    v_exp_f32 v19, v19
    v_cvt_pk_bf16_f32 v48, v16, v17
    v_mfma_f32_32x32x16_bf16 a[16:31], a[120:123], v[56:59], a[16:31]
    buffer_load_dwordx4 a[100:103], v1, s[8:11], s26 offen offset:3072 sc1
    s_add_u32 s26, s26, 4096
    v_exp_f32 v20, v20
    v_exp_f32 v21, v21
    v_cvt_pk_bf16_f32 v49, v18, v19
    v_exp_f32 v22, v22
    v_mfma_f32_32x32x16_bf16 v[32:47], a[116:119], a[92:95], v[32:47]
    v_exp_f32 v23, v23
    v_cvt_pk_bf16_f32 v50, v20, v21
    v_exp_f32 v24, v24
    v_exp_f32 v25, v25
    v_mfma_f32_16x16x32_bf16 v[68:71], v[80:83], v[56:59], v[68:71]
    v_cvt_pk_bf16_f32 v51, v22, v23
    v_exp_f32 v26, v26
    v_mfma_f32_32x32x16_bf16 a[16:31], a[124:127], v[60:63], a[16:31]
    v_exp_f32 v27, v27
    buffer_store_dwordx4 v[172:175], v244, s[8:11], s47 offen offset:1024 sc1
    v_cvt_pk_bf16_f32 v52, v24, v25
    v_exp_f32 v28, v28
    v_exp_f32 v29, v29
    v_cvt_pk_bf16_f32 v53, v26, v27
    v_exp_f32 v30, v30
    v_exp_f32 v31, v31
    v_cvt_pk_bf16_f32 v54, v28, v29
    v_mfma_f32_16x16x32_bf16 v[68:71], v[80:83], v[60:63], v[68:71]
    v_cvt_pk_bf16_f32 v55, v30, v31
    s_waitcnt vmcnt(12)
    v_exp_f32 v32, v32
    v_mfma_f32_32x32x16_bf16 v[16:31], a[128:131], a[64:67], 0
    v_exp_f32 v33, v33
    v_exp_f32 v34, v34
    v_exp_f32 v35, v35
    v_cvt_pk_bf16_f32 v56, v32, v33
    v_mfma_f32_32x32x16_bf16 a[32:47], a[120:123], v[48:51], a[32:47]
    buffer_load_dwordx4 a[104:107], v1, s[8:11], s27 offen offset:2048 sc1
    v_exp_f32 v36, v36
    v_exp_f32 v37, v37
    v_cvt_pk_bf16_f32 v57, v34, v35
    v_exp_f32 v38, v38
    v_mfma_f32_32x32x16_bf16 v[16:31], a[132:135], a[68:71], v[16:31]
    v_exp_f32 v39, v39
    v_cvt_pk_bf16_f32 v58, v36, v37
    v_exp_f32 v40, v40
    v_exp_f32 v41, v41
    v_mfma_f32_16x16x32_bf16 v[72:75], v[80:83], v[48:51], v[72:75]
    v_cvt_pk_bf16_f32 v59, v38, v39
    v_exp_f32 v42, v42
    v_mfma_f32_32x32x16_bf16 a[32:47], a[124:127], v[52:55], a[32:47]
    v_exp_f32 v43, v43
    v_cvt_pk_bf16_f32 v60, v40, v41
    v_exp_f32 v44, v44
    v_exp_f32 v45, v45
    v_cvt_pk_bf16_f32 v61, v42, v43
    v_exp_f32 v46, v46
    v_exp_f32 v47, v47
    v_cvt_pk_bf16_f32 v62, v44, v45
    v_mfma_f32_16x16x32_bf16 v[72:75], v[80:83], v[52:55], v[72:75]
    v_cvt_pk_bf16_f32 v63, v46, v47
    v_exp_f32 v16, v16
    v_mfma_f32_32x32x16_bf16 v[32:47], a[128:131], a[72:75], 0
    v_exp_f32 v17, v17
    v_exp_f32 v18, v18
    v_exp_f32 v19, v19
    v_cvt_pk_bf16_f32 v48, v16, v17
    v_mfma_f32_32x32x16_bf16 a[48:63], a[120:123], v[56:59], a[48:63]
    buffer_load_dwordx4 a[108:111], v1, s[8:11], s27 offen offset:3072 sc1
    s_add_u32 s27, s27, 4096
    v_exp_f32 v20, v20
    v_exp_f32 v21, v21
    v_cvt_pk_bf16_f32 v49, v18, v19
    v_exp_f32 v22, v22
    v_mfma_f32_32x32x16_bf16 v[32:47], a[132:135], a[76:79], v[32:47]
    v_exp_f32 v23, v23
    v_cvt_pk_bf16_f32 v50, v20, v21
    v_exp_f32 v24, v24
    v_exp_f32 v25, v25
    v_mfma_f32_16x16x32_bf16 v[76:79], v[80:83], v[56:59], v[76:79]
    v_cvt_pk_bf16_f32 v51, v22, v23
    v_exp_f32 v26, v26
    v_mfma_f32_32x32x16_bf16 a[48:63], a[124:127], v[60:63], a[48:63]
    v_exp_f32 v27, v27
    v_cvt_pk_bf16_f32 v52, v24, v25
    v_exp_f32 v28, v28
    v_exp_f32 v29, v29
    v_cvt_pk_bf16_f32 v53, v26, v27
    v_exp_f32 v30, v30
    v_exp_f32 v31, v31
    v_cvt_pk_bf16_f32 v54, v28, v29
    v_mfma_f32_16x16x32_bf16 v[76:79], v[80:83], v[60:63], v[76:79]
    v_cvt_pk_bf16_f32 v55, v30, v31
    s_waitcnt vmcnt(12)
    v_exp_f32 v32, v32
    v_mfma_f32_32x32x16_bf16 v[16:31], a[128:131], a[80:83], 0
    v_exp_f32 v33, v33
    v_exp_f32 v34, v34
    v_exp_f32 v35, v35
    v_cvt_pk_bf16_f32 v56, v32, v33
    v_mfma_f32_32x32x16_bf16 a[0:15], a[136:139], v[48:51], a[0:15]
    buffer_load_dwordx4 a[112:115], v1, s[8:11], s26 offen offset:0 sc1
    v_exp_f32 v36, v36
    v_exp_f32 v37, v37
    v_cvt_pk_bf16_f32 v57, v34, v35
    v_exp_f32 v38, v38
    v_mfma_f32_32x32x16_bf16 v[16:31], a[132:135], a[84:87], v[16:31]
    v_exp_f32 v39, v39
    v_cvt_pk_bf16_f32 v58, v36, v37
    v_exp_f32 v40, v40
    v_exp_f32 v41, v41
    v_mfma_f32_16x16x32_bf16 v[64:67], v[80:83], v[48:51], v[64:67]
    v_cvt_pk_bf16_f32 v59, v38, v39
    v_exp_f32 v42, v42
    v_mfma_f32_32x32x16_bf16 a[0:15], a[140:143], v[52:55], a[0:15]
    v_exp_f32 v43, v43
    buffer_store_dwordx4 v[176:179], v244, s[8:11], s50 offen offset:2048 sc1
    v_cvt_pk_bf16_f32 v60, v40, v41
    v_exp_f32 v44, v44
    v_exp_f32 v45, v45
    v_cvt_pk_bf16_f32 v61, v42, v43
    v_exp_f32 v46, v46
    v_exp_f32 v47, v47
    v_cvt_pk_bf16_f32 v62, v44, v45
    v_mfma_f32_16x16x32_bf16 v[64:67], v[80:83], v[52:55], v[64:67]
    v_cvt_pk_bf16_f32 v63, v46, v47
    v_exp_f32 v16, v16
    v_mfma_f32_32x32x16_bf16 v[32:47], a[128:131], a[88:91], 0
    v_exp_f32 v17, v17
    v_exp_f32 v18, v18
    v_exp_f32 v19, v19
    v_cvt_pk_bf16_f32 v48, v16, v17
    v_mfma_f32_32x32x16_bf16 a[16:31], a[136:139], v[56:59], a[16:31]
    buffer_load_dwordx4 a[116:119], v1, s[8:11], s26 offen offset:1024 sc1
    v_exp_f32 v20, v20
    v_exp_f32 v21, v21
    v_cvt_pk_bf16_f32 v49, v18, v19
    v_exp_f32 v22, v22
    v_mfma_f32_32x32x16_bf16 v[32:47], a[132:135], a[92:95], v[32:47]
    v_exp_f32 v23, v23
    v_cvt_pk_bf16_f32 v50, v20, v21
    v_exp_f32 v24, v24
    v_exp_f32 v25, v25
    v_mfma_f32_16x16x32_bf16 v[68:71], v[80:83], v[56:59], v[68:71]
    v_cvt_pk_bf16_f32 v51, v22, v23
    v_exp_f32 v26, v26
    v_mfma_f32_32x32x16_bf16 a[16:31], a[140:143], v[60:63], a[16:31]
    v_exp_f32 v27, v27
    v_cvt_pk_bf16_f32 v52, v24, v25
    v_exp_f32 v28, v28
    v_exp_f32 v29, v29
    v_cvt_pk_bf16_f32 v53, v26, v27
    v_exp_f32 v30, v30
    v_exp_f32 v31, v31
    v_cvt_pk_bf16_f32 v54, v28, v29
    v_mfma_f32_16x16x32_bf16 v[68:71], v[80:83], v[60:63], v[68:71]
    v_cvt_pk_bf16_f32 v55, v30, v31
    s_waitcnt vmcnt(12)
    v_exp_f32 v32, v32
    v_mfma_f32_32x32x16_bf16 v[16:31], a[144:147], a[64:67], 0
    v_exp_f32 v33, v33
    v_exp_f32 v34, v34
    v_exp_f32 v35, v35
    v_cvt_pk_bf16_f32 v56, v32, v33
    v_mfma_f32_32x32x16_bf16 a[32:47], a[136:139], v[48:51], a[32:47]
    buffer_load_dwordx4 a[120:123], v1, s[8:11], s27 offen offset:0 sc1
    v_exp_f32 v36, v36
    v_exp_f32 v37, v37
    v_cvt_pk_bf16_f32 v57, v34, v35
    v_exp_f32 v38, v38
    v_mfma_f32_32x32x16_bf16 v[16:31], a[148:151], a[68:71], v[16:31]
    v_exp_f32 v39, v39
    v_cvt_pk_bf16_f32 v58, v36, v37
    v_exp_f32 v40, v40
    v_exp_f32 v41, v41
    v_mfma_f32_16x16x32_bf16 v[72:75], v[80:83], v[48:51], v[72:75]
    v_cvt_pk_bf16_f32 v59, v38, v39
    v_exp_f32 v42, v42
    v_mfma_f32_32x32x16_bf16 a[32:47], a[140:143], v[52:55], a[32:47]
    v_exp_f32 v43, v43
    v_cvt_pk_bf16_f32 v60, v40, v41
    v_exp_f32 v44, v44
    v_exp_f32 v45, v45
    v_cvt_pk_bf16_f32 v61, v42, v43
    v_exp_f32 v46, v46
    v_exp_f32 v47, v47
    v_cvt_pk_bf16_f32 v62, v44, v45
    v_mfma_f32_16x16x32_bf16 v[72:75], v[80:83], v[52:55], v[72:75]
    v_cvt_pk_bf16_f32 v63, v46, v47
    v_exp_f32 v16, v16
    v_mfma_f32_32x32x16_bf16 v[32:47], a[144:147], a[72:75], 0
    v_exp_f32 v17, v17
    v_exp_f32 v18, v18
    v_exp_f32 v19, v19
    v_cvt_pk_bf16_f32 v48, v16, v17
    v_mfma_f32_32x32x16_bf16 a[48:63], a[136:139], v[56:59], a[48:63]
    buffer_load_dwordx4 a[124:127], v1, s[8:11], s27 offen offset:1024 sc1
    v_exp_f32 v20, v20
    v_exp_f32 v21, v21
    v_cvt_pk_bf16_f32 v49, v18, v19
    v_exp_f32 v22, v22
    v_mfma_f32_32x32x16_bf16 v[32:47], a[148:151], a[76:79], v[32:47]
    v_exp_f32 v23, v23
    v_cvt_pk_bf16_f32 v50, v20, v21
    v_exp_f32 v24, v24
    v_exp_f32 v25, v25
    v_mfma_f32_16x16x32_bf16 v[76:79], v[80:83], v[56:59], v[76:79]
    v_cvt_pk_bf16_f32 v51, v22, v23
    v_exp_f32 v26, v26
    v_mfma_f32_32x32x16_bf16 a[48:63], a[140:143], v[60:63], a[48:63]
    v_exp_f32 v27, v27
    buffer_store_dwordx4 v[180:183], v244, s[8:11], s51 offen offset:2048 sc1
    buffer_load_dwordx4 a[240:243], v1, s[72:75], s80 offen
    s_add_u32 s80, s80, 1024
    v_cvt_pk_bf16_f32 v52, v24, v25
    v_exp_f32 v28, v28
    v_exp_f32 v29, v29
    v_cvt_pk_bf16_f32 v53, v26, v27
    v_exp_f32 v30, v30
    v_exp_f32 v31, v31
    v_cvt_pk_bf16_f32 v54, v28, v29
    v_mfma_f32_16x16x32_bf16 v[76:79], v[80:83], v[60:63], v[76:79]
    v_cvt_pk_bf16_f32 v55, v30, v31
    s_waitcnt vmcnt(12)
    v_exp_f32 v32, v32
    v_mfma_f32_32x32x16_bf16 v[16:31], a[144:147], a[80:83], 0
    v_exp_f32 v33, v33
    v_exp_f32 v34, v34
    v_exp_f32 v35, v35
    v_cvt_pk_bf16_f32 v56, v32, v33
    v_mfma_f32_32x32x16_bf16 a[0:15], a[152:155], v[48:51], a[0:15]
    buffer_load_dwordx4 a[128:131], v1, s[8:11], s26 offen offset:2048 sc1
    v_exp_f32 v36, v36
    v_exp_f32 v37, v37
    v_cvt_pk_bf16_f32 v57, v34, v35
    v_exp_f32 v38, v38
    v_mfma_f32_32x32x16_bf16 v[16:31], a[148:151], a[84:87], v[16:31]
    v_exp_f32 v39, v39
    v_cvt_pk_bf16_f32 v58, v36, v37
    v_exp_f32 v40, v40
    v_exp_f32 v41, v41
    v_mfma_f32_16x16x32_bf16 v[64:67], v[80:83], v[48:51], v[64:67]
    v_cvt_pk_bf16_f32 v59, v38, v39
    v_exp_f32 v42, v42
    v_mfma_f32_32x32x16_bf16 a[0:15], a[156:159], v[52:55], a[0:15]
    v_exp_f32 v43, v43
    v_cvt_pk_bf16_f32 v60, v40, v41
    v_exp_f32 v44, v44
    v_exp_f32 v45, v45
    v_cvt_pk_bf16_f32 v61, v42, v43
    v_exp_f32 v46, v46
    v_exp_f32 v47, v47
    v_cvt_pk_bf16_f32 v62, v44, v45
    v_mfma_f32_16x16x32_bf16 v[64:67], v[80:83], v[52:55], v[64:67]
    v_cvt_pk_bf16_f32 v63, v46, v47
    v_exp_f32 v16, v16
    v_mfma_f32_32x32x16_bf16 v[32:47], a[144:147], a[88:91], 0
    v_exp_f32 v17, v17
    v_exp_f32 v18, v18
    v_exp_f32 v19, v19
    v_cvt_pk_bf16_f32 v48, v16, v17
    v_mfma_f32_32x32x16_bf16 a[16:31], a[152:155], v[56:59], a[16:31]
    buffer_load_dwordx4 a[132:135], v1, s[8:11], s26 offen offset:3072 sc1
    s_add_u32 s26, s26, 4096
    v_exp_f32 v20, v20
    v_exp_f32 v21, v21
    v_cvt_pk_bf16_f32 v49, v18, v19
    v_exp_f32 v22, v22
    v_mfma_f32_32x32x16_bf16 v[32:47], a[148:151], a[92:95], v[32:47]
    v_exp_f32 v23, v23
    v_cvt_pk_bf16_f32 v50, v20, v21
L_pad_6:
    s_cbranch_execz L_pad_9
    v_exp_f32 v24, v24
    v_exp_f32 v25, v25
    v_mfma_f32_16x16x32_bf16 v[68:71], v[80:83], v[56:59], v[68:71]
    v_cvt_pk_bf16_f32 v51, v22, v23
    v_exp_f32 v26, v26
    v_mfma_f32_32x32x16_bf16 a[16:31], a[156:159], v[60:63], a[16:31]
    v_exp_f32 v27, v27
    v_cvt_pk_bf16_f32 v52, v24, v25
    v_exp_f32 v28, v28
    v_exp_f32 v29, v29
    v_cvt_pk_bf16_f32 v53, v26, v27
    v_exp_f32 v30, v30
    v_exp_f32 v31, v31
    v_cvt_pk_bf16_f32 v54, v28, v29
    v_mfma_f32_16x16x32_bf16 v[68:71], v[80:83], v[60:63], v[68:71]
    v_cvt_pk_bf16_f32 v55, v30, v31
    s_waitcnt vmcnt(12)
    v_exp_f32 v32, v32
    v_mfma_f32_32x32x16_bf16 v[16:31], a[96:99], a[64:67], 0
    v_exp_f32 v33, v33
    v_exp_f32 v34, v34
    v_exp_f32 v35, v35
    v_cvt_pk_bf16_f32 v56, v32, v33
    v_mfma_f32_32x32x16_bf16 a[32:47], a[152:155], v[48:51], a[32:47]
    buffer_load_dwordx4 a[136:139], v1, s[8:11], s27 offen offset:2048 sc1
    v_exp_f32 v36, v36
    v_exp_f32 v37, v37
    v_cvt_pk_bf16_f32 v57, v34, v35
    v_exp_f32 v38, v38
    v_mfma_f32_32x32x16_bf16 v[16:31], a[100:103], a[68:71], v[16:31]
    v_exp_f32 v39, v39
    v_cvt_pk_bf16_f32 v58, v36, v37
    v_exp_f32 v40, v40
    v_exp_f32 v41, v41
    v_mfma_f32_16x16x32_bf16 v[72:75], v[80:83], v[48:51], v[72:75]
    v_cvt_pk_bf16_f32 v59, v38, v39
    v_exp_f32 v42, v42
    v_mfma_f32_32x32x16_bf16 a[32:47], a[156:159], v[52:55], a[32:47]
    v_exp_f32 v43, v43
    buffer_store_dwordx4 v[184:187], v244, s[8:11], s46 offen offset:2048 sc1
    v_cvt_pk_bf16_f32 v60, v40, v41
    v_exp_f32 v44, v44
    v_exp_f32 v45, v45
    v_cvt_pk_bf16_f32 v61, v42, v43
    v_exp_f32 v46, v46
    v_exp_f32 v47, v47
    v_cvt_pk_bf16_f32 v62, v44, v45
    v_mfma_f32_16x16x32_bf16 v[72:75], v[80:83], v[52:55], v[72:75]
    v_cvt_pk_bf16_f32 v63, v46, v47
    v_exp_f32 v16, v16
    v_mfma_f32_32x32x16_bf16 v[32:47], a[96:99], a[72:75], 0
    v_exp_f32 v17, v17
    v_exp_f32 v18, v18
    v_exp_f32 v19, v19
    v_cvt_pk_bf16_f32 v48, v16, v17
    v_mfma_f32_32x32x16_bf16 a[48:63], a[152:155], v[56:59], a[48:63]
    buffer_load_dwordx4 a[140:143], v1, s[8:11], s27 offen offset:3072 sc1
    s_add_u32 s27, s27, 4096
    v_exp_f32 v20, v20
    v_exp_f32 v21, v21
    v_cvt_pk_bf16_f32 v49, v18, v19
    v_exp_f32 v22, v22
    v_mfma_f32_32x32x16_bf16 v[32:47], a[100:103], a[76:79], v[32:47]
    v_exp_f32 v23, v23
    v_cvt_pk_bf16_f32 v50, v20, v21
    v_exp_f32 v24, v24
    v_exp_f32 v25, v25
    v_mfma_f32_16x16x32_bf16 v[76:79], v[80:83], v[56:59], v[76:79]
    v_cvt_pk_bf16_f32 v51, v22, v23
    v_exp_f32 v26, v26
    v_mfma_f32_32x32x16_bf16 a[48:63], a[156:159], v[60:63], a[48:63]
    v_exp_f32 v27, v27
    v_cvt_pk_bf16_f32 v52, v24, v25
    v_exp_f32 v28, v28
    v_exp_f32 v29, v29
    v_cvt_pk_bf16_f32 v53, v26, v27
    v_exp_f32 v30, v30
    v_exp_f32 v31, v31
    v_cvt_pk_bf16_f32 v54, v28, v29
    v_mfma_f32_16x16x32_bf16 v[76:79], v[80:83], v[60:63], v[76:79]
    v_cvt_pk_bf16_f32 v55, v30, v31
    s_waitcnt vmcnt(12)
    v_exp_f32 v32, v32
    v_mfma_f32_32x32x16_bf16 v[16:31], a[96:99], a[80:83], 0
    v_exp_f32 v33, v33
    v_exp_f32 v34, v34
    v_exp_f32 v35, v35
    v_cvt_pk_bf16_f32 v56, v32, v33
    v_mfma_f32_32x32x16_bf16 a[0:15], a[104:107], v[48:51], a[0:15]
    buffer_load_dwordx4 a[144:147], v1, s[8:11], s26 offen offset:0 sc1
    v_exp_f32 v36, v36
    v_exp_f32 v37, v37
    v_cvt_pk_bf16_f32 v57, v34, v35
    v_exp_f32 v38, v38
    v_mfma_f32_32x32x16_bf16 v[16:31], a[100:103], a[84:87], v[16:31]
    v_exp_f32 v39, v39
    v_cvt_pk_bf16_f32 v58, v36, v37
    v_exp_f32 v40, v40
    v_exp_f32 v41, v41
    v_mfma_f32_16x16x32_bf16 v[64:67], v[80:83], v[48:51], v[64:67]
    v_cvt_pk_bf16_f32 v59, v38, v39
    v_exp_f32 v42, v42
    v_mfma_f32_32x32x16_bf16 a[0:15], a[108:111], v[52:55], a[0:15]
    v_exp_f32 v43, v43
    v_cvt_pk_bf16_f32 v60, v40, v41
    v_exp_f32 v44, v44
    v_exp_f32 v45, v45
    v_cvt_pk_bf16_f32 v61, v42, v43
    v_exp_f32 v46, v46
    v_exp_f32 v47, v47
    v_cvt_pk_bf16_f32 v62, v44, v45
    v_mfma_f32_16x16x32_bf16 v[64:67], v[80:83], v[52:55], v[64:67]
    v_cvt_pk_bf16_f32 v63, v46, v47
    v_exp_f32 v16, v16
    v_mfma_f32_32x32x16_bf16 v[32:47], a[96:99], a[88:91], 0
    v_exp_f32 v17, v17
    v_exp_f32 v18, v18
    v_exp_f32 v19, v19
    v_cvt_pk_bf16_f32 v48, v16, v17
    v_mfma_f32_32x32x16_bf16 a[16:31], a[104:107], v[56:59], a[16:31]
    buffer_load_dwordx4 a[148:151], v1, s[8:11], s26 offen offset:1024 sc1
    v_exp_f32 v20, v20
    v_exp_f32 v21, v21
    v_cvt_pk_bf16_f32 v49, v18, v19
    v_exp_f32 v22, v22
    v_mfma_f32_32x32x16_bf16 v[32:47], a[100:103], a[92:95], v[32:47]
    v_exp_f32 v23, v23
    v_cvt_pk_bf16_f32 v50, v20, v21
    v_exp_f32 v24, v24
    v_exp_f32 v25, v25
    v_mfma_f32_16x16x32_bf16 v[68:71], v[80:83], v[56:59], v[68:71]
    v_cvt_pk_bf16_f32 v51, v22, v23
    v_exp_f32 v26, v26
    v_mfma_f32_32x32x16_bf16 a[16:31], a[108:111], v[60:63], a[16:31]
    v_exp_f32 v27, v27
    buffer_store_dwordx4 v[188:191], v244, s[8:11], s47 offen offset:2048 sc1
    v_cvt_pk_bf16_f32 v52, v24, v25
    v_exp_f32 v28, v28
    v_exp_f32 v29, v29
    v_cvt_pk_bf16_f32 v53, v26, v27
    v_exp_f32 v30, v30
    v_exp_f32 v31, v31
    v_cvt_pk_bf16_f32 v54, v28, v29
    v_mfma_f32_16x16x32_bf16 v[68:71], v[80:83], v[60:63], v[68:71]
    v_cvt_pk_bf16_f32 v55, v30, v31
    s_waitcnt vmcnt(12)
    v_exp_f32 v32, v32
    v_mfma_f32_32x32x16_bf16 v[16:31], a[112:115], a[64:67], 0
    v_exp_f32 v33, v33
    v_exp_f32 v34, v34
    v_exp_f32 v35, v35
    v_cvt_pk_bf16_f32 v56, v32, v33
    v_mfma_f32_32x32x16_bf16 a[32:47], a[104:107], v[48:51], a[32:47]
    buffer_load_dwordx4 a[152:155], v1, s[8:11], s27 offen offset:0 sc1
    v_exp_f32 v36, v36
    v_exp_f32 v37, v37
    v_cvt_pk_bf16_f32 v57, v34, v35
    v_exp_f32 v38, v38
    v_mfma_f32_32x32x16_bf16 v[16:31], a[116:119], a[68:71], v[16:31]
    v_exp_f32 v39, v39
    v_cvt_pk_bf16_f32 v58, v36, v37
    v_exp_f32 v40, v40
    v_exp_f32 v41, v41
    v_mfma_f32_16x16x32_bf16 v[72:75], v[80:83], v[48:51], v[72:75]
    v_cvt_pk_bf16_f32 v59, v38, v39
    v_exp_f32 v42, v42
    v_mfma_f32_32x32x16_bf16 a[32:47], a[108:111], v[52:55], a[32:47]
    v_exp_f32 v43, v43
    v_cvt_pk_bf16_f32 v60, v40, v41
    v_exp_f32 v44, v44
    v_exp_f32 v45, v45
    v_cvt_pk_bf16_f32 v61, v42, v43
    v_exp_f32 v46, v46
    v_exp_f32 v47, v47
    v_cvt_pk_bf16_f32 v62, v44, v45
    v_mfma_f32_16x16x32_bf16 v[72:75], v[80:83], v[52:55], v[72:75]
    v_cvt_pk_bf16_f32 v63, v46, v47
    v_exp_f32 v16, v16
    v_mfma_f32_32x32x16_bf16 v[32:47], a[112:115], a[72:75], 0
    v_exp_f32 v17, v17
    v_exp_f32 v18, v18
    v_exp_f32 v19, v19
    v_cvt_pk_bf16_f32 v48, v16, v17
    v_mfma_f32_32x32x16_bf16 a[48:63], a[104:107], v[56:59], a[48:63]
    buffer_load_dwordx4 a[156:159], v1, s[8:11], s27 offen offset:1024 sc1
    v_exp_f32 v20, v20
    v_exp_f32 v21, v21
    v_cvt_pk_bf16_f32 v49, v18, v19
    v_exp_f32 v22, v22
    v_mfma_f32_32x32x16_bf16 v[32:47], a[116:119], a[76:79], v[32:47]
    v_exp_f32 v23, v23
    v_cvt_pk_bf16_f32 v50, v20, v21
    v_exp_f32 v24, v24
    v_exp_f32 v25, v25
    v_mfma_f32_16x16x32_bf16 v[76:79], v[80:83], v[56:59], v[76:79]
    v_cvt_pk_bf16_f32 v51, v22, v23
    v_exp_f32 v26, v26
    v_mfma_f32_32x32x16_bf16 a[48:63], a[108:111], v[60:63], a[48:63]
    v_exp_f32 v27, v27
    v_cvt_pk_bf16_f32 v52, v24, v25
    v_exp_f32 v28, v28
    v_exp_f32 v29, v29
    v_cvt_pk_bf16_f32 v53, v26, v27
    v_exp_f32 v30, v30
    v_exp_f32 v31, v31
    v_cvt_pk_bf16_f32 v54, v28, v29
    v_mfma_f32_16x16x32_bf16 v[76:79], v[80:83], v[60:63], v[76:79]
    v_cvt_pk_bf16_f32 v55, v30, v31
    s_waitcnt vmcnt(12)
    v_exp_f32 v32, v32
    v_mfma_f32_32x32x16_bf16 v[16:31], a[112:115], a[80:83], 0
    v_exp_f32 v33, v33
    v_exp_f32 v34, v34
    v_exp_f32 v35, v35
    v_cvt_pk_bf16_f32 v56, v32, v33
    v_mfma_f32_32x32x16_bf16 a[0:15], a[120:123], v[48:51], a[0:15]
    buffer_load_dwordx4 a[96:99], v1, s[8:11], s26 offen offset:2048 sc1
    v_exp_f32 v36, v36
    v_exp_f32 v37, v37
    v_cvt_pk_bf16_f32 v57, v34, v35
    v_exp_f32 v38, v38
    v_mfma_f32_32x32x16_bf16 v[16:31], a[116:119], a[84:87], v[16:31]
    v_exp_f32 v39, v39
    v_cvt_pk_bf16_f32 v58, v36, v37
    v_exp_f32 v40, v40
    v_exp_f32 v41, v41
    v_mfma_f32_16x16x32_bf16 v[64:67], v[80:83], v[48:51], v[64:67]
    v_cvt_pk_bf16_f32 v59, v38, v39
    v_exp_f32 v42, v42
    v_mfma_f32_32x32x16_bf16 a[0:15], a[124:127], v[52:55], a[0:15]
    v_exp_f32 v43, v43
    buffer_store_dwordx2 v[192:193], v245, s[8:11], s50 offen offset:3072 sc1
    v_cvt_pk_bf16_f32 v60, v40, v41
    v_exp_f32 v44, v44
    v_exp_f32 v45, v45
    v_cvt_pk_bf16_f32 v61, v42, v43
    v_exp_f32 v46, v46
    v_exp_f32 v47, v47
    v_cvt_pk_bf16_f32 v62, v44, v45
    v_mfma_f32_16x16x32_bf16 v[64:67], v[80:83], v[52:55], v[64:67]
    v_cvt_pk_bf16_f32 v63, v46, v47
    v_exp_f32 v16, v16
    v_mfma_f32_32x32x16_bf16 v[32:47], a[112:115], a[88:91], 0
    v_exp_f32 v17, v17
    v_exp_f32 v18, v18
    v_exp_f32 v19, v19
    v_cvt_pk_bf16_f32 v48, v16, v17
    v_mfma_f32_32x32x16_bf16 a[16:31], a[120:123], v[56:59], a[16:31]
    buffer_load_dwordx4 a[100:103], v1, s[8:11], s26 offen offset:3072 sc1
    s_add_u32 s26, s26, 4096
    v_exp_f32 v20, v20
    v_exp_f32 v21, v21
    v_cvt_pk_bf16_f32 v49, v18, v19
    v_exp_f32 v22, v22
    v_mfma_f32_32x32x16_bf16 v[32:47], a[116:119], a[92:95], v[32:47]
    v_exp_f32 v23, v23
    v_cvt_pk_bf16_f32 v50, v20, v21
    v_exp_f32 v24, v24
    v_exp_f32 v25, v25
    v_mfma_f32_16x16x32_bf16 v[68:71], v[80:83], v[56:59], v[68:71]
    v_cvt_pk_bf16_f32 v51, v22, v23
    v_exp_f32 v26, v26
    v_mfma_f32_32x32x16_bf16 a[16:31], a[124:127], v[60:63], a[16:31]
    v_exp_f32 v27, v27
    v_cvt_pk_bf16_f32 v52, v24, v25
    v_exp_f32 v28, v28
    v_exp_f32 v29, v29
    v_cvt_pk_bf16_f32 v53, v26, v27
    v_exp_f32 v30, v30
    v_exp_f32 v31, v31
    v_cvt_pk_bf16_f32 v54, v28, v29
    v_mfma_f32_16x16x32_bf16 v[68:71], v[80:83], v[60:63], v[68:71]
    v_cvt_pk_bf16_f32 v55, v30, v31
    s_waitcnt vmcnt(11)
    v_exp_f32 v32, v32
    v_mfma_f32_32x32x16_bf16 v[16:31], a[128:131], a[64:67], 0
    v_exp_f32 v33, v33
    v_exp_f32 v34, v34
    v_exp_f32 v35, v35
    v_cvt_pk_bf16_f32 v56, v32, v33
    v_mfma_f32_32x32x16_bf16 a[32:47], a[120:123], v[48:51], a[32:47]
    buffer_load_dwordx4 a[104:107], v1, s[8:11], s27 offen offset:2048 sc1
    v_exp_f32 v36, v36
    v_exp_f32 v37, v37
    v_cvt_pk_bf16_f32 v57, v34, v35
    v_exp_f32 v38, v38
    v_mfma_f32_32x32x16_bf16 v[16:31], a[132:135], a[68:71], v[16:31]
    v_exp_f32 v39, v39
    v_cvt_pk_bf16_f32 v58, v36, v37
    v_exp_f32 v40, v40
    v_exp_f32 v41, v41
    v_mfma_f32_16x16x32_bf16 v[72:75], v[80:83], v[48:51], v[72:75]
    v_cvt_pk_bf16_f32 v59, v38, v39
    v_exp_f32 v42, v42
    v_mfma_f32_32x32x16_bf16 a[32:47], a[124:127], v[52:55], a[32:47]
    v_exp_f32 v43, v43
    v_cvt_pk_bf16_f32 v60, v40, v41
    v_exp_f32 v44, v44
    v_exp_f32 v45, v45
    v_cvt_pk_bf16_f32 v61, v42, v43
    v_exp_f32 v46, v46
    v_exp_f32 v47, v47
    v_cvt_pk_bf16_f32 v62, v44, v45
    v_mfma_f32_16x16x32_bf16 v[72:75], v[80:83], v[52:55], v[72:75]
    v_cvt_pk_bf16_f32 v63, v46, v47
    v_exp_f32 v16, v16
    v_mfma_f32_32x32x16_bf16 v[32:47], a[128:131], a[72:75], 0
    v_exp_f32 v17, v17
    v_exp_f32 v18, v18
    v_exp_f32 v19, v19
    v_cvt_pk_bf16_f32 v48, v16, v17
    v_mfma_f32_32x32x16_bf16 a[48:63], a[120:123], v[56:59], a[48:63]
    buffer_load_dwordx4 a[108:111], v1, s[8:11], s27 offen offset:3072 sc1
    s_add_u32 s27, s27, 4096
    v_exp_f32 v20, v20
    v_exp_f32 v21, v21
    v_cvt_pk_bf16_f32 v49, v18, v19
    v_exp_f32 v22, v22
    v_mfma_f32_32x32x16_bf16 v[32:47], a[132:135], a[76:79], v[32:47]
    v_exp_f32 v23, v23
    v_cvt_pk_bf16_f32 v50, v20, v21
    v_exp_f32 v24, v24
    v_exp_f32 v25, v25
    v_mfma_f32_16x16x32_bf16 v[76:79], v[80:83], v[56:59], v[76:79]
    v_cvt_pk_bf16_f32 v51, v22, v23
    v_exp_f32 v26, v26
    v_mfma_f32_32x32x16_bf16 a[48:63], a[124:127], v[60:63], a[48:63]
    v_exp_f32 v27, v27
    buffer_store_dwordx2 v[194:195], v245, s[8:11], s51 offen offset:3072 sc1
    v_cvt_pk_bf16_f32 v52, v24, v25
    v_exp_f32 v28, v28
    v_exp_f32 v29, v29
    v_cvt_pk_bf16_f32 v53, v26, v27
    v_exp_f32 v30, v30
    v_exp_f32 v31, v31
    v_cvt_pk_bf16_f32 v54, v28, v29
    v_mfma_f32_16x16x32_bf16 v[76:79], v[80:83], v[60:63], v[76:79]
    v_cvt_pk_bf16_f32 v55, v30, v31
    s_waitcnt vmcnt(11)
    v_exp_f32 v32, v32
    v_mfma_f32_32x32x16_bf16 v[16:31], a[128:131], a[80:83], 0
    v_exp_f32 v33, v33
    v_exp_f32 v34, v34
    v_exp_f32 v35, v35
    v_cvt_pk_bf16_f32 v56, v32, v33
    v_mfma_f32_32x32x16_bf16 a[0:15], a[136:139], v[48:51], a[0:15]
    buffer_load_dwordx4 a[112:115], v1, s[8:11], s26 offen offset:0 sc1
    v_exp_f32 v36, v36
    v_exp_f32 v37, v37
    v_cvt_pk_bf16_f32 v57, v34, v35
    v_exp_f32 v38, v38
    v_mfma_f32_32x32x16_bf16 v[16:31], a[132:135], a[84:87], v[16:31]
    v_exp_f32 v39, v39
    v_cvt_pk_bf16_f32 v58, v36, v37
    v_exp_f32 v40, v40
    v_exp_f32 v41, v41
    v_mfma_f32_16x16x32_bf16 v[64:67], v[80:83], v[48:51], v[64:67]
    v_cvt_pk_bf16_f32 v59, v38, v39
    v_exp_f32 v42, v42
    v_mfma_f32_32x32x16_bf16 a[0:15], a[140:143], v[52:55], a[0:15]
    v_exp_f32 v43, v43
    v_cvt_pk_bf16_f32 v60, v40, v41
    v_exp_f32 v44, v44
    v_exp_f32 v45, v45
    v_cvt_pk_bf16_f32 v61, v42, v43
    v_exp_f32 v46, v46
    v_exp_f32 v47, v47
    v_cvt_pk_bf16_f32 v62, v44, v45
    v_mfma_f32_16x16x32_bf16 v[64:67], v[80:83], v[52:55], v[64:67]
    v_cvt_pk_bf16_f32 v63, v46, v47
    v_exp_f32 v16, v16
    v_mfma_f32_32x32x16_bf16 v[32:47], a[128:131], a[88:91], 0
    v_exp_f32 v17, v17
    v_exp_f32 v18, v18
    v_exp_f32 v19, v19
    v_cvt_pk_bf16_f32 v48, v16, v17
    v_mfma_f32_32x32x16_bf16 a[16:31], a[136:139], v[56:59], a[16:31]
    buffer_load_dwordx4 a[116:119], v1, s[8:11], s26 offen offset:1024 sc1
    v_exp_f32 v20, v20
    v_exp_f32 v21, v21
    v_cvt_pk_bf16_f32 v49, v18, v19
    v_exp_f32 v22, v22
    v_mfma_f32_32x32x16_bf16 v[32:47], a[132:135], a[92:95], v[32:47]
    v_exp_f32 v23, v23
    v_cvt_pk_bf16_f32 v50, v20, v21
    v_exp_f32 v24, v24
    v_exp_f32 v25, v25
    v_mfma_f32_16x16x32_bf16 v[68:71], v[80:83], v[56:59], v[68:71]
    v_cvt_pk_bf16_f32 v51, v22, v23
    v_exp_f32 v26, v26
    v_mfma_f32_32x32x16_bf16 a[16:31], a[140:143], v[60:63], a[16:31]
    v_exp_f32 v27, v27
    v_cvt_pk_bf16_f32 v52, v24, v25
    v_exp_f32 v28, v28
    v_exp_f32 v29, v29
    v_cvt_pk_bf16_f32 v53, v26, v27
    v_exp_f32 v30, v30
    v_exp_f32 v31, v31
    v_cvt_pk_bf16_f32 v54, v28, v29
    v_mfma_f32_16x16x32_bf16 v[68:71], v[80:83], v[60:63], v[68:71]
    v_cvt_pk_bf16_f32 v55, v30, v31
    s_waitcnt vmcnt(11)
    v_exp_f32 v32, v32
    v_mfma_f32_32x32x16_bf16 v[16:31], a[144:147], a[64:67], 0
    v_exp_f32 v33, v33
    v_exp_f32 v34, v34
    v_exp_f32 v35, v35
    v_cvt_pk_bf16_f32 v56, v32, v33
    v_mfma_f32_32x32x16_bf16 a[32:47], a[136:139], v[48:51], a[32:47]
    buffer_load_dwordx4 a[120:123], v1, s[8:11], s27 offen offset:0 sc1
    v_exp_f32 v36, v36
    v_exp_f32 v37, v37
    v_cvt_pk_bf16_f32 v57, v34, v35
    v_exp_f32 v38, v38
    v_mfma_f32_32x32x16_bf16 v[16:31], a[148:151], a[68:71], v[16:31]
    v_exp_f32 v39, v39
    v_cvt_pk_bf16_f32 v58, v36, v37
    v_exp_f32 v40, v40
    v_exp_f32 v41, v41
    v_mfma_f32_16x16x32_bf16 v[72:75], v[80:83], v[48:51], v[72:75]
    v_cvt_pk_bf16_f32 v59, v38, v39
    v_exp_f32 v42, v42
    v_mfma_f32_32x32x16_bf16 a[32:47], a[140:143], v[52:55], a[32:47]
    v_exp_f32 v43, v43
    buffer_store_dwordx2 v[196:197], v245, s[8:11], s46 offen offset:3072 sc1
    buffer_load_dwordx4 a[240:243], v1, s[52:55], s66 offen offset:0
    v_cvt_pk_bf16_f32 v60, v40, v41
    v_exp_f32 v44, v44
    v_exp_f32 v45, v45
    v_cvt_pk_bf16_f32 v61, v42, v43
    v_exp_f32 v46, v46
    v_exp_f32 v47, v47
    v_cvt_pk_bf16_f32 v62, v44, v45
    v_mfma_f32_16x16x32_bf16 v[72:75], v[80:83], v[52:55], v[72:75]
    v_cvt_pk_bf16_f32 v63, v46, v47
    v_exp_f32 v16, v16
    v_mfma_f32_32x32x16_bf16 v[32:47], a[144:147], a[72:75], 0
    v_exp_f32 v17, v17
    v_exp_f32 v18, v18
    v_exp_f32 v19, v19
    v_cvt_pk_bf16_f32 v48, v16, v17
    v_mfma_f32_32x32x16_bf16 a[48:63], a[136:139], v[56:59], a[48:63]
    buffer_load_dwordx4 a[124:127], v1, s[8:11], s27 offen offset:1024 sc1
    v_exp_f32 v20, v20
    v_exp_f32 v21, v21
    v_cvt_pk_bf16_f32 v49, v18, v19
    v_exp_f32 v22, v22
    v_mfma_f32_32x32x16_bf16 v[32:47], a[148:151], a[76:79], v[32:47]
    v_exp_f32 v23, v23
    v_cvt_pk_bf16_f32 v50, v20, v21
    v_exp_f32 v24, v24
    v_exp_f32 v25, v25
    v_mfma_f32_16x16x32_bf16 v[76:79], v[80:83], v[56:59], v[76:79]
    v_cvt_pk_bf16_f32 v51, v22, v23
    v_exp_f32 v26, v26
    v_mfma_f32_32x32x16_bf16 a[48:63], a[140:143], v[60:63], a[48:63]
    v_exp_f32 v27, v27
    v_cvt_pk_bf16_f32 v52, v24, v25
    v_exp_f32 v28, v28
    v_exp_f32 v29, v29
    v_cvt_pk_bf16_f32 v53, v26, v27
    v_exp_f32 v30, v30
    v_exp_f32 v31, v31
    v_cvt_pk_bf16_f32 v54, v28, v29
    v_mfma_f32_16x16x32_bf16 v[76:79], v[80:83], v[60:63], v[76:79]
    v_cvt_pk_bf16_f32 v55, v30, v31
    s_waitcnt vmcnt(12)
    v_exp_f32 v32, v32
    v_mfma_f32_32x32x16_bf16 v[16:31], a[144:147], a[80:83], 0
    v_exp_f32 v33, v33
    v_exp_f32 v34, v34
    v_exp_f32 v35, v35
    v_cvt_pk_bf16_f32 v56, v32, v33
    v_mfma_f32_32x32x16_bf16 a[0:15], a[152:155], v[48:51], a[0:15]
    buffer_load_dwordx4 a[128:131], v1, s[8:11], s26 offen offset:2048 sc1
    v_exp_f32 v36, v36
    v_exp_f32 v37, v37
    v_cvt_pk_bf16_f32 v57, v34, v35
    v_exp_f32 v38, v38
    v_mfma_f32_32x32x16_bf16 v[16:31], a[148:151], a[84:87], v[16:31]
    v_exp_f32 v39, v39
    v_cvt_pk_bf16_f32 v58, v36, v37
    v_exp_f32 v40, v40
    v_exp_f32 v41, v41
    v_mfma_f32_16x16x32_bf16 v[64:67], v[80:83], v[48:51], v[64:67]
    v_cvt_pk_bf16_f32 v59, v38, v39
    v_exp_f32 v42, v42
    v_mfma_f32_32x32x16_bf16 a[0:15], a[156:159], v[52:55], a[0:15]
    v_exp_f32 v43, v43
    v_cvt_pk_bf16_f32 v60, v40, v41
    v_exp_f32 v44, v44
    v_exp_f32 v45, v45
    v_cvt_pk_bf16_f32 v61, v42, v43
    v_exp_f32 v46, v46
    v_exp_f32 v47, v47
    v_cvt_pk_bf16_f32 v62, v44, v45
    v_mfma_f32_16x16x32_bf16 v[64:67], v[80:83], v[52:55], v[64:67]
    v_cvt_pk_bf16_f32 v63, v46, v47
    v_exp_f32 v16, v16
    v_mfma_f32_32x32x16_bf16 v[32:47], a[144:147], a[88:91], 0
    v_exp_f32 v17, v17
    v_exp_f32 v18, v18
    v_exp_f32 v19, v19
    v_cvt_pk_bf16_f32 v48, v16, v17
    v_mfma_f32_32x32x16_bf16 a[16:31], a[152:155], v[56:59], a[16:31]
    buffer_load_dwordx4 a[132:135], v1, s[8:11], s26 offen offset:3072 sc1
    s_add_u32 s26, s26, 4096
    v_exp_f32 v20, v20
    v_exp_f32 v21, v21
    v_cvt_pk_bf16_f32 v49, v18, v19
    v_exp_f32 v22, v22
    v_mfma_f32_32x32x16_bf16 v[32:47], a[148:151], a[92:95], v[32:47]
    v_exp_f32 v23, v23
    v_cvt_pk_bf16_f32 v50, v20, v21
    v_exp_f32 v24, v24
    v_exp_f32 v25, v25
    v_mfma_f32_16x16x32_bf16 v[68:71], v[80:83], v[56:59], v[68:71]
    v_cvt_pk_bf16_f32 v51, v22, v23
    v_exp_f32 v26, v26
    v_mfma_f32_32x32x16_bf16 a[16:31], a[156:159], v[60:63], a[16:31]
    v_exp_f32 v27, v27
    buffer_store_dwordx2 v[198:199], v245, s[8:11], s47 offen offset:3072 sc1
    v_cvt_pk_bf16_f32 v52, v24, v25
    v_exp_f32 v28, v28
    v_exp_f32 v29, v29
    v_cvt_pk_bf16_f32 v53, v26, v27
    v_exp_f32 v30, v30
    v_exp_f32 v31, v31
    v_cvt_pk_bf16_f32 v54, v28, v29
    v_mfma_f32_16x16x32_bf16 v[68:71], v[80:83], v[60:63], v[68:71]
    v_cvt_pk_bf16_f32 v55, v30, v31
    s_waitcnt vmcnt(12)
    v_exp_f32 v32, v32
    v_mfma_f32_32x32x16_bf16 v[16:31], a[96:99], a[64:67], 0
    v_exp_f32 v33, v33
    v_exp_f32 v34, v34
    v_exp_f32 v35, v35
    v_cvt_pk_bf16_f32 v56, v32, v33
    v_mfma_f32_32x32x16_bf16 a[32:47], a[152:155], v[48:51], a[32:47]
    buffer_load_dwordx4 a[136:139], v1, s[8:11], s27 offen offset:2048 sc1
    v_exp_f32 v36, v36
    v_exp_f32 v37, v37
    v_cvt_pk_bf16_f32 v57, v34, v35
    v_exp_f32 v38, v38
    v_mfma_f32_32x32x16_bf16 v[16:31], a[100:103], a[68:71], v[16:31]
    v_exp_f32 v39, v39
    v_cvt_pk_bf16_f32 v58, v36, v37
    v_exp_f32 v40, v40
    v_exp_f32 v41, v41
    v_mfma_f32_16x16x32_bf16 v[72:75], v[80:83], v[48:51], v[72:75]
    v_cvt_pk_bf16_f32 v59, v38, v39
    v_exp_f32 v42, v42
    v_mfma_f32_32x32x16_bf16 a[32:47], a[156:159], v[52:55], a[32:47]
    v_exp_f32 v43, v43
    v_cvt_pk_bf16_f32 v60, v40, v41
    v_exp_f32 v44, v44
    v_exp_f32 v45, v45
    v_cvt_pk_bf16_f32 v61, v42, v43
    v_exp_f32 v46, v46
    v_exp_f32 v47, v47
    v_cvt_pk_bf16_f32 v62, v44, v45
    v_mfma_f32_16x16x32_bf16 v[72:75], v[80:83], v[52:55], v[72:75]
    v_cvt_pk_bf16_f32 v63, v46, v47
    v_exp_f32 v16, v16
    v_mfma_f32_32x32x16_bf16 v[32:47], a[96:99], a[72:75], 0
    v_exp_f32 v17, v17
    v_exp_f32 v18, v18
    v_exp_f32 v19, v19
    v_cvt_pk_bf16_f32 v48, v16, v17
    v_mfma_f32_32x32x16_bf16 a[48:63], a[152:155], v[56:59], a[48:63]
    buffer_load_dwordx4 a[140:143], v1, s[8:11], s27 offen offset:3072 sc1
    s_add_u32 s27, s27, 4096
    v_exp_f32 v20, v20
    v_exp_f32 v21, v21
    v_cvt_pk_bf16_f32 v49, v18, v19
    v_exp_f32 v22, v22
    v_mfma_f32_32x32x16_bf16 v[32:47], a[100:103], a[76:79], v[32:47]
    v_exp_f32 v23, v23
    v_cvt_pk_bf16_f32 v50, v20, v21
    v_exp_f32 v24, v24
    v_exp_f32 v25, v25
    v_mfma_f32_16x16x32_bf16 v[76:79], v[80:83], v[56:59], v[76:79]
    v_cvt_pk_bf16_f32 v51, v22, v23
    v_exp_f32 v26, v26
    v_mfma_f32_32x32x16_bf16 a[48:63], a[156:159], v[60:63], a[48:63]
    v_exp_f32 v27, v27
    v_cvt_pk_bf16_f32 v52, v24, v25
    v_exp_f32 v28, v28
    v_exp_f32 v29, v29
    v_cvt_pk_bf16_f32 v53, v26, v27
    v_exp_f32 v30, v30
    v_exp_f32 v31, v31
    v_cvt_pk_bf16_f32 v54, v28, v29
    v_mfma_f32_16x16x32_bf16 v[76:79], v[80:83], v[60:63], v[76:79]
    v_cvt_pk_bf16_f32 v55, v30, v31
    s_waitcnt vmcnt(12)
    v_exp_f32 v32, v32
    v_mfma_f32_32x32x16_bf16 v[16:31], a[96:99], a[80:83], 0
    v_exp_f32 v33, v33
    v_exp_f32 v34, v34
    v_exp_f32 v35, v35
    v_cvt_pk_bf16_f32 v56, v32, v33
    v_mfma_f32_32x32x16_bf16 a[0:15], a[104:107], v[48:51], a[0:15]
    buffer_load_dwordx4 a[144:147], v1, s[8:11], s26 offen offset:0 sc1
    v_exp_f32 v36, v36
    v_exp_f32 v37, v37
    v_cvt_pk_bf16_f32 v57, v34, v35
    v_exp_f32 v38, v38
    v_mfma_f32_32x32x16_bf16 v[16:31], a[100:103], a[84:87], v[16:31]
    v_exp_f32 v39, v39
    v_cvt_pk_bf16_f32 v58, v36, v37
    v_exp_f32 v40, v40
    v_exp_f32 v41, v41
    v_mfma_f32_16x16x32_bf16 v[64:67], v[80:83], v[48:51], v[64:67]
    v_cvt_pk_bf16_f32 v59, v38, v39
    v_exp_f32 v42, v42
    v_mfma_f32_32x32x16_bf16 a[0:15], a[108:111], v[52:55], a[0:15]
    v_exp_f32 v43, v43
    v_cvt_pk_bf16_f32 v60, v40, v41
    v_exp_f32 v44, v44
    v_exp_f32 v45, v45
    v_cvt_pk_bf16_f32 v61, v42, v43
    v_exp_f32 v46, v46
    v_exp_f32 v47, v47
    v_cvt_pk_bf16_f32 v62, v44, v45
    v_mfma_f32_16x16x32_bf16 v[64:67], v[80:83], v[52:55], v[64:67]
    v_cvt_pk_bf16_f32 v63, v46, v47
    v_exp_f32 v16, v16
    v_mfma_f32_32x32x16_bf16 v[32:47], a[96:99], a[88:91], 0
    v_exp_f32 v17, v17
    v_exp_f32 v18, v18
    v_exp_f32 v19, v19
    v_cvt_pk_bf16_f32 v48, v16, v17
    v_mfma_f32_32x32x16_bf16 a[16:31], a[104:107], v[56:59], a[16:31]
    buffer_load_dwordx4 a[148:151], v1, s[8:11], s26 offen offset:1024 sc1
    v_exp_f32 v20, v20
    v_exp_f32 v21, v21
    v_cvt_pk_bf16_f32 v49, v18, v19
    v_exp_f32 v22, v22
    v_mfma_f32_32x32x16_bf16 v[32:47], a[100:103], a[92:95], v[32:47]
    v_exp_f32 v23, v23
    v_cvt_pk_bf16_f32 v50, v20, v21
    v_exp_f32 v24, v24
    v_exp_f32 v25, v25
    v_mfma_f32_16x16x32_bf16 v[68:71], v[80:83], v[56:59], v[68:71]
    v_cvt_pk_bf16_f32 v51, v22, v23
    v_exp_f32 v26, v26
    v_mfma_f32_32x32x16_bf16 a[16:31], a[108:111], v[60:63], a[16:31]
    v_exp_f32 v27, v27
    v_cvt_pk_bf16_f32 v52, v24, v25
    v_exp_f32 v28, v28
    v_exp_f32 v29, v29
    v_cvt_pk_bf16_f32 v53, v26, v27
    v_exp_f32 v30, v30
    v_exp_f32 v31, v31
    v_cvt_pk_bf16_f32 v54, v28, v29
    v_mfma_f32_16x16x32_bf16 v[68:71], v[80:83], v[60:63], v[68:71]
    v_cvt_pk_bf16_f32 v55, v30, v31
    s_waitcnt vmcnt(11)
    v_exp_f32 v32, v32
    v_mfma_f32_32x32x16_bf16 v[16:31], a[112:115], a[64:67], 0
    v_exp_f32 v33, v33
    v_exp_f32 v34, v34
    v_exp_f32 v35, v35
    v_cvt_pk_bf16_f32 v56, v32, v33
    v_mfma_f32_32x32x16_bf16 a[32:47], a[104:107], v[48:51], a[32:47]
    buffer_load_dwordx4 a[152:155], v1, s[8:11], s27 offen offset:0 sc1
    v_exp_f32 v36, v36
    v_exp_f32 v37, v37
    v_cvt_pk_bf16_f32 v57, v34, v35
    v_exp_f32 v38, v38
    v_mfma_f32_32x32x16_bf16 v[16:31], a[116:119], a[68:71], v[16:31]
    v_exp_f32 v39, v39
    v_cvt_pk_bf16_f32 v58, v36, v37
    v_exp_f32 v40, v40
    v_exp_f32 v41, v41
    v_mfma_f32_16x16x32_bf16 v[72:75], v[80:83], v[48:51], v[72:75]
    v_cvt_pk_bf16_f32 v59, v38, v39
    v_exp_f32 v42, v42
    v_mfma_f32_32x32x16_bf16 a[32:47], a[108:111], v[52:55], a[32:47]
    v_exp_f32 v43, v43
    v_cvt_pk_bf16_f32 v60, v40, v41
    v_exp_f32 v44, v44
    v_exp_f32 v45, v45
    v_cvt_pk_bf16_f32 v61, v42, v43
    v_exp_f32 v46, v46
    v_exp_f32 v47, v47
    v_cvt_pk_bf16_f32 v62, v44, v45
    v_mfma_f32_16x16x32_bf16 v[72:75], v[80:83], v[52:55], v[72:75]
L_pad_7:
    s_cbranch_execz L_pad_10
    v_cvt_pk_bf16_f32 v63, v46, v47
    v_exp_f32 v16, v16
    v_mfma_f32_32x32x16_bf16 v[32:47], a[112:115], a[72:75], 0
    v_exp_f32 v17, v17
    v_exp_f32 v18, v18
    v_exp_f32 v19, v19
    v_cvt_pk_bf16_f32 v48, v16, v17
    v_mfma_f32_32x32x16_bf16 a[48:63], a[104:107], v[56:59], a[48:63]
    buffer_load_dwordx4 a[156:159], v1, s[8:11], s27 offen offset:1024 sc1
    v_exp_f32 v20, v20
    v_exp_f32 v21, v21
    v_cvt_pk_bf16_f32 v49, v18, v19
    v_exp_f32 v22, v22
    v_mfma_f32_32x32x16_bf16 v[32:47], a[116:119], a[76:79], v[32:47]
    v_exp_f32 v23, v23
    v_cvt_pk_bf16_f32 v50, v20, v21
    v_exp_f32 v24, v24
    v_exp_f32 v25, v25
    v_mfma_f32_16x16x32_bf16 v[76:79], v[80:83], v[56:59], v[76:79]
    v_cvt_pk_bf16_f32 v51, v22, v23
    v_exp_f32 v26, v26
    v_mfma_f32_32x32x16_bf16 a[48:63], a[108:111], v[60:63], a[48:63]
    v_exp_f32 v27, v27
    v_cvt_pk_bf16_f32 v52, v24, v25
    v_exp_f32 v28, v28
    v_exp_f32 v29, v29
    v_cvt_pk_bf16_f32 v53, v26, v27
    v_exp_f32 v30, v30
    v_exp_f32 v31, v31
    v_cvt_pk_bf16_f32 v54, v28, v29
    v_mfma_f32_16x16x32_bf16 v[76:79], v[80:83], v[60:63], v[76:79]
    v_cvt_pk_bf16_f32 v55, v30, v31
    s_waitcnt vmcnt(9)
    v_exp_f32 v32, v32
    v_mfma_f32_32x32x16_bf16 v[16:31], a[112:115], a[80:83], 0
    v_exp_f32 v33, v33
    v_exp_f32 v34, v34
    v_exp_f32 v35, v35
    v_cvt_pk_bf16_f32 v56, v32, v33
    v_mfma_f32_32x32x16_bf16 a[0:15], a[120:123], v[48:51], a[0:15]
    buffer_load_dwordx4 a[96:99], v1, s[8:11], s26 offen offset:2048 sc1
    v_exp_f32 v36, v36
    v_exp_f32 v37, v37
    v_cvt_pk_bf16_f32 v57, v34, v35
    v_exp_f32 v38, v38
    v_mfma_f32_32x32x16_bf16 v[16:31], a[116:119], a[84:87], v[16:31]
    v_exp_f32 v39, v39
    v_cvt_pk_bf16_f32 v58, v36, v37
    v_exp_f32 v40, v40
    v_exp_f32 v41, v41
    v_mfma_f32_16x16x32_bf16 v[64:67], v[80:83], v[48:51], v[64:67]
    v_cvt_pk_bf16_f32 v59, v38, v39
    v_exp_f32 v42, v42
    v_mfma_f32_32x32x16_bf16 a[0:15], a[124:127], v[52:55], a[0:15]
    v_exp_f32 v43, v43
    buffer_load_dwordx4 a[240:243], v1, s[52:55], s66 offen offset:1024
    v_cvt_pk_bf16_f32 v60, v40, v41
    v_exp_f32 v44, v44
    v_exp_f32 v45, v45
    v_cvt_pk_bf16_f32 v61, v42, v43
    v_exp_f32 v46, v46
    v_exp_f32 v47, v47
    v_cvt_pk_bf16_f32 v62, v44, v45
    v_mfma_f32_16x16x32_bf16 v[64:67], v[80:83], v[52:55], v[64:67]
    v_cvt_pk_bf16_f32 v63, v46, v47
    v_exp_f32 v16, v16
    v_mfma_f32_32x32x16_bf16 v[32:47], a[112:115], a[88:91], 0
    v_exp_f32 v17, v17
    v_exp_f32 v18, v18
    v_exp_f32 v19, v19
    v_cvt_pk_bf16_f32 v48, v16, v17
    v_mfma_f32_32x32x16_bf16 a[16:31], a[120:123], v[56:59], a[16:31]
    buffer_load_dwordx4 a[100:103], v1, s[8:11], s26 offen offset:3072 sc1
    s_add_u32 s26, s26, 4096
    v_exp_f32 v20, v20
    v_exp_f32 v21, v21
    v_cvt_pk_bf16_f32 v49, v18, v19
    v_exp_f32 v22, v22
    v_mfma_f32_32x32x16_bf16 v[32:47], a[116:119], a[92:95], v[32:47]
    v_exp_f32 v23, v23
    v_cvt_pk_bf16_f32 v50, v20, v21
    v_exp_f32 v24, v24
    v_exp_f32 v25, v25
    v_mfma_f32_16x16x32_bf16 v[68:71], v[80:83], v[56:59], v[68:71]
    v_cvt_pk_bf16_f32 v51, v22, v23
    v_exp_f32 v26, v26
    v_mfma_f32_32x32x16_bf16 a[16:31], a[124:127], v[60:63], a[16:31]
    v_exp_f32 v27, v27
    v_cvt_pk_bf16_f32 v52, v24, v25
    v_exp_f32 v28, v28
    v_exp_f32 v29, v29
    v_cvt_pk_bf16_f32 v53, v26, v27
    v_exp_f32 v30, v30
    v_exp_f32 v31, v31
    v_cvt_pk_bf16_f32 v54, v28, v29
    v_mfma_f32_16x16x32_bf16 v[68:71], v[80:83], v[60:63], v[68:71]
    v_cvt_pk_bf16_f32 v55, v30, v31
    s_waitcnt vmcnt(10)
    v_exp_f32 v32, v32
    v_mfma_f32_32x32x16_bf16 v[16:31], a[128:131], a[64:67], 0
    v_exp_f32 v33, v33
    v_exp_f32 v34, v34
    v_exp_f32 v35, v35
    v_cvt_pk_bf16_f32 v56, v32, v33
    v_mfma_f32_32x32x16_bf16 a[32:47], a[120:123], v[48:51], a[32:47]
    buffer_load_dwordx4 a[104:107], v1, s[8:11], s27 offen offset:2048 sc1
    v_exp_f32 v36, v36
    v_exp_f32 v37, v37
    v_cvt_pk_bf16_f32 v57, v34, v35
    v_exp_f32 v38, v38
    v_mfma_f32_32x32x16_bf16 v[16:31], a[132:135], a[68:71], v[16:31]
    v_exp_f32 v39, v39
    v_cvt_pk_bf16_f32 v58, v36, v37
    v_exp_f32 v40, v40
    v_exp_f32 v41, v41
    v_mfma_f32_16x16x32_bf16 v[72:75], v[80:83], v[48:51], v[72:75]
    v_cvt_pk_bf16_f32 v59, v38, v39
    v_exp_f32 v42, v42
    v_mfma_f32_32x32x16_bf16 a[32:47], a[124:127], v[52:55], a[32:47]
    v_exp_f32 v43, v43
    v_cvt_pk_bf16_f32 v60, v40, v41
    v_exp_f32 v44, v44
    v_exp_f32 v45, v45
    v_cvt_pk_bf16_f32 v61, v42, v43
    v_exp_f32 v46, v46
    v_exp_f32 v47, v47
    v_cvt_pk_bf16_f32 v62, v44, v45
    v_mfma_f32_16x16x32_bf16 v[72:75], v[80:83], v[52:55], v[72:75]
    v_cvt_pk_bf16_f32 v63, v46, v47
    v_exp_f32 v16, v16
    v_mfma_f32_32x32x16_bf16 v[32:47], a[128:131], a[72:75], 0
    v_exp_f32 v17, v17
    v_exp_f32 v18, v18
    v_exp_f32 v19, v19
    v_cvt_pk_bf16_f32 v48, v16, v17
    v_mfma_f32_32x32x16_bf16 a[48:63], a[120:123], v[56:59], a[48:63]
    buffer_load_dwordx4 a[108:111], v1, s[8:11], s27 offen offset:3072 sc1
    s_add_u32 s27, s27, 4096
    v_exp_f32 v20, v20
    v_exp_f32 v21, v21
    v_cvt_pk_bf16_f32 v49, v18, v19
    v_exp_f32 v22, v22
    v_mfma_f32_32x32x16_bf16 v[32:47], a[132:135], a[76:79], v[32:47]
    v_exp_f32 v23, v23
    v_cvt_pk_bf16_f32 v50, v20, v21
    v_exp_f32 v24, v24
    v_exp_f32 v25, v25
    v_mfma_f32_16x16x32_bf16 v[76:79], v[80:83], v[56:59], v[76:79]
    v_cvt_pk_bf16_f32 v51, v22, v23
    v_exp_f32 v26, v26
    v_mfma_f32_32x32x16_bf16 a[48:63], a[124:127], v[60:63], a[48:63]
    v_exp_f32 v27, v27
    v_cvt_pk_bf16_f32 v52, v24, v25
    v_exp_f32 v28, v28
    v_exp_f32 v29, v29
    v_cvt_pk_bf16_f32 v53, v26, v27
    v_exp_f32 v30, v30
    v_exp_f32 v31, v31
    v_cvt_pk_bf16_f32 v54, v28, v29
    v_mfma_f32_16x16x32_bf16 v[76:79], v[80:83], v[60:63], v[76:79]
    v_cvt_pk_bf16_f32 v55, v30, v31
    s_waitcnt vmcnt(9)
    v_exp_f32 v32, v32
    v_mfma_f32_32x32x16_bf16 v[16:31], a[128:131], a[80:83], 0
    v_exp_f32 v33, v33
    v_exp_f32 v34, v34
    v_exp_f32 v35, v35
    v_cvt_pk_bf16_f32 v56, v32, v33
    v_mfma_f32_32x32x16_bf16 a[0:15], a[136:139], v[48:51], a[0:15]
    buffer_load_dwordx4 a[112:115], v1, s[8:11], s26 offen offset:0 sc1
    v_exp_f32 v36, v36
    v_exp_f32 v37, v37
    v_cvt_pk_bf16_f32 v57, v34, v35
    v_exp_f32 v38, v38
    v_mfma_f32_32x32x16_bf16 v[16:31], a[132:135], a[84:87], v[16:31]
    v_exp_f32 v39, v39
    v_cvt_pk_bf16_f32 v58, v36, v37
    v_exp_f32 v40, v40
    v_exp_f32 v41, v41
    v_mfma_f32_16x16x32_bf16 v[64:67], v[80:83], v[48:51], v[64:67]
    v_cvt_pk_bf16_f32 v59, v38, v39
    v_exp_f32 v42, v42
    v_mfma_f32_32x32x16_bf16 a[0:15], a[140:143], v[52:55], a[0:15]
    v_exp_f32 v43, v43
    v_cvt_pk_bf16_f32 v60, v40, v41
    v_exp_f32 v44, v44
    v_exp_f32 v45, v45
    v_cvt_pk_bf16_f32 v61, v42, v43
    v_exp_f32 v46, v46
    v_exp_f32 v47, v47
    v_cvt_pk_bf16_f32 v62, v44, v45
    v_mfma_f32_16x16x32_bf16 v[64:67], v[80:83], v[52:55], v[64:67]
    v_cvt_pk_bf16_f32 v63, v46, v47
    v_exp_f32 v16, v16
    v_mfma_f32_32x32x16_bf16 v[32:47], a[128:131], a[88:91], 0
    v_exp_f32 v17, v17
    v_exp_f32 v18, v18
    v_exp_f32 v19, v19
    v_cvt_pk_bf16_f32 v48, v16, v17
    v_mfma_f32_32x32x16_bf16 a[16:31], a[136:139], v[56:59], a[16:31]
    buffer_load_dwordx4 a[116:119], v1, s[8:11], s26 offen offset:1024 sc1
    v_exp_f32 v20, v20
    v_exp_f32 v21, v21
    v_cvt_pk_bf16_f32 v49, v18, v19
    v_exp_f32 v22, v22
    v_mfma_f32_32x32x16_bf16 v[32:47], a[132:135], a[92:95], v[32:47]
    v_exp_f32 v23, v23
    v_cvt_pk_bf16_f32 v50, v20, v21
    v_exp_f32 v24, v24
    v_exp_f32 v25, v25
    v_mfma_f32_16x16x32_bf16 v[68:71], v[80:83], v[56:59], v[68:71]
    v_cvt_pk_bf16_f32 v51, v22, v23
    v_exp_f32 v26, v26
    v_mfma_f32_32x32x16_bf16 a[16:31], a[140:143], v[60:63], a[16:31]
    v_exp_f32 v27, v27
    v_cvt_pk_bf16_f32 v52, v24, v25
    v_exp_f32 v28, v28
    v_exp_f32 v29, v29
    v_cvt_pk_bf16_f32 v53, v26, v27
    v_exp_f32 v30, v30
    v_exp_f32 v31, v31
    v_cvt_pk_bf16_f32 v54, v28, v29
    v_mfma_f32_16x16x32_bf16 v[68:71], v[80:83], v[60:63], v[68:71]
    v_cvt_pk_bf16_f32 v55, v30, v31
    s_waitcnt vmcnt(9)
    v_exp_f32 v32, v32
    v_mfma_f32_32x32x16_bf16 v[16:31], a[144:147], a[64:67], 0
    v_exp_f32 v33, v33
    v_exp_f32 v34, v34
    v_exp_f32 v35, v35
    v_cvt_pk_bf16_f32 v56, v32, v33
    v_mfma_f32_32x32x16_bf16 a[32:47], a[136:139], v[48:51], a[32:47]
    buffer_load_dwordx4 a[120:123], v1, s[8:11], s27 offen offset:0 sc1
    v_exp_f32 v36, v36
    v_exp_f32 v37, v37
    v_cvt_pk_bf16_f32 v57, v34, v35
    v_exp_f32 v38, v38
    v_mfma_f32_32x32x16_bf16 v[16:31], a[148:151], a[68:71], v[16:31]
    v_exp_f32 v39, v39
    v_cvt_pk_bf16_f32 v58, v36, v37
    v_exp_f32 v40, v40
    v_exp_f32 v41, v41
    v_mfma_f32_16x16x32_bf16 v[72:75], v[80:83], v[48:51], v[72:75]
    v_cvt_pk_bf16_f32 v59, v38, v39
    v_exp_f32 v42, v42
    v_mfma_f32_32x32x16_bf16 a[32:47], a[140:143], v[52:55], a[32:47]
    v_exp_f32 v43, v43
    v_cvt_pk_bf16_f32 v60, v40, v41
    v_exp_f32 v44, v44
    v_exp_f32 v45, v45
    v_cvt_pk_bf16_f32 v61, v42, v43
    v_exp_f32 v46, v46
    v_exp_f32 v47, v47
    v_cvt_pk_bf16_f32 v62, v44, v45
    v_mfma_f32_16x16x32_bf16 v[72:75], v[80:83], v[52:55], v[72:75]
    v_cvt_pk_bf16_f32 v63, v46, v47
    v_exp_f32 v16, v16
    v_mfma_f32_32x32x16_bf16 v[32:47], a[144:147], a[72:75], 0
    v_exp_f32 v17, v17
    v_exp_f32 v18, v18
    v_exp_f32 v19, v19
    v_cvt_pk_bf16_f32 v48, v16, v17
    v_mfma_f32_32x32x16_bf16 a[48:63], a[136:139], v[56:59], a[48:63]
    buffer_load_dwordx4 a[124:127], v1, s[8:11], s27 offen offset:1024 sc1
    v_exp_f32 v20, v20
    v_exp_f32 v21, v21
    v_cvt_pk_bf16_f32 v49, v18, v19
    v_exp_f32 v22, v22
    v_mfma_f32_32x32x16_bf16 v[32:47], a[148:151], a[76:79], v[32:47]
    v_exp_f32 v23, v23
    v_cvt_pk_bf16_f32 v50, v20, v21
    v_exp_f32 v24, v24
    v_exp_f32 v25, v25
    v_mfma_f32_16x16x32_bf16 v[76:79], v[80:83], v[56:59], v[76:79]
    v_cvt_pk_bf16_f32 v51, v22, v23
    v_exp_f32 v26, v26
    v_mfma_f32_32x32x16_bf16 a[48:63], a[140:143], v[60:63], a[48:63]
    v_exp_f32 v27, v27
    v_cvt_pk_bf16_f32 v52, v24, v25
    v_exp_f32 v28, v28
    v_exp_f32 v29, v29
    v_cvt_pk_bf16_f32 v53, v26, v27
    v_exp_f32 v30, v30
    v_exp_f32 v31, v31
    v_cvt_pk_bf16_f32 v54, v28, v29
    v_mfma_f32_16x16x32_bf16 v[76:79], v[80:83], v[60:63], v[76:79]
    v_cvt_pk_bf16_f32 v55, v30, v31
    s_waitcnt vmcnt(9)
    v_exp_f32 v32, v32
    v_mfma_f32_32x32x16_bf16 v[16:31], a[144:147], a[80:83], 0
    v_exp_f32 v33, v33
    v_exp_f32 v34, v34
    v_exp_f32 v35, v35
    v_cvt_pk_bf16_f32 v56, v32, v33
    v_mfma_f32_32x32x16_bf16 a[0:15], a[152:155], v[48:51], a[0:15]
    buffer_load_dwordx4 a[128:131], v1, s[8:11], s26 offen offset:2048 sc1
    v_exp_f32 v36, v36
    v_exp_f32 v37, v37
    v_cvt_pk_bf16_f32 v57, v34, v35
    v_exp_f32 v38, v38
    v_mfma_f32_32x32x16_bf16 v[16:31], a[148:151], a[84:87], v[16:31]
    v_exp_f32 v39, v39
    v_cvt_pk_bf16_f32 v58, v36, v37
    v_exp_f32 v40, v40
    v_exp_f32 v41, v41
    v_mfma_f32_16x16x32_bf16 v[64:67], v[80:83], v[48:51], v[64:67]
    v_cvt_pk_bf16_f32 v59, v38, v39
    v_exp_f32 v42, v42
    v_mfma_f32_32x32x16_bf16 a[0:15], a[156:159], v[52:55], a[0:15]
    v_exp_f32 v43, v43
    v_cvt_pk_bf16_f32 v60, v40, v41
    v_exp_f32 v44, v44
    v_exp_f32 v45, v45
    v_cvt_pk_bf16_f32 v61, v42, v43
    v_exp_f32 v46, v46
    v_exp_f32 v47, v47
    v_cvt_pk_bf16_f32 v62, v44, v45
    v_mfma_f32_16x16x32_bf16 v[64:67], v[80:83], v[52:55], v[64:67]
    v_cvt_pk_bf16_f32 v63, v46, v47
    v_exp_f32 v16, v16
    v_mfma_f32_32x32x16_bf16 v[32:47], a[144:147], a[88:91], 0
    v_exp_f32 v17, v17
    v_exp_f32 v18, v18
    v_exp_f32 v19, v19
    v_cvt_pk_bf16_f32 v48, v16, v17
    v_mfma_f32_32x32x16_bf16 a[16:31], a[152:155], v[56:59], a[16:31]
    buffer_load_dwordx4 a[132:135], v1, s[8:11], s26 offen offset:3072 sc1
    s_add_u32 s26, s26, 4096
    v_exp_f32 v20, v20
    v_exp_f32 v21, v21
    v_cvt_pk_bf16_f32 v49, v18, v19
    v_exp_f32 v22, v22
    v_mfma_f32_32x32x16_bf16 v[32:47], a[148:151], a[92:95], v[32:47]
    v_exp_f32 v23, v23
    v_cvt_pk_bf16_f32 v50, v20, v21
    v_exp_f32 v24, v24
    v_exp_f32 v25, v25
    v_mfma_f32_16x16x32_bf16 v[68:71], v[80:83], v[56:59], v[68:71]
    v_cvt_pk_bf16_f32 v51, v22, v23
    v_exp_f32 v26, v26
    v_mfma_f32_32x32x16_bf16 a[16:31], a[156:159], v[60:63], a[16:31]
    v_exp_f32 v27, v27
    v_cvt_pk_bf16_f32 v52, v24, v25
    v_exp_f32 v28, v28
    v_exp_f32 v29, v29
    v_cvt_pk_bf16_f32 v53, v26, v27
    v_exp_f32 v30, v30
    v_exp_f32 v31, v31
    v_cvt_pk_bf16_f32 v54, v28, v29
    v_mfma_f32_16x16x32_bf16 v[68:71], v[80:83], v[60:63], v[68:71]
    v_cvt_pk_bf16_f32 v55, v30, v31
    s_waitcnt vmcnt(8)
    v_exp_f32 v32, v32
    v_mfma_f32_32x32x16_bf16 v[16:31], a[96:99], a[64:67], 0
    v_exp_f32 v33, v33
    v_exp_f32 v34, v34
    v_exp_f32 v35, v35
    v_cvt_pk_bf16_f32 v56, v32, v33
    v_mfma_f32_32x32x16_bf16 a[32:47], a[152:155], v[48:51], a[32:47]
    buffer_load_dwordx4 a[136:139], v1, s[8:11], s27 offen offset:2048 sc1
    v_exp_f32 v36, v36
    v_exp_f32 v37, v37
    v_cvt_pk_bf16_f32 v57, v34, v35
    v_exp_f32 v38, v38
    v_mfma_f32_32x32x16_bf16 v[16:31], a[100:103], a[68:71], v[16:31]
    v_exp_f32 v39, v39
    v_cvt_pk_bf16_f32 v58, v36, v37
    v_exp_f32 v40, v40
    v_exp_f32 v41, v41
    v_mfma_f32_16x16x32_bf16 v[72:75], v[80:83], v[48:51], v[72:75]
    v_cvt_pk_bf16_f32 v59, v38, v39
    v_exp_f32 v42, v42
    v_mfma_f32_32x32x16_bf16 a[32:47], a[156:159], v[52:55], a[32:47]
    v_exp_f32 v43, v43
    s_barrier
    s_cmp_lg_u32 s3, 0
    s_cbranch_scc1 L_sig3
    v_mov_b32 v14, s61
    v_mov_b32 v15, 0
    s_mov_b64 exec, 1
    buffer_store_dword v14, v15, s[8:11], s58 offen sc1
    s_mov_b64 exec, -1
L_sig3:
    v_cvt_pk_bf16_f32 v60, v40, v41
    v_exp_f32 v44, v44
    v_exp_f32 v45, v45
    v_cvt_pk_bf16_f32 v61, v42, v43
    v_exp_f32 v46, v46
    v_exp_f32 v47, v47
    v_cvt_pk_bf16_f32 v62, v44, v45
    v_mfma_f32_16x16x32_bf16 v[72:75], v[80:83], v[52:55], v[72:75]
    v_cvt_pk_bf16_f32 v63, v46, v47
    s_mov_b32 s30, 3
.p2align 4
L_A_loop1:
    v_exp_f32 v16, v16
    v_mfma_f32_32x32x16_bf16 v[32:47], a[96:99], a[72:75], 0
    v_exp_f32 v17, v17
    v_exp_f32 v18, v18
    v_exp_f32 v19, v19
    v_cvt_pk_bf16_f32 v48, v16, v17
    v_mfma_f32_32x32x16_bf16 a[48:63], a[152:155], v[56:59], a[48:63]
    buffer_load_dwordx4 a[140:143], v1, s[8:11], s27 offen offset:3072 sc1
    s_add_u32 s27, s27, 4096
    v_exp_f32 v20, v20
    v_exp_f32 v21, v21
    v_cvt_pk_bf16_f32 v49, v18, v19
    v_exp_f32 v22, v22
    v_mfma_f32_32x32x16_bf16 v[32:47], a[100:103], a[76:79], v[32:47]
    v_exp_f32 v23, v23
    v_cvt_pk_bf16_f32 v50, v20, v21
    v_exp_f32 v24, v24
    v_exp_f32 v25, v25
    v_mfma_f32_16x16x32_bf16 v[76:79], v[80:83], v[56:59], v[76:79]
    v_cvt_pk_bf16_f32 v51, v22, v23
    v_exp_f32 v26, v26
    v_mfma_f32_32x32x16_bf16 a[48:63], a[156:159], v[60:63], a[48:63]
    v_exp_f32 v27, v27
    v_cvt_pk_bf16_f32 v52, v24, v25
    v_exp_f32 v28, v28
    v_exp_f32 v29, v29
    v_cvt_pk_bf16_f32 v53, v26, v27
    v_exp_f32 v30, v30
    v_exp_f32 v31, v31
    v_cvt_pk_bf16_f32 v54, v28, v29
    v_mfma_f32_16x16x32_bf16 v[76:79], v[80:83], v[60:63], v[76:79]
    v_cvt_pk_bf16_f32 v55, v30, v31
    s_waitcnt vmcnt(8)
    v_exp_f32 v32, v32
    v_mfma_f32_32x32x16_bf16 v[16:31], a[96:99], a[80:83], 0
    v_exp_f32 v33, v33
    v_exp_f32 v34, v34
    v_exp_f32 v35, v35
    v_cvt_pk_bf16_f32 v56, v32, v33
    v_mfma_f32_32x32x16_bf16 a[0:15], a[104:107], v[48:51], a[0:15]
    buffer_load_dwordx4 a[144:147], v1, s[8:11], s26 offen offset:0 sc1
    v_exp_f32 v36, v36
    v_exp_f32 v37, v37
    v_cvt_pk_bf16_f32 v57, v34, v35
    v_exp_f32 v38, v38
    v_mfma_f32_32x32x16_bf16 v[16:31], a[100:103], a[84:87], v[16:31]
    v_exp_f32 v39, v39
    v_cvt_pk_bf16_f32 v58, v36, v37
    v_exp_f32 v40, v40
    v_exp_f32 v41, v41
    v_mfma_f32_16x16x32_bf16 v[64:67], v[80:83], v[48:51], v[64:67]
    v_cvt_pk_bf16_f32 v59, v38, v39
    v_exp_f32 v42, v42
    v_mfma_f32_32x32x16_bf16 a[0:15], a[108:111], v[52:55], a[0:15]
    v_exp_f32 v43, v43
    v_cvt_pk_bf16_f32 v60, v40, v41
    v_exp_f32 v44, v44
    v_exp_f32 v45, v45
    v_cvt_pk_bf16_f32 v61, v42, v43
    v_exp_f32 v46, v46
    v_exp_f32 v47, v47
    v_cvt_pk_bf16_f32 v62, v44, v45
    v_mfma_f32_16x16x32_bf16 v[64:67], v[80:83], v[52:55], v[64:67]
    v_cvt_pk_bf16_f32 v63, v46, v47
    v_exp_f32 v16, v16
    v_mfma_f32_32x32x16_bf16 v[32:47], a[96:99], a[88:91], 0
    v_exp_f32 v17, v17
    v_exp_f32 v18, v18
    v_exp_f32 v19, v19
    v_cvt_pk_bf16_f32 v48, v16, v17
    v_mfma_f32_32x32x16_bf16 a[16:31], a[104:107], v[56:59], a[16:31]
    buffer_load_dwordx4 a[148:151], v1, s[8:11], s26 offen offset:1024 sc1
    v_exp_f32 v20, v20
    v_exp_f32 v21, v21
    v_cvt_pk_bf16_f32 v49, v18, v19
    v_exp_f32 v22, v22
    v_mfma_f32_32x32x16_bf16 v[32:47], a[100:103], a[92:95], v[32:47]
    v_exp_f32 v23, v23
    v_cvt_pk_bf16_f32 v50, v20, v21
    v_exp_f32 v24, v24
    v_exp_f32 v25, v25
    v_mfma_f32_16x16x32_bf16 v[68:71], v[80:83], v[56:59], v[68:71]
    v_cvt_pk_bf16_f32 v51, v22, v23
    v_exp_f32 v26, v26
    v_mfma_f32_32x32x16_bf16 a[16:31], a[108:111], v[60:63], a[16:31]
    v_exp_f32 v27, v27
    v_cvt_pk_bf16_f32 v52, v24, v25
    v_exp_f32 v28, v28
    v_exp_f32 v29, v29
    v_cvt_pk_bf16_f32 v53, v26, v27
    v_exp_f32 v30, v30
    v_exp_f32 v31, v31
    v_cvt_pk_bf16_f32 v54, v28, v29
    v_mfma_f32_16x16x32_bf16 v[68:71], v[80:83], v[60:63], v[68:71]
    v_cvt_pk_bf16_f32 v55, v30, v31
    s_waitcnt vmcnt(8)
    v_exp_f32 v32, v32
    v_mfma_f32_32x32x16_bf16 v[16:31], a[112:115], a[64:67], 0
    v_exp_f32 v33, v33
    v_exp_f32 v34, v34
    v_exp_f32 v35, v35
    v_cvt_pk_bf16_f32 v56, v32, v33
    v_mfma_f32_32x32x16_bf16 a[32:47], a[104:107], v[48:51], a[32:47]
    buffer_load_dwordx4 a[152:155], v1, s[8:11], s27 offen offset:0 sc1
    v_exp_f32 v36, v36
    v_exp_f32 v37, v37
    v_cvt_pk_bf16_f32 v57, v34, v35
    v_exp_f32 v38, v38
    v_mfma_f32_32x32x16_bf16 v[16:31], a[116:119], a[68:71], v[16:31]
    v_exp_f32 v39, v39
    v_cvt_pk_bf16_f32 v58, v36, v37
    v_exp_f32 v40, v40
    v_exp_f32 v41, v41
    v_mfma_f32_16x16x32_bf16 v[72:75], v[80:83], v[48:51], v[72:75]
    v_cvt_pk_bf16_f32 v59, v38, v39
    v_exp_f32 v42, v42
    v_mfma_f32_32x32x16_bf16 a[32:47], a[108:111], v[52:55], a[32:47]
    v_exp_f32 v43, v43
    v_cvt_pk_bf16_f32 v60, v40, v41
    v_exp_f32 v44, v44
    v_exp_f32 v45, v45
    v_cvt_pk_bf16_f32 v61, v42, v43
    v_exp_f32 v46, v46
    v_exp_f32 v47, v47
    v_cvt_pk_bf16_f32 v62, v44, v45
    v_mfma_f32_16x16x32_bf16 v[72:75], v[80:83], v[52:55], v[72:75]
    v_cvt_pk_bf16_f32 v63, v46, v47
    v_exp_f32 v16, v16
    v_mfma_f32_32x32x16_bf16 v[32:47], a[112:115], a[72:75], 0
    v_exp_f32 v17, v17
    v_exp_f32 v18, v18
    v_exp_f32 v19, v19
    v_cvt_pk_bf16_f32 v48, v16, v17
    v_mfma_f32_32x32x16_bf16 a[48:63], a[104:107], v[56:59], a[48:63]
    buffer_load_dwordx4 a[156:159], v1, s[8:11], s27 offen offset:1024 sc1
    v_exp_f32 v20, v20
    v_exp_f32 v21, v21
    v_cvt_pk_bf16_f32 v49, v18, v19
    v_exp_f32 v22, v22
    v_mfma_f32_32x32x16_bf16 v[32:47], a[116:119], a[76:79], v[32:47]
    v_exp_f32 v23, v23
    v_cvt_pk_bf16_f32 v50, v20, v21
    v_exp_f32 v24, v24
    v_exp_f32 v25, v25
    v_mfma_f32_16x16x32_bf16 v[76:79], v[80:83], v[56:59], v[76:79]
    v_cvt_pk_bf16_f32 v51, v22, v23
    v_exp_f32 v26, v26
    v_mfma_f32_32x32x16_bf16 a[48:63], a[108:111], v[60:63], a[48:63]
    v_exp_f32 v27, v27
    v_cvt_pk_bf16_f32 v52, v24, v25
    v_exp_f32 v28, v28
    v_exp_f32 v29, v29
    v_cvt_pk_bf16_f32 v53, v26, v27
    v_exp_f32 v30, v30
    v_exp_f32 v31, v31
    v_cvt_pk_bf16_f32 v54, v28, v29
    v_mfma_f32_16x16x32_bf16 v[76:79], v[80:83], v[60:63], v[76:79]
    v_cvt_pk_bf16_f32 v55, v30, v31
    s_waitcnt vmcnt(8)
    v_exp_f32 v32, v32
    v_mfma_f32_32x32x16_bf16 v[16:31], a[112:115], a[80:83], 0
    v_exp_f32 v33, v33
    v_exp_f32 v34, v34
    v_exp_f32 v35, v35
    v_cvt_pk_bf16_f32 v56, v32, v33
    v_mfma_f32_32x32x16_bf16 a[0:15], a[120:123], v[48:51], a[0:15]
    buffer_load_dwordx4 a[96:99], v1, s[8:11], s26 offen offset:2048 sc1
    v_exp_f32 v36, v36
    v_exp_f32 v37, v37
    v_cvt_pk_bf16_f32 v57, v34, v35
    v_exp_f32 v38, v38
    v_mfma_f32_32x32x16_bf16 v[16:31], a[116:119], a[84:87], v[16:31]
    v_exp_f32 v39, v39
    v_cvt_pk_bf16_f32 v58, v36, v37
    v_exp_f32 v40, v40
    v_exp_f32 v41, v41
    v_mfma_f32_16x16x32_bf16 v[64:67], v[80:83], v[48:51], v[64:67]
    v_cvt_pk_bf16_f32 v59, v38, v39
    v_exp_f32 v42, v42
    v_mfma_f32_32x32x16_bf16 a[0:15], a[124:127], v[52:55], a[0:15]
    v_exp_f32 v43, v43
    v_cvt_pk_bf16_f32 v60, v40, v41
    v_exp_f32 v44, v44
    v_exp_f32 v45, v45
    v_cvt_pk_bf16_f32 v61, v42, v43
    v_exp_f32 v46, v46
    v_exp_f32 v47, v47
    v_cvt_pk_bf16_f32 v62, v44, v45
    v_mfma_f32_16x16x32_bf16 v[64:67], v[80:83], v[52:55], v[64:67]
    v_cvt_pk_bf16_f32 v63, v46, v47
    v_exp_f32 v16, v16
    v_mfma_f32_32x32x16_bf16 v[32:47], a[112:115], a[88:91], 0
    v_exp_f32 v17, v17
    v_exp_f32 v18, v18
    v_exp_f32 v19, v19
    v_cvt_pk_bf16_f32 v48, v16, v17
    v_mfma_f32_32x32x16_bf16 a[16:31], a[120:123], v[56:59], a[16:31]
    buffer_load_dwordx4 a[100:103], v1, s[8:11], s26 offen offset:3072 sc1
    s_add_u32 s26, s26, 4096
    v_exp_f32 v20, v20
    v_exp_f32 v21, v21
    v_cvt_pk_bf16_f32 v49, v18, v19
    v_exp_f32 v22, v22
    v_mfma_f32_32x32x16_bf16 v[32:47], a[116:119], a[92:95], v[32:47]
    v_exp_f32 v23, v23
    v_cvt_pk_bf16_f32 v50, v20, v21
    v_exp_f32 v24, v24
    v_exp_f32 v25, v25
    v_mfma_f32_16x16x32_bf16 v[68:71], v[80:83], v[56:59], v[68:71]
    v_cvt_pk_bf16_f32 v51, v22, v23
    v_exp_f32 v26, v26
    v_mfma_f32_32x32x16_bf16 a[16:31], a[124:127], v[60:63], a[16:31]
    v_exp_f32 v27, v27
    v_cvt_pk_bf16_f32 v52, v24, v25
    v_exp_f32 v28, v28
    v_exp_f32 v29, v29
    v_cvt_pk_bf16_f32 v53, v26, v27
    v_exp_f32 v30, v30
    v_exp_f32 v31, v31
    v_cvt_pk_bf16_f32 v54, v28, v29
    v_mfma_f32_16x16x32_bf16 v[68:71], v[80:83], v[60:63], v[68:71]
    v_cvt_pk_bf16_f32 v55, v30, v31
    s_waitcnt vmcnt(8)
    v_exp_f32 v32, v32
    v_mfma_f32_32x32x16_bf16 v[16:31], a[128:131], a[64:67], 0
    v_exp_f32 v33, v33
    v_exp_f32 v34, v34
    v_exp_f32 v35, v35
    v_cvt_pk_bf16_f32 v56, v32, v33
    v_mfma_f32_32x32x16_bf16 a[32:47], a[120:123], v[48:51], a[32:47]
    buffer_load_dwordx4 a[104:107], v1, s[8:11], s27 offen offset:2048 sc1
    v_exp_f32 v36, v36
    v_exp_f32 v37, v37
    v_cvt_pk_bf16_f32 v57, v34, v35
    v_exp_f32 v38, v38
    v_mfma_f32_32x32x16_bf16 v[16:31], a[132:135], a[68:71], v[16:31]
    v_exp_f32 v39, v39
    v_cvt_pk_bf16_f32 v58, v36, v37
    v_exp_f32 v40, v40
    v_exp_f32 v41, v41
    v_mfma_f32_16x16x32_bf16 v[72:75], v[80:83], v[48:51], v[72:75]
    v_cvt_pk_bf16_f32 v59, v38, v39
    v_exp_f32 v42, v42
    v_mfma_f32_32x32x16_bf16 a[32:47], a[124:127], v[52:55], a[32:47]
    v_exp_f32 v43, v43
    v_cvt_pk_bf16_f32 v60, v40, v41
    v_exp_f32 v44, v44
    v_exp_f32 v45, v45
    v_cvt_pk_bf16_f32 v61, v42, v43
    v_exp_f32 v46, v46
    v_exp_f32 v47, v47
    v_cvt_pk_bf16_f32 v62, v44, v45
    v_mfma_f32_16x16x32_bf16 v[72:75], v[80:83], v[52:55], v[72:75]
    v_cvt_pk_bf16_f32 v63, v46, v47
    v_exp_f32 v16, v16
    v_mfma_f32_32x32x16_bf16 v[32:47], a[128:131], a[72:75], 0
    v_exp_f32 v17, v17
    v_exp_f32 v18, v18
    v_exp_f32 v19, v19
    v_cvt_pk_bf16_f32 v48, v16, v17
    v_mfma_f32_32x32x16_bf16 a[48:63], a[120:123], v[56:59], a[48:63]
    buffer_load_dwordx4 a[108:111], v1, s[8:11], s27 offen offset:3072 sc1
    s_add_u32 s27, s27, 4096
    v_exp_f32 v20, v20
    v_exp_f32 v21, v21
    v_cvt_pk_bf16_f32 v49, v18, v19
    v_exp_f32 v22, v22
    v_mfma_f32_32x32x16_bf16 v[32:47], a[132:135], a[76:79], v[32:47]
    v_exp_f32 v23, v23
    v_cvt_pk_bf16_f32 v50, v20, v21
    v_exp_f32 v24, v24
    v_exp_f32 v25, v25
    v_mfma_f32_16x16x32_bf16 v[76:79], v[80:83], v[56:59], v[76:79]
    v_cvt_pk_bf16_f32 v51, v22, v23
    v_exp_f32 v26, v26
    v_mfma_f32_32x32x16_bf16 a[48:63], a[124:127], v[60:63], a[48:63]
    v_exp_f32 v27, v27
    v_cvt_pk_bf16_f32 v52, v24, v25
    v_exp_f32 v28, v28
    v_exp_f32 v29, v29
    v_cvt_pk_bf16_f32 v53, v26, v27
    v_exp_f32 v30, v30
    v_exp_f32 v31, v31
    v_cvt_pk_bf16_f32 v54, v28, v29
    v_mfma_f32_16x16x32_bf16 v[76:79], v[80:83], v[60:63], v[76:79]
    v_cvt_pk_bf16_f32 v55, v30, v31
    s_waitcnt vmcnt(8)
    v_exp_f32 v32, v32
    v_mfma_f32_32x32x16_bf16 v[16:31], a[128:131], a[80:83], 0
    v_exp_f32 v33, v33
    v_exp_f32 v34, v34
    v_exp_f32 v35, v35
    v_cvt_pk_bf16_f32 v56, v32, v33
    v_mfma_f32_32x32x16_bf16 a[0:15], a[136:139], v[48:51], a[0:15]
    buffer_load_dwordx4 a[112:115], v1, s[8:11], s26 offen offset:0 sc1
    v_exp_f32 v36, v36
    v_exp_f32 v37, v37
    v_cvt_pk_bf16_f32 v57, v34, v35
    v_exp_f32 v38, v38
    v_mfma_f32_32x32x16_bf16 v[16:31], a[132:135], a[84:87], v[16:31]
L_pad_8:
    s_cbranch_execz L_pad_11
    v_exp_f32 v39, v39
    v_cvt_pk_bf16_f32 v58, v36, v37
    v_exp_f32 v40, v40
    v_exp_f32 v41, v41
    v_mfma_f32_16x16x32_bf16 v[64:67], v[80:83], v[48:51], v[64:67]
    v_cvt_pk_bf16_f32 v59, v38, v39
    v_exp_f32 v42, v42
    v_mfma_f32_32x32x16_bf16 a[0:15], a[140:143], v[52:55], a[0:15]
    v_exp_f32 v43, v43
    v_cvt_pk_bf16_f32 v60, v40, v41
    v_exp_f32 v44, v44
    v_exp_f32 v45, v45
    v_cvt_pk_bf16_f32 v61, v42, v43
    v_exp_f32 v46, v46
    v_exp_f32 v47, v47
    v_cvt_pk_bf16_f32 v62, v44, v45
    v_mfma_f32_16x16x32_bf16 v[64:67], v[80:83], v[52:55], v[64:67]
    v_cvt_pk_bf16_f32 v63, v46, v47
    v_exp_f32 v16, v16
    v_mfma_f32_32x32x16_bf16 v[32:47], a[128:131], a[88:91], 0
    v_exp_f32 v17, v17
    v_exp_f32 v18, v18
    v_exp_f32 v19, v19
    v_cvt_pk_bf16_f32 v48, v16, v17
    v_mfma_f32_32x32x16_bf16 a[16:31], a[136:139], v[56:59], a[16:31]
    buffer_load_dwordx4 a[116:119], v1, s[8:11], s26 offen offset:1024 sc1
    v_exp_f32 v20, v20
    v_exp_f32 v21, v21
    v_cvt_pk_bf16_f32 v49, v18, v19
    v_exp_f32 v22, v22
    v_mfma_f32_32x32x16_bf16 v[32:47], a[132:135], a[92:95], v[32:47]
    v_exp_f32 v23, v23
    v_cvt_pk_bf16_f32 v50, v20, v21
    v_exp_f32 v24, v24
    v_exp_f32 v25, v25
    v_mfma_f32_16x16x32_bf16 v[68:71], v[80:83], v[56:59], v[68:71]
    v_cvt_pk_bf16_f32 v51, v22, v23
    v_exp_f32 v26, v26
    v_mfma_f32_32x32x16_bf16 a[16:31], a[140:143], v[60:63], a[16:31]
    v_exp_f32 v27, v27
    v_cvt_pk_bf16_f32 v52, v24, v25
    v_exp_f32 v28, v28
    v_exp_f32 v29, v29
    v_cvt_pk_bf16_f32 v53, v26, v27
    v_exp_f32 v30, v30
    v_exp_f32 v31, v31
    v_cvt_pk_bf16_f32 v54, v28, v29
    v_mfma_f32_16x16x32_bf16 v[68:71], v[80:83], v[60:63], v[68:71]
    v_cvt_pk_bf16_f32 v55, v30, v31
    s_waitcnt vmcnt(8)
    v_exp_f32 v32, v32
    v_mfma_f32_32x32x16_bf16 v[16:31], a[144:147], a[64:67], 0
    v_exp_f32 v33, v33
    v_exp_f32 v34, v34
    v_exp_f32 v35, v35
    v_cvt_pk_bf16_f32 v56, v32, v33
    v_mfma_f32_32x32x16_bf16 a[32:47], a[136:139], v[48:51], a[32:47]
    buffer_load_dwordx4 a[120:123], v1, s[8:11], s27 offen offset:0 sc1
    v_exp_f32 v36, v36
    v_exp_f32 v37, v37
    v_cvt_pk_bf16_f32 v57, v34, v35
    v_exp_f32 v38, v38
    v_mfma_f32_32x32x16_bf16 v[16:31], a[148:151], a[68:71], v[16:31]
    v_exp_f32 v39, v39
    v_cvt_pk_bf16_f32 v58, v36, v37
    v_exp_f32 v40, v40
    v_exp_f32 v41, v41
    v_mfma_f32_16x16x32_bf16 v[72:75], v[80:83], v[48:51], v[72:75]
    v_cvt_pk_bf16_f32 v59, v38, v39
    v_exp_f32 v42, v42
    v_mfma_f32_32x32x16_bf16 a[32:47], a[140:143], v[52:55], a[32:47]
    v_exp_f32 v43, v43
    v_cvt_pk_bf16_f32 v60, v40, v41
    v_exp_f32 v44, v44
    v_exp_f32 v45, v45
    v_cvt_pk_bf16_f32 v61, v42, v43
    v_exp_f32 v46, v46
    v_exp_f32 v47, v47
    v_cvt_pk_bf16_f32 v62, v44, v45
    v_mfma_f32_16x16x32_bf16 v[72:75], v[80:83], v[52:55], v[72:75]
    v_cvt_pk_bf16_f32 v63, v46, v47
    v_exp_f32 v16, v16
    v_mfma_f32_32x32x16_bf16 v[32:47], a[144:147], a[72:75], 0
    v_exp_f32 v17, v17
    v_exp_f32 v18, v18
    v_exp_f32 v19, v19
    v_cvt_pk_bf16_f32 v48, v16, v17
    v_mfma_f32_32x32x16_bf16 a[48:63], a[136:139], v[56:59], a[48:63]
    buffer_load_dwordx4 a[124:127], v1, s[8:11], s27 offen offset:1024 sc1
    v_exp_f32 v20, v20
    v_exp_f32 v21, v21
    v_cvt_pk_bf16_f32 v49, v18, v19
    v_exp_f32 v22, v22
    v_mfma_f32_32x32x16_bf16 v[32:47], a[148:151], a[76:79], v[32:47]
    v_exp_f32 v23, v23
    v_cvt_pk_bf16_f32 v50, v20, v21
    v_exp_f32 v24, v24
    v_exp_f32 v25, v25
    v_mfma_f32_16x16x32_bf16 v[76:79], v[80:83], v[56:59], v[76:79]
    v_cvt_pk_bf16_f32 v51, v22, v23
    v_exp_f32 v26, v26
    v_mfma_f32_32x32x16_bf16 a[48:63], a[140:143], v[60:63], a[48:63]
    v_exp_f32 v27, v27
    v_cvt_pk_bf16_f32 v52, v24, v25
    v_exp_f32 v28, v28
    v_exp_f32 v29, v29
    v_cvt_pk_bf16_f32 v53, v26, v27
    v_exp_f32 v30, v30
    v_exp_f32 v31, v31
    v_cvt_pk_bf16_f32 v54, v28, v29
    v_mfma_f32_16x16x32_bf16 v[76:79], v[80:83], v[60:63], v[76:79]
    v_cvt_pk_bf16_f32 v55, v30, v31
    s_waitcnt vmcnt(8)
    v_exp_f32 v32, v32
    v_mfma_f32_32x32x16_bf16 v[16:31], a[144:147], a[80:83], 0
    v_exp_f32 v33, v33
    v_exp_f32 v34, v34
    v_exp_f32 v35, v35
    v_cvt_pk_bf16_f32 v56, v32, v33
    v_mfma_f32_32x32x16_bf16 a[0:15], a[152:155], v[48:51], a[0:15]
    buffer_load_dwordx4 a[128:131], v1, s[8:11], s26 offen offset:2048 sc1
    v_exp_f32 v36, v36
    v_exp_f32 v37, v37
    v_cvt_pk_bf16_f32 v57, v34, v35
    v_exp_f32 v38, v38
    v_mfma_f32_32x32x16_bf16 v[16:31], a[148:151], a[84:87], v[16:31]
    v_exp_f32 v39, v39
    v_cvt_pk_bf16_f32 v58, v36, v37
    v_exp_f32 v40, v40
    v_exp_f32 v41, v41
    v_mfma_f32_16x16x32_bf16 v[64:67], v[80:83], v[48:51], v[64:67]
    v_cvt_pk_bf16_f32 v59, v38, v39
    v_exp_f32 v42, v42
    v_mfma_f32_32x32x16_bf16 a[0:15], a[156:159], v[52:55], a[0:15]
    v_exp_f32 v43, v43
    v_cvt_pk_bf16_f32 v60, v40, v41
    v_exp_f32 v44, v44
    v_exp_f32 v45, v45
    v_cvt_pk_bf16_f32 v61, v42, v43
    v_exp_f32 v46, v46
    v_exp_f32 v47, v47
    v_cvt_pk_bf16_f32 v62, v44, v45
    v_mfma_f32_16x16x32_bf16 v[64:67], v[80:83], v[52:55], v[64:67]
    v_cvt_pk_bf16_f32 v63, v46, v47
    v_exp_f32 v16, v16
    v_mfma_f32_32x32x16_bf16 v[32:47], a[144:147], a[88:91], 0
    v_exp_f32 v17, v17
    v_exp_f32 v18, v18
    v_exp_f32 v19, v19
    v_cvt_pk_bf16_f32 v48, v16, v17
    v_mfma_f32_32x32x16_bf16 a[16:31], a[152:155], v[56:59], a[16:31]
    buffer_load_dwordx4 a[132:135], v1, s[8:11], s26 offen offset:3072 sc1
    s_add_u32 s26, s26, 4096
    v_exp_f32 v20, v20
    v_exp_f32 v21, v21
    v_cvt_pk_bf16_f32 v49, v18, v19
    v_exp_f32 v22, v22
    v_mfma_f32_32x32x16_bf16 v[32:47], a[148:151], a[92:95], v[32:47]
    v_exp_f32 v23, v23
    v_cvt_pk_bf16_f32 v50, v20, v21
    v_exp_f32 v24, v24
    v_exp_f32 v25, v25
    v_mfma_f32_16x16x32_bf16 v[68:71], v[80:83], v[56:59], v[68:71]
    v_cvt_pk_bf16_f32 v51, v22, v23
    v_exp_f32 v26, v26
    v_mfma_f32_32x32x16_bf16 a[16:31], a[156:159], v[60:63], a[16:31]
    v_exp_f32 v27, v27
    v_cvt_pk_bf16_f32 v52, v24, v25
    v_exp_f32 v28, v28
    v_exp_f32 v29, v29
    v_cvt_pk_bf16_f32 v53, v26, v27
    v_exp_f32 v30, v30
    v_exp_f32 v31, v31
    v_cvt_pk_bf16_f32 v54, v28, v29
    v_mfma_f32_16x16x32_bf16 v[68:71], v[80:83], v[60:63], v[68:71]
    v_cvt_pk_bf16_f32 v55, v30, v31
    s_waitcnt vmcnt(8)
    v_exp_f32 v32, v32
    v_mfma_f32_32x32x16_bf16 v[16:31], a[96:99], a[64:67], 0
    v_exp_f32 v33, v33
    v_exp_f32 v34, v34
    v_exp_f32 v35, v35
    v_cvt_pk_bf16_f32 v56, v32, v33
    v_mfma_f32_32x32x16_bf16 a[32:47], a[152:155], v[48:51], a[32:47]
    buffer_load_dwordx4 a[136:139], v1, s[8:11], s27 offen offset:2048 sc1
    v_exp_f32 v36, v36
    v_exp_f32 v37, v37
    v_cvt_pk_bf16_f32 v57, v34, v35
    v_exp_f32 v38, v38
    v_mfma_f32_32x32x16_bf16 v[16:31], a[100:103], a[68:71], v[16:31]
    v_exp_f32 v39, v39
    v_cvt_pk_bf16_f32 v58, v36, v37
    v_exp_f32 v40, v40
    v_exp_f32 v41, v41
    v_mfma_f32_16x16x32_bf16 v[72:75], v[80:83], v[48:51], v[72:75]
    v_cvt_pk_bf16_f32 v59, v38, v39
    v_exp_f32 v42, v42
    v_mfma_f32_32x32x16_bf16 a[32:47], a[156:159], v[52:55], a[32:47]
    v_exp_f32 v43, v43
    v_cvt_pk_bf16_f32 v60, v40, v41
    v_exp_f32 v44, v44
    v_exp_f32 v45, v45
    v_cvt_pk_bf16_f32 v61, v42, v43
    v_exp_f32 v46, v46
    v_exp_f32 v47, v47
    v_cvt_pk_bf16_f32 v62, v44, v45
    v_mfma_f32_16x16x32_bf16 v[72:75], v[80:83], v[52:55], v[72:75]
    v_cvt_pk_bf16_f32 v63, v46, v47
    s_sub_u32 s30, s30, 1
    s_cmp_lg_u32 s30, 0
    s_cbranch_scc1 L_A_loop1
    v_exp_f32 v16, v16
    v_mfma_f32_32x32x16_bf16 v[32:47], a[96:99], a[72:75], 0
    v_exp_f32 v17, v17
    v_exp_f32 v18, v18
    v_exp_f32 v19, v19
    v_cvt_pk_bf16_f32 v48, v16, v17
    v_mfma_f32_32x32x16_bf16 a[48:63], a[152:155], v[56:59], a[48:63]
    buffer_load_dwordx4 a[140:143], v1, s[8:11], s27 offen offset:3072 sc1
    s_add_u32 s27, s27, 4096
    v_exp_f32 v20, v20
    v_exp_f32 v21, v21
    v_cvt_pk_bf16_f32 v49, v18, v19
    v_exp_f32 v22, v22
    v_mfma_f32_32x32x16_bf16 v[32:47], a[100:103], a[76:79], v[32:47]
    v_exp_f32 v23, v23
    v_cvt_pk_bf16_f32 v50, v20, v21
    v_exp_f32 v24, v24
    v_exp_f32 v25, v25
    v_mfma_f32_16x16x32_bf16 v[76:79], v[80:83], v[56:59], v[76:79]
    v_cvt_pk_bf16_f32 v51, v22, v23
    v_exp_f32 v26, v26
    v_mfma_f32_32x32x16_bf16 a[48:63], a[156:159], v[60:63], a[48:63]
    v_exp_f32 v27, v27
    v_add_u32 v224, 0, v1
    v_add_u32 v225, 114688, v1
    v_add_u32 v226, 229376, v1
    v_add_u32 v227, 344064, v1
    v_add_u32 v228, s67, v249
    v_add_u32 v229, s67, v250
    v_min_u32 v243, 7, v0
    v_lshlrev_b32 v243, 2, v243
    buffer_load_dword v242, v243, s[8:11], s62 offen sc1
    v_cvt_pk_bf16_f32 v52, v24, v25
    v_exp_f32 v28, v28
    v_exp_f32 v29, v29
    v_cvt_pk_bf16_f32 v53, v26, v27
    v_exp_f32 v30, v30
    v_exp_f32 v31, v31
    v_cvt_pk_bf16_f32 v54, v28, v29
    v_mfma_f32_16x16x32_bf16 v[76:79], v[80:83], v[60:63], v[76:79]
    v_cvt_pk_bf16_f32 v55, v30, v31
    s_waitcnt vmcnt(9)
    v_exp_f32 v32, v32
    v_mfma_f32_32x32x16_bf16 v[16:31], a[96:99], a[80:83], 0
    v_exp_f32 v33, v33
    v_exp_f32 v34, v34
    v_exp_f32 v35, v35
    v_cvt_pk_bf16_f32 v56, v32, v33
    v_mfma_f32_32x32x16_bf16 a[0:15], a[104:107], v[48:51], a[0:15]
    buffer_load_dwordx4 a[144:147], v1, s[8:11], s26 offen offset:0 sc1
    v_exp_f32 v36, v36
    v_exp_f32 v37, v37
    v_cvt_pk_bf16_f32 v57, v34, v35
    v_exp_f32 v38, v38
    v_mfma_f32_32x32x16_bf16 v[16:31], a[100:103], a[84:87], v[16:31]
    v_exp_f32 v39, v39
    v_cvt_pk_bf16_f32 v58, v36, v37
    v_exp_f32 v40, v40
    v_exp_f32 v41, v41
    v_mfma_f32_16x16x32_bf16 v[64:67], v[80:83], v[48:51], v[64:67]
    v_cvt_pk_bf16_f32 v59, v38, v39
    v_exp_f32 v42, v42
    v_mfma_f32_32x32x16_bf16 a[0:15], a[108:111], v[52:55], a[0:15]
    v_exp_f32 v43, v43
    s_add_u32 m0, s89, 0
    s_nop 0
    buffer_load_dwordx4 v247, s[20:23], s71 offen offset:0 lds
    s_add_u32 m0, s89, 4032
    s_nop 0
    buffer_load_dwordx4 v247, s[20:23], s71 offen offset:64 lds
    s_add_u32 m0, s89, 8192
    s_nop 0
    buffer_load_dwordx4 v248, s[20:23], s71 offen offset:0 lds
    s_add_u32 m0, s89, 12224
    s_nop 0
    buffer_load_dwordx4 v248, s[20:23], s71 offen offset:64 lds
    s_add_u32 s71, s71, 131072
    s_add_u32 s89, s89, 16384
    s_sub_u32 s39, s89, 65536
    s_cmp_ge_u32 s39, 98304
    s_cselect_b32 s39, 98304, 0
    s_sub_u32 s89, s89, s39
    v_cvt_pk_bf16_f32 v60, v40, v41
    v_exp_f32 v44, v44
    v_exp_f32 v45, v45
    v_cvt_pk_bf16_f32 v61, v42, v43
    v_exp_f32 v46, v46
    v_exp_f32 v47, v47
    v_cvt_pk_bf16_f32 v62, v44, v45
    v_mfma_f32_16x16x32_bf16 v[64:67], v[80:83], v[52:55], v[64:67]
    v_cvt_pk_bf16_f32 v63, v46, v47
    v_exp_f32 v16, v16
    v_mfma_f32_32x32x16_bf16 v[32:47], a[96:99], a[88:91], 0
    v_exp_f32 v17, v17
    v_exp_f32 v18, v18
    v_exp_f32 v19, v19
    v_cvt_pk_bf16_f32 v48, v16, v17
    v_mfma_f32_32x32x16_bf16 a[16:31], a[104:107], v[56:59], a[16:31]
    buffer_load_dwordx4 a[148:151], v1, s[8:11], s26 offen offset:1024 sc1
    v_exp_f32 v20, v20
    v_exp_f32 v21, v21
    v_cvt_pk_bf16_f32 v49, v18, v19
    v_exp_f32 v22, v22
    v_mfma_f32_32x32x16_bf16 v[32:47], a[100:103], a[92:95], v[32:47]
    v_exp_f32 v23, v23
    v_cvt_pk_bf16_f32 v50, v20, v21
    v_exp_f32 v24, v24
    v_exp_f32 v25, v25
    v_mfma_f32_16x16x32_bf16 v[68:71], v[80:83], v[56:59], v[68:71]
    v_cvt_pk_bf16_f32 v51, v22, v23
    v_exp_f32 v26, v26
    v_mfma_f32_32x32x16_bf16 a[16:31], a[108:111], v[60:63], a[16:31]
    v_exp_f32 v27, v27
    s_add_u32 m0, s89, 0
    s_nop 0
    buffer_load_dwordx4 v247, s[20:23], s71 offen offset:0 lds
    s_add_u32 m0, s89, 4032
    s_nop 0
    buffer_load_dwordx4 v247, s[20:23], s71 offen offset:64 lds
    s_add_u32 m0, s89, 8192
    s_nop 0
    buffer_load_dwordx4 v248, s[20:23], s71 offen offset:0 lds
    s_add_u32 m0, s89, 12224
    s_nop 0
    buffer_load_dwordx4 v248, s[20:23], s71 offen offset:64 lds
    s_add_u32 s71, s71, 131072
    s_add_u32 s89, s89, 16384
    s_sub_u32 s39, s89, 65536
    s_cmp_ge_u32 s39, 98304
    s_cselect_b32 s39, 98304, 0
    s_sub_u32 s89, s89, s39
    v_cvt_pk_bf16_f32 v52, v24, v25
    v_exp_f32 v28, v28
    v_exp_f32 v29, v29
    v_cvt_pk_bf16_f32 v53, v26, v27
    v_exp_f32 v30, v30
    v_exp_f32 v31, v31
    v_cvt_pk_bf16_f32 v54, v28, v29
    v_mfma_f32_16x16x32_bf16 v[68:71], v[80:83], v[60:63], v[68:71]
    v_cvt_pk_bf16_f32 v55, v30, v31
    s_waitcnt vmcnt(17)
    v_exp_f32 v32, v32
    v_mfma_f32_32x32x16_bf16 v[16:31], a[112:115], a[64:67], 0
    v_exp_f32 v33, v33
    v_exp_f32 v34, v34
    v_exp_f32 v35, v35
    v_cvt_pk_bf16_f32 v56, v32, v33
    v_mfma_f32_32x32x16_bf16 a[32:47], a[104:107], v[48:51], a[32:47]
    buffer_load_dwordx4 a[152:155], v1, s[8:11], s27 offen offset:0 sc1
    v_exp_f32 v36, v36
    v_exp_f32 v37, v37
    v_cvt_pk_bf16_f32 v57, v34, v35
    v_exp_f32 v38, v38
    v_mfma_f32_32x32x16_bf16 v[16:31], a[116:119], a[68:71], v[16:31]
    v_exp_f32 v39, v39
    v_cvt_pk_bf16_f32 v58, v36, v37
    v_exp_f32 v40, v40
    v_exp_f32 v41, v41
    v_mfma_f32_16x16x32_bf16 v[72:75], v[80:83], v[48:51], v[72:75]
    v_cvt_pk_bf16_f32 v59, v38, v39
    v_exp_f32 v42, v42
    v_mfma_f32_32x32x16_bf16 a[32:47], a[108:111], v[52:55], a[32:47]
    v_exp_f32 v43, v43
    s_add_u32 m0, s89, 0
    s_nop 0
    buffer_load_dwordx4 v247, s[20:23], s71 offen offset:0 lds
    s_add_u32 m0, s89, 4032
    s_nop 0
    buffer_load_dwordx4 v247, s[20:23], s71 offen offset:64 lds
    s_add_u32 m0, s89, 8192
    s_nop 0
    buffer_load_dwordx4 v248, s[20:23], s71 offen offset:0 lds
    s_add_u32 m0, s89, 12224
    s_nop 0
    buffer_load_dwordx4 v248, s[20:23], s71 offen offset:64 lds
    s_add_u32 s71, s71, 131072
    s_add_u32 s89, s89, 16384
    s_sub_u32 s39, s89, 65536
    s_cmp_ge_u32 s39, 98304
    s_cselect_b32 s39, 98304, 0
    s_sub_u32 s89, s89, s39
    v_cvt_pk_bf16_f32 v60, v40, v41
    v_exp_f32 v44, v44
    v_exp_f32 v45, v45
    v_cvt_pk_bf16_f32 v61, v42, v43
    v_exp_f32 v46, v46
    v_exp_f32 v47, v47
    v_cvt_pk_bf16_f32 v62, v44, v45
    v_mfma_f32_16x16x32_bf16 v[72:75], v[80:83], v[52:55], v[72:75]
    v_cvt_pk_bf16_f32 v63, v46, v47
    v_exp_f32 v16, v16
    v_mfma_f32_32x32x16_bf16 v[32:47], a[112:115], a[72:75], 0
    v_exp_f32 v17, v17
    v_exp_f32 v18, v18
    v_exp_f32 v19, v19
    v_cvt_pk_bf16_f32 v48, v16, v17
    v_mfma_f32_32x32x16_bf16 a[48:63], a[104:107], v[56:59], a[48:63]
    buffer_load_dwordx4 a[156:159], v1, s[8:11], s27 offen offset:1024 sc1
    v_exp_f32 v20, v20
    v_exp_f32 v21, v21
    v_cvt_pk_bf16_f32 v49, v18, v19
    v_exp_f32 v22, v22
    v_mfma_f32_32x32x16_bf16 v[32:47], a[116:119], a[76:79], v[32:47]
    v_exp_f32 v23, v23
    v_cvt_pk_bf16_f32 v50, v20, v21
    v_exp_f32 v24, v24
    v_exp_f32 v25, v25
    v_mfma_f32_16x16x32_bf16 v[76:79], v[80:83], v[56:59], v[76:79]
    v_cvt_pk_bf16_f32 v51, v22, v23
    v_exp_f32 v26, v26
    v_mfma_f32_32x32x16_bf16 a[48:63], a[108:111], v[60:63], a[48:63]
    v_exp_f32 v27, v27
    s_add_u32 m0, s89, 0
    s_nop 0
    buffer_load_dwordx4 v247, s[20:23], s71 offen offset:0 lds
    s_add_u32 m0, s89, 4032
    s_nop 0
    buffer_load_dwordx4 v247, s[20:23], s71 offen offset:64 lds
    s_add_u32 m0, s89, 8192
    s_nop 0
    buffer_load_dwordx4 v248, s[20:23], s71 offen offset:0 lds
    s_add_u32 m0, s89, 12224
    s_nop 0
    buffer_load_dwordx4 v248, s[20:23], s71 offen offset:64 lds
    s_add_u32 s71, s71, 131072
    s_add_u32 s89, s89, 16384
    s_sub_u32 s39, s89, 65536
    s_cmp_ge_u32 s39, 98304
    s_cselect_b32 s39, 98304, 0
    s_sub_u32 s89, s89, s39
    v_cvt_pk_bf16_f32 v52, v24, v25
    v_exp_f32 v28, v28
    v_exp_f32 v29, v29
    v_cvt_pk_bf16_f32 v53, v26, v27
    v_exp_f32 v30, v30
    v_exp_f32 v31, v31
    v_cvt_pk_bf16_f32 v54, v28, v29
    v_mfma_f32_16x16x32_bf16 v[76:79], v[80:83], v[60:63], v[76:79]
    v_cvt_pk_bf16_f32 v55, v30, v31
    s_waitcnt vmcnt(25)
    v_exp_f32 v32, v32
    v_mfma_f32_32x32x16_bf16 v[16:31], a[112:115], a[80:83], 0
    v_exp_f32 v33, v33
    v_exp_f32 v34, v34
    v_exp_f32 v35, v35
    v_cvt_pk_bf16_f32 v56, v32, v33
    v_mfma_f32_32x32x16_bf16 a[0:15], a[120:123], v[48:51], a[0:15]
    v_exp_f32 v36, v36
    v_exp_f32 v37, v37
    v_cvt_pk_bf16_f32 v57, v34, v35
    v_exp_f32 v38, v38
    v_mfma_f32_32x32x16_bf16 v[16:31], a[116:119], a[84:87], v[16:31]
    v_exp_f32 v39, v39
    v_cvt_pk_bf16_f32 v58, v36, v37
    v_exp_f32 v40, v40
    v_exp_f32 v41, v41
    v_mfma_f32_16x16x32_bf16 v[64:67], v[80:83], v[48:51], v[64:67]
    v_cvt_pk_bf16_f32 v59, v38, v39
    v_exp_f32 v42, v42
    v_mfma_f32_32x32x16_bf16 a[0:15], a[124:127], v[52:55], a[0:15]
    v_exp_f32 v43, v43
    v_cvt_pk_bf16_f32 v60, v40, v41
    v_exp_f32 v44, v44
    v_exp_f32 v45, v45
    v_cvt_pk_bf16_f32 v61, v42, v43
    v_exp_f32 v46, v46
    v_exp_f32 v47, v47
    v_cvt_pk_bf16_f32 v62, v44, v45
    v_mfma_f32_16x16x32_bf16 v[64:67], v[80:83], v[52:55], v[64:67]
    v_cvt_pk_bf16_f32 v63, v46, v47
    v_exp_f32 v16, v16
    v_mfma_f32_32x32x16_bf16 v[32:47], a[112:115], a[88:91], 0
    v_exp_f32 v17, v17
    v_exp_f32 v18, v18
    v_exp_f32 v19, v19
    v_cvt_pk_bf16_f32 v48, v16, v17
    v_mfma_f32_32x32x16_bf16 a[16:31], a[120:123], v[56:59], a[16:31]
    v_exp_f32 v20, v20
    v_exp_f32 v21, v21
    v_cvt_pk_bf16_f32 v49, v18, v19
    v_exp_f32 v22, v22
    v_mfma_f32_32x32x16_bf16 v[32:47], a[116:119], a[92:95], v[32:47]
    v_exp_f32 v23, v23
    v_cvt_pk_bf16_f32 v50, v20, v21
    v_exp_f32 v24, v24
    v_exp_f32 v25, v25
    v_mfma_f32_16x16x32_bf16 v[68:71], v[80:83], v[56:59], v[68:71]
    v_cvt_pk_bf16_f32 v51, v22, v23
    v_exp_f32 v26, v26
    v_mfma_f32_32x32x16_bf16 a[16:31], a[124:127], v[60:63], a[16:31]
    v_exp_f32 v27, v27
    s_waitcnt vmcnt(20)
    v_cmp_ne_u32 vcc, s61, v242
    s_nop 0
    s_cbranch_vccz L_apoll4_ok
    s_mov_b32 s34, 0x40000
L_apoll4:
    s_sleep 1
    buffer_load_dword v242, v243, s[8:11], s62 offen sc1
    s_waitcnt vmcnt(0)
    v_cmp_ne_u32 vcc, s61, v242
    s_sub_u32 s34, s34, 1
    s_cbranch_scc1 L_apoll4_ok
    s_nop 0
    s_cbranch_vccnz L_apoll4
L_apoll4_ok:
    v_cvt_pk_bf16_f32 v52, v24, v25
    v_exp_f32 v28, v28
    v_exp_f32 v29, v29
    v_cvt_pk_bf16_f32 v53, v26, v27
    v_exp_f32 v30, v30
    v_exp_f32 v31, v31
    v_cvt_pk_bf16_f32 v54, v28, v29
    v_mfma_f32_16x16x32_bf16 v[68:71], v[80:83], v[60:63], v[68:71]
    v_cvt_pk_bf16_f32 v55, v30, v31
    s_waitcnt vmcnt(23)
    v_exp_f32 v32, v32
    v_mfma_f32_32x32x16_bf16 v[16:31], a[128:131], a[64:67], 0
    v_exp_f32 v33, v33
    v_exp_f32 v34, v34
    v_exp_f32 v35, v35
    v_cvt_pk_bf16_f32 v56, v32, v33
    v_mfma_f32_32x32x16_bf16 a[32:47], a[120:123], v[48:51], a[32:47]
    v_exp_f32 v36, v36
    v_exp_f32 v37, v37
    v_cvt_pk_bf16_f32 v57, v34, v35
    v_exp_f32 v38, v38
    v_mfma_f32_32x32x16_bf16 v[16:31], a[132:135], a[68:71], v[16:31]
    v_exp_f32 v39, v39
    v_cvt_pk_bf16_f32 v58, v36, v37
    v_exp_f32 v40, v40
    v_exp_f32 v41, v41
    v_mfma_f32_16x16x32_bf16 v[72:75], v[80:83], v[48:51], v[72:75]
    v_cvt_pk_bf16_f32 v59, v38, v39
    v_exp_f32 v42, v42
    v_mfma_f32_32x32x16_bf16 a[32:47], a[124:127], v[52:55], a[32:47]
    v_exp_f32 v43, v43
    v_cvt_pk_bf16_f32 v60, v40, v41
    v_exp_f32 v44, v44
    v_exp_f32 v45, v45
    v_cvt_pk_bf16_f32 v61, v42, v43
    v_exp_f32 v46, v46
    v_exp_f32 v47, v47
    v_cvt_pk_bf16_f32 v62, v44, v45
    v_mfma_f32_16x16x32_bf16 v[72:75], v[80:83], v[52:55], v[72:75]
    v_cvt_pk_bf16_f32 v63, v46, v47
    v_exp_f32 v16, v16
    v_mfma_f32_32x32x16_bf16 v[32:47], a[128:131], a[72:75], 0
    v_exp_f32 v17, v17
    v_exp_f32 v18, v18
    v_exp_f32 v19, v19
    v_cvt_pk_bf16_f32 v48, v16, v17
    v_mfma_f32_32x32x16_bf16 a[48:63], a[120:123], v[56:59], a[48:63]
    v_exp_f32 v20, v20
    v_exp_f32 v21, v21
    v_cvt_pk_bf16_f32 v49, v18, v19
    v_exp_f32 v22, v22
    v_mfma_f32_32x32x16_bf16 v[32:47], a[132:135], a[76:79], v[32:47]
    v_exp_f32 v23, v23
    v_cvt_pk_bf16_f32 v50, v20, v21
    v_exp_f32 v24, v24
    v_exp_f32 v25, v25
    v_mfma_f32_16x16x32_bf16 v[76:79], v[80:83], v[56:59], v[76:79]
    v_cvt_pk_bf16_f32 v51, v22, v23
    v_exp_f32 v26, v26
    v_mfma_f32_32x32x16_bf16 a[48:63], a[124:127], v[60:63], a[48:63]
    v_exp_f32 v27, v27
    buffer_load_dwordx4 a[192:195], v224, s[8:11], s70 offen sc1
    buffer_load_dwordx4 a[196:199], v225, s[8:11], s70 offen sc1
    buffer_load_dwordx4 a[200:203], v226, s[8:11], s70 offen sc1
    buffer_load_dwordx4 a[204:207], v227, s[8:11], s70 offen sc1
    s_add_u32 s70, s70, 1024
    v_cvt_pk_bf16_f32 v52, v24, v25
    v_exp_f32 v28, v28
    v_exp_f32 v29, v29
    v_cvt_pk_bf16_f32 v53, v26, v27
    v_exp_f32 v30, v30
    v_exp_f32 v31, v31
    v_cvt_pk_bf16_f32 v54, v28, v29
    v_mfma_f32_16x16x32_bf16 v[76:79], v[80:83], v[60:63], v[76:79]
    v_cvt_pk_bf16_f32 v55, v30, v31
    s_waitcnt vmcnt(25)
    v_exp_f32 v32, v32
    v_mfma_f32_32x32x16_bf16 v[16:31], a[128:131], a[80:83], 0
    v_exp_f32 v33, v33
    v_exp_f32 v34, v34
    v_exp_f32 v35, v35
    v_cvt_pk_bf16_f32 v56, v32, v33
    v_mfma_f32_32x32x16_bf16 a[0:15], a[136:139], v[48:51], a[0:15]
    v_exp_f32 v36, v36
    v_exp_f32 v37, v37
    v_cvt_pk_bf16_f32 v57, v34, v35
    v_exp_f32 v38, v38
    v_mfma_f32_32x32x16_bf16 v[16:31], a[132:135], a[84:87], v[16:31]
    v_exp_f32 v39, v39
    v_cvt_pk_bf16_f32 v58, v36, v37
    v_exp_f32 v40, v40
    v_exp_f32 v41, v41
    v_mfma_f32_16x16x32_bf16 v[64:67], v[80:83], v[48:51], v[64:67]
    v_cvt_pk_bf16_f32 v59, v38, v39
    v_exp_f32 v42, v42
    v_mfma_f32_32x32x16_bf16 a[0:15], a[140:143], v[52:55], a[0:15]
    v_exp_f32 v43, v43
    v_cvt_pk_bf16_f32 v60, v40, v41
    v_exp_f32 v44, v44
    v_exp_f32 v45, v45
    v_cvt_pk_bf16_f32 v61, v42, v43
    v_exp_f32 v46, v46
    v_exp_f32 v47, v47
    v_cvt_pk_bf16_f32 v62, v44, v45
    v_mfma_f32_16x16x32_bf16 v[64:67], v[80:83], v[52:55], v[64:67]
    v_cvt_pk_bf16_f32 v63, v46, v47
    v_exp_f32 v16, v16
    v_mfma_f32_32x32x16_bf16 v[32:47], a[128:131], a[88:91], 0
    v_exp_f32 v17, v17
    v_exp_f32 v18, v18
    v_exp_f32 v19, v19
    v_cvt_pk_bf16_f32 v48, v16, v17
    v_mfma_f32_32x32x16_bf16 a[16:31], a[136:139], v[56:59], a[16:31]
    v_exp_f32 v20, v20
    v_exp_f32 v21, v21
    v_cvt_pk_bf16_f32 v49, v18, v19
    v_exp_f32 v22, v22
    v_mfma_f32_32x32x16_bf16 v[32:47], a[132:135], a[92:95], v[32:47]
    v_exp_f32 v23, v23
    v_cvt_pk_bf16_f32 v50, v20, v21
    v_exp_f32 v24, v24
    v_exp_f32 v25, v25
    v_mfma_f32_16x16x32_bf16 v[68:71], v[80:83], v[56:59], v[68:71]
    v_cvt_pk_bf16_f32 v51, v22, v23
    v_exp_f32 v26, v26
    v_mfma_f32_32x32x16_bf16 a[16:31], a[140:143], v[60:63], a[16:31]
    v_exp_f32 v27, v27
    buffer_load_dwordx4 a[208:211], v224, s[8:11], s70 offen sc1
    buffer_load_dwordx4 a[212:215], v225, s[8:11], s70 offen sc1
    buffer_load_dwordx4 a[216:219], v226, s[8:11], s70 offen sc1
    buffer_load_dwordx4 a[220:223], v227, s[8:11], s70 offen sc1
    s_add_u32 s70, s70, 1024
    v_cvt_pk_bf16_f32 v52, v24, v25
    v_exp_f32 v28, v28
    v_exp_f32 v29, v29
    v_cvt_pk_bf16_f32 v53, v26, v27
    v_exp_f32 v30, v30
    v_exp_f32 v31, v31
    v_cvt_pk_bf16_f32 v54, v28, v29
    v_mfma_f32_16x16x32_bf16 v[68:71], v[80:83], v[60:63], v[68:71]
    v_cvt_pk_bf16_f32 v55, v30, v31
    s_waitcnt vmcnt(22)
    v_exp_f32 v32, v32
    v_mfma_f32_32x32x16_bf16 v[16:31], a[144:147], a[64:67], 0
    v_exp_f32 v33, v33
    v_exp_f32 v34, v34
    v_exp_f32 v35, v35
    v_cvt_pk_bf16_f32 v56, v32, v33
    v_mfma_f32_32x32x16_bf16 a[32:47], a[136:139], v[48:51], a[32:47]
    v_exp_f32 v36, v36
    v_exp_f32 v37, v37
    v_cvt_pk_bf16_f32 v57, v34, v35
    v_exp_f32 v38, v38
    v_mfma_f32_32x32x16_bf16 v[16:31], a[148:151], a[68:71], v[16:31]
    v_exp_f32 v39, v39
    v_cvt_pk_bf16_f32 v58, v36, v37
    v_exp_f32 v40, v40
    v_exp_f32 v41, v41
    v_mfma_f32_16x16x32_bf16 v[72:75], v[80:83], v[48:51], v[72:75]
    v_cvt_pk_bf16_f32 v59, v38, v39
    v_exp_f32 v42, v42
    v_mfma_f32_32x32x16_bf16 a[32:47], a[140:143], v[52:55], a[32:47]
    v_exp_f32 v43, v43
    v_cvt_pk_bf16_f32 v60, v40, v41
    v_exp_f32 v44, v44
    v_exp_f32 v45, v45
    v_cvt_pk_bf16_f32 v61, v42, v43
    v_exp_f32 v46, v46
    v_exp_f32 v47, v47
    v_cvt_pk_bf16_f32 v62, v44, v45
    v_mfma_f32_16x16x32_bf16 v[72:75], v[80:83], v[52:55], v[72:75]
L_pad_9:
    s_cbranch_execz L_pad_12
    v_cvt_pk_bf16_f32 v63, v46, v47
    v_exp_f32 v16, v16
    v_mfma_f32_32x32x16_bf16 v[32:47], a[144:147], a[72:75], 0
    v_exp_f32 v17, v17
    v_exp_f32 v18, v18
    v_exp_f32 v19, v19
    v_cvt_pk_bf16_f32 v48, v16, v17
    v_mfma_f32_32x32x16_bf16 a[48:63], a[136:139], v[56:59], a[48:63]
    v_exp_f32 v20, v20
    v_exp_f32 v21, v21
    v_cvt_pk_bf16_f32 v49, v18, v19
    v_exp_f32 v22, v22
    v_mfma_f32_32x32x16_bf16 v[32:47], a[148:151], a[76:79], v[32:47]
    v_exp_f32 v23, v23
    v_cvt_pk_bf16_f32 v50, v20, v21
    v_exp_f32 v24, v24
    v_exp_f32 v25, v25
    v_mfma_f32_16x16x32_bf16 v[76:79], v[80:83], v[56:59], v[76:79]
    v_cvt_pk_bf16_f32 v51, v22, v23
    v_exp_f32 v26, v26
    v_mfma_f32_32x32x16_bf16 a[48:63], a[140:143], v[60:63], a[48:63]
    v_exp_f32 v27, v27
    buffer_load_dwordx4 a[224:227], v224, s[8:11], s70 offen sc1
    buffer_load_dwordx4 a[228:231], v225, s[8:11], s70 offen sc1
    buffer_load_dwordx4 a[232:235], v226, s[8:11], s70 offen sc1
    buffer_load_dwordx4 a[236:239], v227, s[8:11], s70 offen sc1
    s_add_u32 s70, s70, 1024
    v_cvt_pk_bf16_f32 v52, v24, v25
    v_exp_f32 v28, v28
    v_exp_f32 v29, v29
    v_cvt_pk_bf16_f32 v53, v26, v27
    v_exp_f32 v30, v30
    v_exp_f32 v31, v31
    v_cvt_pk_bf16_f32 v54, v28, v29
    v_mfma_f32_16x16x32_bf16 v[76:79], v[80:83], v[60:63], v[76:79]
    v_cvt_pk_bf16_f32 v55, v30, v31
    s_waitcnt vmcnt(16)
    v_exp_f32 v32, v32
    v_mfma_f32_32x32x16_bf16 v[16:31], a[144:147], a[80:83], 0
    v_exp_f32 v33, v33
    v_exp_f32 v34, v34
    v_exp_f32 v35, v35
    v_cvt_pk_bf16_f32 v56, v32, v33
    v_mfma_f32_32x32x16_bf16 a[0:15], a[152:155], v[48:51], a[0:15]
    v_exp_f32 v36, v36
    v_exp_f32 v37, v37
    v_cvt_pk_bf16_f32 v57, v34, v35
    v_exp_f32 v38, v38
    v_mfma_f32_32x32x16_bf16 v[16:31], a[148:151], a[84:87], v[16:31]
    v_exp_f32 v39, v39
    v_cvt_pk_bf16_f32 v58, v36, v37
    v_exp_f32 v40, v40
    v_exp_f32 v41, v41
    v_mfma_f32_16x16x32_bf16 v[64:67], v[80:83], v[48:51], v[64:67]
    v_cvt_pk_bf16_f32 v59, v38, v39
    v_exp_f32 v42, v42
    v_mfma_f32_32x32x16_bf16 a[0:15], a[156:159], v[52:55], a[0:15]
    v_exp_f32 v43, v43
    v_cvt_pk_bf16_f32 v60, v40, v41
    v_exp_f32 v44, v44
    v_exp_f32 v45, v45
    v_cvt_pk_bf16_f32 v61, v42, v43
    v_exp_f32 v46, v46
    v_exp_f32 v47, v47
    v_cvt_pk_bf16_f32 v62, v44, v45
    v_mfma_f32_16x16x32_bf16 v[64:67], v[80:83], v[52:55], v[64:67]
    v_cvt_pk_bf16_f32 v63, v46, v47
    v_exp_f32 v16, v16
    v_mfma_f32_32x32x16_bf16 v[32:47], a[144:147], a[88:91], 0
    v_exp_f32 v17, v17
    v_exp_f32 v18, v18
    v_exp_f32 v19, v19
    v_cvt_pk_bf16_f32 v48, v16, v17
    v_mfma_f32_32x32x16_bf16 a[16:31], a[152:155], v[56:59], a[16:31]
    v_exp_f32 v20, v20
    v_exp_f32 v21, v21
    v_cvt_pk_bf16_f32 v49, v18, v19
    v_exp_f32 v22, v22
    v_mfma_f32_32x32x16_bf16 v[32:47], a[148:151], a[92:95], v[32:47]
    v_exp_f32 v23, v23
    v_cvt_pk_bf16_f32 v50, v20, v21
    v_exp_f32 v24, v24
    v_exp_f32 v25, v25
    v_mfma_f32_16x16x32_bf16 v[68:71], v[80:83], v[56:59], v[68:71]
    v_cvt_pk_bf16_f32 v51, v22, v23
    v_exp_f32 v26, v26
    v_mfma_f32_32x32x16_bf16 a[16:31], a[156:159], v[60:63], a[16:31]
    v_exp_f32 v27, v27
    v_cvt_pk_bf16_f32 v52, v24, v25
    v_exp_f32 v28, v28
    v_exp_f32 v29, v29
    v_cvt_pk_bf16_f32 v53, v26, v27
    v_exp_f32 v30, v30
    v_exp_f32 v31, v31
    v_cvt_pk_bf16_f32 v54, v28, v29
    v_mfma_f32_16x16x32_bf16 v[68:71], v[80:83], v[60:63], v[68:71]
    v_cvt_pk_bf16_f32 v55, v30, v31
    v_exp_f32 v32, v32
    v_mfma_f32_32x32x16_bf16 a[32:47], a[152:155], v[48:51], a[32:47]
    v_exp_f32 v33, v33
    v_exp_f32 v34, v34
    v_exp_f32 v35, v35
    v_cvt_pk_bf16_f32 v56, v32, v33
    v_mfma_f32_16x16x32_bf16 v[72:75], v[80:83], v[48:51], v[72:75]
    v_exp_f32 v36, v36
    v_exp_f32 v37, v37
    v_mfma_f32_32x32x16_bf16 a[32:47], a[156:159], v[52:55], a[32:47]
    v_cvt_pk_bf16_f32 v57, v34, v35
    v_exp_f32 v38, v38
    v_exp_f32 v39, v39
    v_cvt_pk_bf16_f32 v58, v36, v37
    v_exp_f32 v40, v40
    v_exp_f32 v41, v41
    v_cvt_pk_bf16_f32 v59, v38, v39
    v_exp_f32 v42, v42
    v_exp_f32 v43, v43
    v_cvt_pk_bf16_f32 v60, v40, v41
    v_exp_f32 v44, v44
    v_exp_f32 v45, v45
    v_cvt_pk_bf16_f32 v61, v42, v43
    v_exp_f32 v46, v46
    v_exp_f32 v47, v47
    v_cvt_pk_bf16_f32 v62, v44, v45
    v_mfma_f32_16x16x32_bf16 v[72:75], v[80:83], v[52:55], v[72:75]
    v_cvt_pk_bf16_f32 v63, v46, v47
    s_nop 1
    v_mfma_f32_32x32x16_bf16 a[48:63], a[152:155], v[56:59], a[48:63]
    v_mfma_f32_16x16x32_bf16 v[76:79], v[80:83], v[56:59], v[76:79]
    v_mfma_f32_32x32x16_bf16 a[48:63], a[156:159], v[60:63], a[48:63]
    v_mfma_f32_16x16x32_bf16 v[76:79], v[80:83], v[60:63], v[76:79]
    s_lshl_b32 s35, s3, 13
    v_add_u32 v84, s35, v1
    s_lshl_b32 s35, s3, 9
    s_add_u32 s35, s35, 32768
    v_lshlrev_b32 v85, 2, v0
    v_add_u32 v85, s35, v85
    s_nop 7
    ds_write_b32 v85, v72 offset:0
    ds_write_b128 v84, a[32:35] offset:0
    ds_write_b128 v84, a[36:39] offset:1024
    ds_write_b128 v84, a[40:43] offset:2048
    ds_write_b128 v84, a[44:47] offset:3072
    ds_write_b32 v85, v76 offset:256
    ds_write_b128 v84, a[48:51] offset:4096
    ds_write_b128 v84, a[52:55] offset:5120
    ds_write_b128 v84, a[56:59] offset:6144
    ds_write_b128 v84, a[60:63] offset:7168
    v_accvgpr_read_b32 v16, a0
    v_accvgpr_read_b32 v17, a1
    v_accvgpr_read_b32 v18, a2
    v_accvgpr_read_b32 v19, a3
    v_accvgpr_read_b32 v20, a4
    v_accvgpr_read_b32 v21, a5
    v_accvgpr_read_b32 v22, a6
    v_accvgpr_read_b32 v23, a7
    v_accvgpr_read_b32 v24, a8
    v_accvgpr_read_b32 v25, a9
    v_accvgpr_read_b32 v26, a10
    v_accvgpr_read_b32 v27, a11
    v_accvgpr_read_b32 v28, a12
    v_accvgpr_read_b32 v29, a13
    v_accvgpr_read_b32 v30, a14
    v_accvgpr_read_b32 v31, a15
    v_accvgpr_read_b32 v32, a16
    v_accvgpr_read_b32 v33, a17
    v_accvgpr_read_b32 v34, a18
    v_accvgpr_read_b32 v35, a19
    v_accvgpr_read_b32 v36, a20
    v_accvgpr_read_b32 v37, a21
    v_accvgpr_read_b32 v38, a22
    v_accvgpr_read_b32 v39, a23
    v_accvgpr_read_b32 v40, a24
    v_accvgpr_read_b32 v41, a25
    v_accvgpr_read_b32 v42, a26
    v_accvgpr_read_b32 v43, a27
    v_accvgpr_read_b32 v44, a28
    v_accvgpr_read_b32 v45, a29
    v_accvgpr_read_b32 v46, a30
    v_accvgpr_read_b32 v47, a31
    s_xor_b32 s34, s3, 2
    s_lshl_b32 s35, s34, 13
    v_add_u32 v84, s35, v1
    s_lshl_b32 s35, s34, 9
    s_add_u32 s35, s35, 32768
    v_lshlrev_b32 v85, 2, v0
    v_add_u32 v85, s35, v85
    s_waitcnt lgkmcnt(0)
    s_barrier
    ds_read_b32 v120, v85 offset:0
    ds_read_b128 v[88:91], v84 offset:0
    ds_read_b128 v[92:95], v84 offset:1024
    ds_read_b128 v[96:99], v84 offset:2048
    ds_read_b128 v[100:103], v84 offset:3072
    ds_read_b32 v121, v85 offset:256
    ds_read_b128 v[104:107], v84 offset:4096
    ds_read_b128 v[108:111], v84 offset:5120
    ds_read_b128 v[112:115], v84 offset:6144
    ds_read_b128 v[116:119], v84 offset:7168
    s_waitcnt lgkmcnt(5)
    v_pk_add_f32 v[16:17], v[16:17], v[88:89]
    v_pk_add_f32 v[18:19], v[18:19], v[90:91]
    v_pk_add_f32 v[20:21], v[20:21], v[92:93]
    v_pk_add_f32 v[22:23], v[22:23], v[94:95]
    v_pk_add_f32 v[24:25], v[24:25], v[96:97]
    v_pk_add_f32 v[26:27], v[26:27], v[98:99]
    v_pk_add_f32 v[28:29], v[28:29], v[100:101]
    v_pk_add_f32 v[30:31], v[30:31], v[102:103]
    v_add_f32 v64, v64, v120
    s_waitcnt lgkmcnt(0)
    v_pk_add_f32 v[32:33], v[32:33], v[104:105]
    v_pk_add_f32 v[34:35], v[34:35], v[106:107]
    v_pk_add_f32 v[36:37], v[36:37], v[108:109]
    v_pk_add_f32 v[38:39], v[38:39], v[110:111]
    v_pk_add_f32 v[40:41], v[40:41], v[112:113]
    v_pk_add_f32 v[42:43], v[42:43], v[114:115]
    v_pk_add_f32 v[44:45], v[44:45], v[116:117]
    v_pk_add_f32 v[46:47], v[46:47], v[118:119]
    v_add_f32 v68, v68, v121
L_A_check:
    v_mov_b32 v4, 0
    v_mov_b32 v5, 0
    v_pk_fma_f32 v[4:5], v[16:17], 0, v[4:5] op_sel_hi:[1,0,1]
    v_pk_fma_f32 v[4:5], v[18:19], 0, v[4:5] op_sel_hi:[1,0,1]
    v_pk_fma_f32 v[4:5], v[20:21], 0, v[4:5] op_sel_hi:[1,0,1]
    v_pk_fma_f32 v[4:5], v[22:23], 0, v[4:5] op_sel_hi:[1,0,1]
    v_pk_fma_f32 v[4:5], v[24:25], 0, v[4:5] op_sel_hi:[1,0,1]
    v_pk_fma_f32 v[4:5], v[26:27], 0, v[4:5] op_sel_hi:[1,0,1]
    v_pk_fma_f32 v[4:5], v[28:29], 0, v[4:5] op_sel_hi:[1,0,1]
    v_pk_fma_f32 v[4:5], v[30:31], 0, v[4:5] op_sel_hi:[1,0,1]
    v_pk_fma_f32 v[4:5], v[32:33], 0, v[4:5] op_sel_hi:[1,0,1]
    v_pk_fma_f32 v[4:5], v[34:35], 0, v[4:5] op_sel_hi:[1,0,1]
    v_pk_fma_f32 v[4:5], v[36:37], 0, v[4:5] op_sel_hi:[1,0,1]
    v_pk_fma_f32 v[4:5], v[38:39], 0, v[4:5] op_sel_hi:[1,0,1]
    v_pk_fma_f32 v[4:5], v[40:41], 0, v[4:5] op_sel_hi:[1,0,1]
    v_pk_fma_f32 v[4:5], v[42:43], 0, v[4:5] op_sel_hi:[1,0,1]
    v_pk_fma_f32 v[4:5], v[44:45], 0, v[4:5] op_sel_hi:[1,0,1]
    v_pk_fma_f32 v[4:5], v[46:47], 0, v[4:5] op_sel_hi:[1,0,1]
    v_add_f32 v4, v4, v5
    s_mov_b32 s34, 0x1f800000
    s_mov_b32 s35, 0x5f800000
    v_cmp_le_f32 s[36:37], s34, v64
    v_cmp_ge_f32 s[38:39], s35, v64
    v_cmp_le_f32 s[40:41], s34, v68
    v_cmp_ge_f32 s[42:43], s35, v68
    v_cmp_eq_f32 vcc, 0, v4
    s_nop 1
    s_and_b64 s[36:37], s[36:37], s[38:39]
    s_and_b64 s[40:41], s[40:41], s[42:43]
    s_and_b64 s[36:37], s[36:37], s[40:41]
    s_and_b64 s[36:37], s[36:37], vcc
    s_cmp_eq_u64 s[36:37], -1
    s_cbranch_scc1 L_A_norm
    s_cmp_eq_u32 s33, 1
    s_cbranch_scc1 L_A_norm
    s_mov_b32 s33, 1
    v_accvgpr_write_b32 a0, 0
    v_accvgpr_write_b32 a1, 0
    v_accvgpr_write_b32 a2, 0
    v_accvgpr_write_b32 a3, 0
    v_accvgpr_write_b32 a4, 0
    v_accvgpr_write_b32 a5, 0
    v_accvgpr_write_b32 a6, 0
    v_accvgpr_write_b32 a7, 0
    v_accvgpr_write_b32 a8, 0
    v_accvgpr_write_b32 a9, 0
    v_accvgpr_write_b32 a10, 0
    v_accvgpr_write_b32 a11, 0
    v_accvgpr_write_b32 a12, 0
    v_accvgpr_write_b32 a13, 0
    v_accvgpr_write_b32 a14, 0
    v_accvgpr_write_b32 a15, 0
    v_accvgpr_write_b32 a16, 0
    v_accvgpr_write_b32 a17, 0
    v_accvgpr_write_b32 a18, 0
    v_accvgpr_write_b32 a19, 0
    v_accvgpr_write_b32 a20, 0
    v_accvgpr_write_b32 a21, 0
    v_accvgpr_write_b32 a22, 0
    v_accvgpr_write_b32 a23, 0
    v_accvgpr_write_b32 a24, 0
    v_accvgpr_write_b32 a25, 0
    v_accvgpr_write_b32 a26, 0
    v_accvgpr_write_b32 a27, 0
    v_accvgpr_write_b32 a28, 0
    v_accvgpr_write_b32 a29, 0
    v_accvgpr_write_b32 a30, 0
    v_accvgpr_write_b32 a31, 0
    v_mov_b32 v64, 0
    v_mov_b32 v65, 0
    v_mov_b32 v66, 0
    v_mov_b32 v67, 0
    v_mov_b32 v68, 0
    v_mov_b32 v69, 0
    v_mov_b32 v70, 0
    v_mov_b32 v71, 0
    v_mov_b32 v122, 0xff7fffff
    v_mov_b32 v123, 0xff7fffff
    s_lshl_b32 s34, s24, 17
    s_add_u32 s36, s34, 9437184
    s_add_u32 s37, s34, 13631488
    s_mov_b32 s38, 64
L_A_safe:
    buffer_load_dwordx4 a[96:99], v1, s[8:11], s36 offen offset:0 sc1
    buffer_load_dwordx4 a[104:107], v1, s[8:11], s37 offen offset:0 sc1
    buffer_load_dwordx4 a[100:103], v1, s[8:11], s36 offen offset:1024 sc1
    buffer_load_dwordx4 a[108:111], v1, s[8:11], s37 offen offset:1024 sc1
    s_waitcnt vmcnt(0)
    v_mfma_f32_32x32x16_bf16 v[16:31], a[96:99], a[64:67], 0
    v_mfma_f32_32x32x16_bf16 v[16:31], a[100:103], a[68:71], v[16:31]
    s_nop 7
    s_nop 7
    v_max3_f32 v125, v16, v17, v18
    v_max3_f32 v125, v125, v19, v20
    v_max3_f32 v125, v125, v21, v22
    v_max3_f32 v125, v125, v23, v24
    v_max3_f32 v125, v125, v25, v26
    v_max3_f32 v125, v125, v27, v28
    v_max3_f32 v125, v125, v29, v30
    v_max_f32 v125, v125, v31
    v_mov_b32 v126, v125
    s_nop 1
    v_permlane32_swap_b32 v125, v126
    s_nop 1
    v_max_f32 v125, v125, v126
    v_max_f32 v125, v125, v122
    v_sub_f32 v124, v122, v125
    v_exp_f32 v124, v124
    v_mov_b32 v122, v125
    v_sub_f32 v16, v16, v125
    v_sub_f32 v17, v17, v125
    v_sub_f32 v18, v18, v125
    v_sub_f32 v19, v19, v125
    v_sub_f32 v20, v20, v125
    v_sub_f32 v21, v21, v125
    v_sub_f32 v22, v22, v125
    v_sub_f32 v23, v23, v125
    v_sub_f32 v24, v24, v125
    v_sub_f32 v25, v25, v125
    v_sub_f32 v26, v26, v125
    v_sub_f32 v27, v27, v125
    v_sub_f32 v28, v28, v125
    v_sub_f32 v29, v29, v125
    v_sub_f32 v30, v30, v125
    v_sub_f32 v31, v31, v125
    v_exp_f32 v16, v16
    v_exp_f32 v17, v17
    v_exp_f32 v18, v18
    v_exp_f32 v19, v19
    v_exp_f32 v20, v20
    v_exp_f32 v21, v21
    v_exp_f32 v22, v22
    v_exp_f32 v23, v23
    v_exp_f32 v24, v24
    v_exp_f32 v25, v25
    v_exp_f32 v26, v26
    v_exp_f32 v27, v27
    v_exp_f32 v28, v28
    v_exp_f32 v29, v29
    v_exp_f32 v30, v30
    v_exp_f32 v31, v31
    s_nop 0
    v_cvt_pk_bf16_f32 v48, v16, v17
    v_cvt_pk_bf16_f32 v49, v18, v19
    v_cvt_pk_bf16_f32 v50, v20, v21
    v_cvt_pk_bf16_f32 v51, v22, v23
    v_cvt_pk_bf16_f32 v52, v24, v25
    v_cvt_pk_bf16_f32 v53, v26, v27
    v_cvt_pk_bf16_f32 v54, v28, v29
    v_cvt_pk_bf16_f32 v55, v30, v31
    v_mul_f32 v64, v64, v124
    v_mul_f32 v65, v65, v124
    v_mul_f32 v66, v66, v124
    v_mul_f32 v67, v67, v124
    v_accvgpr_read_b32 v125, a0
    s_nop 0
    v_mul_f32 v125, v125, v124
    s_nop 0
    v_accvgpr_write_b32 a0, v125
    v_accvgpr_read_b32 v125, a1
    s_nop 0
    v_mul_f32 v125, v125, v124
    s_nop 0
    v_accvgpr_write_b32 a1, v125
    v_accvgpr_read_b32 v125, a2
    s_nop 0
    v_mul_f32 v125, v125, v124
    s_nop 0
    v_accvgpr_write_b32 a2, v125
    v_accvgpr_read_b32 v125, a3
    s_nop 0
    v_mul_f32 v125, v125, v124
    s_nop 0
    v_accvgpr_write_b32 a3, v125
    v_accvgpr_read_b32 v125, a4
    s_nop 0
    v_mul_f32 v125, v125, v124
    s_nop 0
    v_accvgpr_write_b32 a4, v125
    v_accvgpr_read_b32 v125, a5
    s_nop 0
    v_mul_f32 v125, v125, v124
    s_nop 0
    v_accvgpr_write_b32 a5, v125
    v_accvgpr_read_b32 v125, a6
    s_nop 0
    v_mul_f32 v125, v125, v124
    s_nop 0
    v_accvgpr_write_b32 a6, v125
    v_accvgpr_read_b32 v125, a7
    s_nop 0
    v_mul_f32 v125, v125, v124
    s_nop 0
    v_accvgpr_write_b32 a7, v125
    v_accvgpr_read_b32 v125, a8
    s_nop 0
    v_mul_f32 v125, v125, v124
    s_nop 0
    v_accvgpr_write_b32 a8, v125
    v_accvgpr_read_b32 v125, a9
    s_nop 0
    v_mul_f32 v125, v125, v124
    s_nop 0
    v_accvgpr_write_b32 a9, v125
    v_accvgpr_read_b32 v125, a10
    s_nop 0
    v_mul_f32 v125, v125, v124
    s_nop 0
    v_accvgpr_write_b32 a10, v125
    v_accvgpr_read_b32 v125, a11
    s_nop 0
    v_mul_f32 v125, v125, v124
    s_nop 0
    v_accvgpr_write_b32 a11, v125
    v_accvgpr_read_b32 v125, a12
    s_nop 0
    v_mul_f32 v125, v125, v124
    s_nop 0
    v_accvgpr_write_b32 a12, v125
    v_accvgpr_read_b32 v125, a13
    s_nop 0
    v_mul_f32 v125, v125, v124
    s_nop 0
    v_accvgpr_write_b32 a13, v125
    v_accvgpr_read_b32 v125, a14
    s_nop 0
    v_mul_f32 v125, v125, v124
    s_nop 0
    v_accvgpr_write_b32 a14, v125
    v_accvgpr_read_b32 v125, a15
    s_nop 0
    v_mul_f32 v125, v125, v124
    s_nop 0
    v_accvgpr_write_b32 a15, v125
    s_nop 3
    v_mfma_f32_32x32x16_bf16 a[0:15], a[104:107], v[48:51], a[0:15]
    v_mfma_f32_16x16x32_bf16 v[64:67], v[80:83], v[48:51], v[64:67]
    v_mfma_f32_32x32x16_bf16 a[0:15], a[108:111], v[52:55], a[0:15]
    v_mfma_f32_16x16x32_bf16 v[64:67], v[80:83], v[52:55], v[64:67]
    s_nop 7
    s_nop 7
    v_mfma_f32_32x32x16_bf16 v[32:47], a[96:99], a[72:75], 0
    v_mfma_f32_32x32x16_bf16 v[32:47], a[100:103], a[76:79], v[32:47]
    s_nop 7
    s_nop 7
    v_max3_f32 v125, v32, v33, v34
    v_max3_f32 v125, v125, v35, v36
    v_max3_f32 v125, v125, v37, v38
    v_max3_f32 v125, v125, v39, v40
    v_max3_f32 v125, v125, v41, v42
    v_max3_f32 v125, v125, v43, v44
    v_max3_f32 v125, v125, v45, v46
    v_max_f32 v125, v125, v47
    v_mov_b32 v126, v125
    s_nop 1
    v_permlane32_swap_b32 v125, v126
    s_nop 1
    v_max_f32 v125, v125, v126
    v_max_f32 v125, v125, v123
    v_sub_f32 v124, v123, v125
    v_exp_f32 v124, v124
    v_mov_b32 v123, v125
    v_sub_f32 v32, v32, v125
    v_sub_f32 v33, v33, v125
    v_sub_f32 v34, v34, v125
    v_sub_f32 v35, v35, v125
    v_sub_f32 v36, v36, v125
    v_sub_f32 v37, v37, v125
    v_sub_f32 v38, v38, v125
    v_sub_f32 v39, v39, v125
    v_sub_f32 v40, v40, v125
    v_sub_f32 v41, v41, v125
    v_sub_f32 v42, v42, v125
    v_sub_f32 v43, v43, v125
    v_sub_f32 v44, v44, v125
    v_sub_f32 v45, v45, v125
    v_sub_f32 v46, v46, v125
    v_sub_f32 v47, v47, v125
    v_exp_f32 v32, v32
    v_exp_f32 v33, v33
    v_exp_f32 v34, v34
    v_exp_f32 v35, v35
    v_exp_f32 v36, v36
    v_exp_f32 v37, v37
    v_exp_f32 v38, v38
    v_exp_f32 v39, v39
    v_exp_f32 v40, v40
    v_exp_f32 v41, v41
    v_exp_f32 v42, v42
    v_exp_f32 v43, v43
    v_exp_f32 v44, v44
    v_exp_f32 v45, v45
    v_exp_f32 v46, v46
    v_exp_f32 v47, v47
    s_nop 0
    v_cvt_pk_bf16_f32 v56, v32, v33
    v_cvt_pk_bf16_f32 v57, v34, v35
    v_cvt_pk_bf16_f32 v58, v36, v37
    v_cvt_pk_bf16_f32 v59, v38, v39
    v_cvt_pk_bf16_f32 v60, v40, v41
    v_cvt_pk_bf16_f32 v61, v42, v43
    v_cvt_pk_bf16_f32 v62, v44, v45
    v_cvt_pk_bf16_f32 v63, v46, v47
    v_mul_f32 v68, v68, v124
    v_mul_f32 v69, v69, v124
    v_mul_f32 v70, v70, v124
    v_mul_f32 v71, v71, v124
    v_accvgpr_read_b32 v125, a16
    s_nop 0
    v_mul_f32 v125, v125, v124
    s_nop 0
    v_accvgpr_write_b32 a16, v125
    v_accvgpr_read_b32 v125, a17
    s_nop 0
    v_mul_f32 v125, v125, v124
    s_nop 0
    v_accvgpr_write_b32 a17, v125
    v_accvgpr_read_b32 v125, a18
    s_nop 0
    v_mul_f32 v125, v125, v124
    s_nop 0
    v_accvgpr_write_b32 a18, v125
    v_accvgpr_read_b32 v125, a19
    s_nop 0
    v_mul_f32 v125, v125, v124
    s_nop 0
    v_accvgpr_write_b32 a19, v125
    v_accvgpr_read_b32 v125, a20
    s_nop 0
    v_mul_f32 v125, v125, v124
    s_nop 0
    v_accvgpr_write_b32 a20, v125
    v_accvgpr_read_b32 v125, a21
    s_nop 0
    v_mul_f32 v125, v125, v124
    s_nop 0
    v_accvgpr_write_b32 a21, v125
    v_accvgpr_read_b32 v125, a22
    s_nop 0
    v_mul_f32 v125, v125, v124
    s_nop 0
    v_accvgpr_write_b32 a22, v125
    v_accvgpr_read_b32 v125, a23
    s_nop 0
    v_mul_f32 v125, v125, v124
    s_nop 0
    v_accvgpr_write_b32 a23, v125
    v_accvgpr_read_b32 v125, a24
    s_nop 0
    v_mul_f32 v125, v125, v124
    s_nop 0
    v_accvgpr_write_b32 a24, v125
    v_accvgpr_read_b32 v125, a25
    s_nop 0
    v_mul_f32 v125, v125, v124
    s_nop 0
    v_accvgpr_write_b32 a25, v125
    v_accvgpr_read_b32 v125, a26
    s_nop 0
    v_mul_f32 v125, v125, v124
    s_nop 0
    v_accvgpr_write_b32 a26, v125
    v_accvgpr_read_b32 v125, a27
    s_nop 0
    v_mul_f32 v125, v125, v124
    s_nop 0
    v_accvgpr_write_b32 a27, v125
    v_accvgpr_read_b32 v125, a28
    s_nop 0
    v_mul_f32 v125, v125, v124
    s_nop 0
    v_accvgpr_write_b32 a28, v125
    v_accvgpr_read_b32 v125, a29
    s_nop 0
    v_mul_f32 v125, v125, v124
    s_nop 0
    v_accvgpr_write_b32 a29, v125
    v_accvgpr_read_b32 v125, a30
    s_nop 0
    v_mul_f32 v125, v125, v124
    s_nop 0
    v_accvgpr_write_b32 a30, v125
    v_accvgpr_read_b32 v125, a31
    s_nop 0
    v_mul_f32 v125, v125, v124
    s_nop 0
    v_accvgpr_write_b32 a31, v125
    s_nop 3
    v_mfma_f32_32x32x16_bf16 a[16:31], a[104:107], v[56:59], a[16:31]
    v_mfma_f32_16x16x32_bf16 v[68:71], v[80:83], v[56:59], v[68:71]
    v_mfma_f32_32x32x16_bf16 a[16:31], a[108:111], v[60:63], a[16:31]
    v_mfma_f32_16x16x32_bf16 v[68:71], v[80:83], v[60:63], v[68:71]
    s_nop 7
    s_nop 7
    s_add_u32 s36, s36, 2048
    s_add_u32 s37, s37, 2048
    s_sub_u32 s38, s38, 1
    s_cmp_lg_u32 s38, 0
    s_cbranch_scc1 L_A_safe
    v_accvgpr_read_b32 v16, a0
    v_accvgpr_read_b32 v17, a1
    v_accvgpr_read_b32 v18, a2
    v_accvgpr_read_b32 v19, a3
    v_accvgpr_read_b32 v20, a4
    v_accvgpr_read_b32 v21, a5
    v_accvgpr_read_b32 v22, a6
    v_accvgpr_read_b32 v23, a7
    v_accvgpr_read_b32 v24, a8
    v_accvgpr_read_b32 v25, a9
    v_accvgpr_read_b32 v26, a10
    v_accvgpr_read_b32 v27, a11
    v_accvgpr_read_b32 v28, a12
    v_accvgpr_read_b32 v29, a13
    v_accvgpr_read_b32 v30, a14
    v_accvgpr_read_b32 v31, a15
    v_accvgpr_read_b32 v32, a16
    v_accvgpr_read_b32 v33, a17
    v_accvgpr_read_b32 v34, a18
    v_accvgpr_read_b32 v35, a19
    v_accvgpr_read_b32 v36, a20
    v_accvgpr_read_b32 v37, a21
    v_accvgpr_read_b32 v38, a22
    v_accvgpr_read_b32 v39, a23
    v_accvgpr_read_b32 v40, a24
    v_accvgpr_read_b32 v41, a25
    v_accvgpr_read_b32 v42, a26
    v_accvgpr_read_b32 v43, a27
    v_accvgpr_read_b32 v44, a28
    v_accvgpr_read_b32 v45, a29
    v_accvgpr_read_b32 v46, a30
    v_accvgpr_read_b32 v47, a31
    s_branch L_A_check
L_A_norm:
    v_rcp_f32 v64, v64
    v_rcp_f32 v68, v68
    s_and_b32 s35, s3, 1
    s_lshl_b32 s35, s35, 2
    s_and_b32 s34, s3, 2
    s_add_u32 s35, s35, s34
    s_lshl_b32 s34, s25, 3
    s_add_u32 s34, s34, s35
    s_lshl_b32 s34, s34, 5
    s_add_u32 s34, s34, s24
    s_lshl_b32 s34, s34, 11
    s_add_u32 s34, s34, 49283072
    v_pk_mul_f32 v[16:17], v[16:17], v[64:65] op_sel_hi:[1,0]
    v_pk_mul_f32 v[18:19], v[18:19], v[64:65] op_sel_hi:[1,0]
    v_pk_mul_f32 v[20:21], v[20:21], v[64:65] op_sel_hi:[1,0]
    v_pk_mul_f32 v[22:23], v[22:23], v[64:65] op_sel_hi:[1,0]
    v_pk_mul_f32 v[24:25], v[24:25], v[64:65] op_sel_hi:[1,0]
    v_pk_mul_f32 v[26:27], v[26:27], v[64:65] op_sel_hi:[1,0]
    v_pk_mul_f32 v[28:29], v[28:29], v[64:65] op_sel_hi:[1,0]
    v_pk_mul_f32 v[30:31], v[30:31], v[64:65] op_sel_hi:[1,0]
    v_cvt_pk_bf16_f32 v48, v16, v17
    v_cvt_pk_bf16_f32 v49, v18, v19
    v_cvt_pk_bf16_f32 v50, v20, v21
    v_cvt_pk_bf16_f32 v51, v22, v23
    v_cvt_pk_bf16_f32 v52, v24, v25
L_pad_10:
    s_cbranch_execz L_pad_13
    v_cvt_pk_bf16_f32 v53, v26, v27
    v_cvt_pk_bf16_f32 v54, v28, v29
    v_cvt_pk_bf16_f32 v55, v30, v31
    s_add_u32 s35, s34, 0
    buffer_store_dwordx4 v[48:51], v1, s[8:11], s35 offen offset:0 sc1
    buffer_store_dwordx4 v[52:55], v1, s[8:11], s35 offen offset:1024 sc1
    v_pk_mul_f32 v[32:33], v[32:33], v[68:69] op_sel_hi:[1,0]
    v_pk_mul_f32 v[34:35], v[34:35], v[68:69] op_sel_hi:[1,0]
    v_pk_mul_f32 v[36:37], v[36:37], v[68:69] op_sel_hi:[1,0]
    v_pk_mul_f32 v[38:39], v[38:39], v[68:69] op_sel_hi:[1,0]
    v_pk_mul_f32 v[40:41], v[40:41], v[68:69] op_sel_hi:[1,0]
    v_pk_mul_f32 v[42:43], v[42:43], v[68:69] op_sel_hi:[1,0]
    v_pk_mul_f32 v[44:45], v[44:45], v[68:69] op_sel_hi:[1,0]
    v_pk_mul_f32 v[46:47], v[46:47], v[68:69] op_sel_hi:[1,0]
    v_cvt_pk_bf16_f32 v56, v32, v33
    v_cvt_pk_bf16_f32 v57, v34, v35
    v_cvt_pk_bf16_f32 v58, v36, v37
    v_cvt_pk_bf16_f32 v59, v38, v39
    v_cvt_pk_bf16_f32 v60, v40, v41
    v_cvt_pk_bf16_f32 v61, v42, v43
    v_cvt_pk_bf16_f32 v62, v44, v45
    v_cvt_pk_bf16_f32 v63, v46, v47
    s_add_u32 s35, s34, 65536
    buffer_store_dwordx4 v[56:59], v1, s[8:11], s35 offen offset:0 sc1
    buffer_store_dwordx4 v[60:63], v1, s[8:11], s35 offen offset:1024 sc1
    s_barrier
    ds_read_b64_tr_b16 a[0:1], v228 offset:0
    ds_read_b64_tr_b16 a[2:3], v228 offset:512
    ds_read_b64_tr_b16 a[4:5], v229 offset:0
    ds_read_b64_tr_b16 a[6:7], v229 offset:512
    ds_read_b64_tr_b16 a[8:9], v228 offset:4096
    ds_read_b64_tr_b16 a[10:11], v228 offset:4608
    ds_read_b64_tr_b16 a[12:13], v229 offset:4096
    ds_read_b64_tr_b16 a[14:15], v229 offset:4608
    s_waitcnt vmcnt(12)
    s_waitcnt lgkmcnt(6)
    v_mfma_f32_16x16x32_bf16 v[16:19], a[0:3], a[192:195], 0
    ds_read_b64_tr_b16 a[16:17], v228 offset:8192
    v_mfma_f32_16x16x32_bf16 v[20:23], a[0:3], a[196:199], 0
    ds_read_b64_tr_b16 a[18:19], v228 offset:8704
    v_mfma_f32_16x16x32_bf16 v[24:27], a[0:3], a[200:203], 0
    buffer_load_dwordx4 a[240:243], v224, s[8:11], s70 offen sc1
    v_mfma_f32_16x16x32_bf16 v[28:31], a[0:3], a[204:207], 0
    s_waitcnt lgkmcnt(6)
    v_mfma_f32_16x16x32_bf16 v[32:35], a[4:7], a[192:195], 0
    ds_read_b64_tr_b16 a[20:21], v229 offset:8192
    v_mfma_f32_16x16x32_bf16 v[36:39], a[4:7], a[196:199], 0
    ds_read_b64_tr_b16 a[22:23], v229 offset:8704
    v_mfma_f32_16x16x32_bf16 v[40:43], a[4:7], a[200:203], 0
    s_add_u32 m0, s89, 0
    s_nop 0
    buffer_load_dwordx4 v247, s[20:23], s71 offen offset:0 lds
    v_mfma_f32_16x16x32_bf16 v[44:47], a[4:7], a[204:207], 0
    s_waitcnt lgkmcnt(6)
    v_mfma_f32_16x16x32_bf16 v[48:51], a[8:11], a[192:195], 0
    ds_read_b64_tr_b16 a[24:25], v228 offset:12288
    v_mfma_f32_16x16x32_bf16 v[52:55], a[8:11], a[196:199], 0
    ds_read_b64_tr_b16 a[26:27], v228 offset:12800
    v_mfma_f32_16x16x32_bf16 v[56:59], a[8:11], a[200:203], 0
    buffer_load_dwordx4 a[244:247], v225, s[8:11], s70 offen sc1
    v_mfma_f32_16x16x32_bf16 v[60:63], a[8:11], a[204:207], 0
    s_waitcnt lgkmcnt(6)
    v_mfma_f32_16x16x32_bf16 v[64:67], a[12:15], a[192:195], 0
    ds_read_b64_tr_b16 a[28:29], v229 offset:12288
    v_mfma_f32_16x16x32_bf16 v[68:71], a[12:15], a[196:199], 0
    ds_read_b64_tr_b16 a[30:31], v229 offset:12800
    v_mfma_f32_16x16x32_bf16 v[72:75], a[12:15], a[200:203], 0
    s_add_u32 m0, s89, 4032
    s_nop 0
    buffer_load_dwordx4 v247, s[20:23], s71 offen offset:64 lds
    v_mfma_f32_16x16x32_bf16 v[76:79], a[12:15], a[204:207], 0
    s_waitcnt lgkmcnt(6)
    v_mfma_f32_16x16x32_bf16 v[80:83], a[16:19], a[192:195], 0
    ds_read_b64_tr_b16 a[0:1], v228 offset:2048
    v_mfma_f32_16x16x32_bf16 v[84:87], a[16:19], a[196:199], 0
    ds_read_b64_tr_b16 a[2:3], v228 offset:2560
    v_mfma_f32_16x16x32_bf16 v[88:91], a[16:19], a[200:203], 0
    buffer_load_dwordx4 a[248:251], v226, s[8:11], s70 offen sc1
    v_mfma_f32_16x16x32_bf16 v[92:95], a[16:19], a[204:207], 0
    s_waitcnt lgkmcnt(6)
    v_mfma_f32_16x16x32_bf16 v[96:99], a[20:23], a[192:195], 0
    ds_read_b64_tr_b16 a[4:5], v229 offset:2048
    v_mfma_f32_16x16x32_bf16 v[100:103], a[20:23], a[196:199], 0
    ds_read_b64_tr_b16 a[6:7], v229 offset:2560
    v_mfma_f32_16x16x32_bf16 v[104:107], a[20:23], a[200:203], 0
    s_add_u32 m0, s89, 8192
    s_nop 0
    buffer_load_dwordx4 v248, s[20:23], s71 offen offset:0 lds
    v_mfma_f32_16x16x32_bf16 v[108:111], a[20:23], a[204:207], 0
    s_waitcnt lgkmcnt(6)
    v_mfma_f32_16x16x32_bf16 v[112:115], a[24:27], a[192:195], 0
    ds_read_b64_tr_b16 a[8:9], v228 offset:6144
    v_mfma_f32_16x16x32_bf16 v[116:119], a[24:27], a[196:199], 0
    ds_read_b64_tr_b16 a[10:11], v228 offset:6656
    v_mfma_f32_16x16x32_bf16 v[120:123], a[24:27], a[200:203], 0
    buffer_load_dwordx4 a[252:255], v227, s[8:11], s70 offen sc1
    v_mfma_f32_16x16x32_bf16 v[124:127], a[24:27], a[204:207], 0
    s_waitcnt lgkmcnt(6)
    v_mfma_f32_16x16x32_bf16 v[128:131], a[28:31], a[192:195], 0
    ds_read_b64_tr_b16 a[12:13], v229 offset:6144
    v_mfma_f32_16x16x32_bf16 v[132:135], a[28:31], a[196:199], 0
    ds_read_b64_tr_b16 a[14:15], v229 offset:6656
    v_mfma_f32_16x16x32_bf16 v[136:139], a[28:31], a[200:203], 0
    s_add_u32 m0, s89, 12224
    s_nop 0
    buffer_load_dwordx4 v248, s[20:23], s71 offen offset:64 lds
    s_add_u32 s70, s70, 1024
    v_mfma_f32_16x16x32_bf16 v[140:143], a[28:31], a[204:207], 0
    s_waitcnt vmcnt(16)
    s_waitcnt lgkmcnt(6)
    v_mfma_f32_16x16x32_bf16 v[16:19], a[0:3], a[208:211], v[16:19]
    ds_read_b64_tr_b16 a[16:17], v228 offset:10240
    v_mfma_f32_16x16x32_bf16 v[20:23], a[0:3], a[212:215], v[20:23]
    ds_read_b64_tr_b16 a[18:19], v228 offset:10752
    v_mfma_f32_16x16x32_bf16 v[24:27], a[0:3], a[216:219], v[24:27]
    s_add_u32 s71, s71, 131072
    s_add_u32 s89, s89, 16384
    s_sub_u32 s39, s89, 65536
    s_cmp_ge_u32 s39, 98304
    s_cselect_b32 s39, 98304, 0
    s_sub_u32 s89, s89, s39
    buffer_load_dwordx4 a[192:195], v224, s[8:11], s70 offen sc1
    v_mfma_f32_16x16x32_bf16 v[28:31], a[0:3], a[220:223], v[28:31]
    s_waitcnt lgkmcnt(6)
    v_mfma_f32_16x16x32_bf16 v[32:35], a[4:7], a[208:211], v[32:35]
    ds_read_b64_tr_b16 a[20:21], v229 offset:10240
    v_mfma_f32_16x16x32_bf16 v[36:39], a[4:7], a[212:215], v[36:39]
    ds_read_b64_tr_b16 a[22:23], v229 offset:10752
    v_mfma_f32_16x16x32_bf16 v[40:43], a[4:7], a[216:219], v[40:43]
    v_mfma_f32_16x16x32_bf16 v[44:47], a[4:7], a[220:223], v[44:47]
    s_add_u32 s67, s67, 16384
    s_cmp_ge_u32 s67, 163840
    s_cselect_b32 s39, 98304, 0
    s_sub_u32 s67, s67, s39
    s_waitcnt lgkmcnt(6)
    v_mfma_f32_16x16x32_bf16 v[48:51], a[8:11], a[208:211], v[48:51]
    ds_read_b64_tr_b16 a[24:25], v228 offset:14336
    v_mfma_f32_16x16x32_bf16 v[52:55], a[8:11], a[212:215], v[52:55]
    ds_read_b64_tr_b16 a[26:27], v228 offset:14848
    v_mfma_f32_16x16x32_bf16 v[56:59], a[8:11], a[216:219], v[56:59]
    buffer_load_dwordx4 a[196:199], v225, s[8:11], s70 offen sc1
    v_mfma_f32_16x16x32_bf16 v[60:63], a[8:11], a[220:223], v[60:63]
    s_waitcnt lgkmcnt(6)
    v_mfma_f32_16x16x32_bf16 v[64:67], a[12:15], a[208:211], v[64:67]
    ds_read_b64_tr_b16 a[28:29], v229 offset:14336
    v_mfma_f32_16x16x32_bf16 v[68:71], a[12:15], a[212:215], v[68:71]
    ds_read_b64_tr_b16 a[30:31], v229 offset:14848
    v_mfma_f32_16x16x32_bf16 v[72:75], a[12:15], a[216:219], v[72:75]
    v_mfma_f32_16x16x32_bf16 v[76:79], a[12:15], a[220:223], v[76:79]
    s_barrier
    v_add_u32 v228, s67, v249
    v_add_u32 v229, s67, v250
    s_waitcnt lgkmcnt(6)
    v_mfma_f32_16x16x32_bf16 v[80:83], a[16:19], a[208:211], v[80:83]
    ds_read_b64_tr_b16 a[0:1], v228 offset:0
    v_mfma_f32_16x16x32_bf16 v[84:87], a[16:19], a[212:215], v[84:87]
    ds_read_b64_tr_b16 a[2:3], v228 offset:512
    v_mfma_f32_16x16x32_bf16 v[88:91], a[16:19], a[216:219], v[88:91]
    buffer_load_dwordx4 a[200:203], v226, s[8:11], s70 offen sc1
    v_mfma_f32_16x16x32_bf16 v[92:95], a[16:19], a[220:223], v[92:95]
    s_waitcnt lgkmcnt(6)
    v_mfma_f32_16x16x32_bf16 v[96:99], a[20:23], a[208:211], v[96:99]
    ds_read_b64_tr_b16 a[4:5], v229 offset:0
    v_mfma_f32_16x16x32_bf16 v[100:103], a[20:23], a[212:215], v[100:103]
    ds_read_b64_tr_b16 a[6:7], v229 offset:512
    v_mfma_f32_16x16x32_bf16 v[104:107], a[20:23], a[216:219], v[104:107]
    v_mfma_f32_16x16x32_bf16 v[108:111], a[20:23], a[220:223], v[108:111]
    s_waitcnt lgkmcnt(6)
    v_mfma_f32_16x16x32_bf16 v[112:115], a[24:27], a[208:211], v[112:115]
    ds_read_b64_tr_b16 a[8:9], v228 offset:4096
    v_mfma_f32_16x16x32_bf16 v[116:119], a[24:27], a[212:215], v[116:119]
    ds_read_b64_tr_b16 a[10:11], v228 offset:4608
    v_mfma_f32_16x16x32_bf16 v[120:123], a[24:27], a[216:219], v[120:123]
    buffer_load_dwordx4 a[204:207], v227, s[8:11], s70 offen sc1
    v_mfma_f32_16x16x32_bf16 v[124:127], a[24:27], a[220:223], v[124:127]
    s_waitcnt lgkmcnt(6)
    v_mfma_f32_16x16x32_bf16 v[128:131], a[28:31], a[208:211], v[128:131]
    ds_read_b64_tr_b16 a[12:13], v229 offset:4096
    v_mfma_f32_16x16x32_bf16 v[132:135], a[28:31], a[212:215], v[132:135]
    ds_read_b64_tr_b16 a[14:15], v229 offset:4608
    v_mfma_f32_16x16x32_bf16 v[136:139], a[28:31], a[216:219], v[136:139]
    s_add_u32 s70, s70, 1024
    v_mfma_f32_16x16x32_bf16 v[140:143], a[28:31], a[220:223], v[140:143]
    s_waitcnt vmcnt(16)
    s_waitcnt lgkmcnt(6)
    v_mfma_f32_16x16x32_bf16 v[16:19], a[0:3], a[224:227], v[16:19]
    ds_read_b64_tr_b16 a[16:17], v228 offset:8192
    v_mfma_f32_16x16x32_bf16 v[20:23], a[0:3], a[228:231], v[20:23]
    ds_read_b64_tr_b16 a[18:19], v228 offset:8704
    v_mfma_f32_16x16x32_bf16 v[24:27], a[0:3], a[232:235], v[24:27]
    buffer_load_dwordx4 a[208:211], v224, s[8:11], s70 offen sc1
    v_mfma_f32_16x16x32_bf16 v[28:31], a[0:3], a[236:239], v[28:31]
    s_waitcnt lgkmcnt(6)
    v_mfma_f32_16x16x32_bf16 v[32:35], a[4:7], a[224:227], v[32:35]
    ds_read_b64_tr_b16 a[20:21], v229 offset:8192
    v_mfma_f32_16x16x32_bf16 v[36:39], a[4:7], a[228:231], v[36:39]
    ds_read_b64_tr_b16 a[22:23], v229 offset:8704
    v_mfma_f32_16x16x32_bf16 v[40:43], a[4:7], a[232:235], v[40:43]
    s_add_u32 m0, s89, 0
    s_nop 0
    buffer_load_dwordx4 v247, s[20:23], s71 offen offset:0 lds
    v_mfma_f32_16x16x32_bf16 v[44:47], a[4:7], a[236:239], v[44:47]
    s_waitcnt lgkmcnt(6)
    v_mfma_f32_16x16x32_bf16 v[48:51], a[8:11], a[224:227], v[48:51]
    ds_read_b64_tr_b16 a[24:25], v228 offset:12288
    v_mfma_f32_16x16x32_bf16 v[52:55], a[8:11], a[228:231], v[52:55]
    ds_read_b64_tr_b16 a[26:27], v228 offset:12800
    v_mfma_f32_16x16x32_bf16 v[56:59], a[8:11], a[232:235], v[56:59]
    buffer_load_dwordx4 a[212:215], v225, s[8:11], s70 offen sc1
    v_mfma_f32_16x16x32_bf16 v[60:63], a[8:11], a[236:239], v[60:63]
    s_waitcnt lgkmcnt(6)
    v_mfma_f32_16x16x32_bf16 v[64:67], a[12:15], a[224:227], v[64:67]
    ds_read_b64_tr_b16 a[28:29], v229 offset:12288
    v_mfma_f32_16x16x32_bf16 v[68:71], a[12:15], a[228:231], v[68:71]
    ds_read_b64_tr_b16 a[30:31], v229 offset:12800
    v_mfma_f32_16x16x32_bf16 v[72:75], a[12:15], a[232:235], v[72:75]
    s_add_u32 m0, s89, 4032
    s_nop 0
    buffer_load_dwordx4 v247, s[20:23], s71 offen offset:64 lds
    v_mfma_f32_16x16x32_bf16 v[76:79], a[12:15], a[236:239], v[76:79]
    s_waitcnt lgkmcnt(6)
    v_mfma_f32_16x16x32_bf16 v[80:83], a[16:19], a[224:227], v[80:83]
    ds_read_b64_tr_b16 a[0:1], v228 offset:2048
    v_mfma_f32_16x16x32_bf16 v[84:87], a[16:19], a[228:231], v[84:87]
    ds_read_b64_tr_b16 a[2:3], v228 offset:2560
    v_mfma_f32_16x16x32_bf16 v[88:91], a[16:19], a[232:235], v[88:91]
    buffer_load_dwordx4 a[216:219], v226, s[8:11], s70 offen sc1
    v_mfma_f32_16x16x32_bf16 v[92:95], a[16:19], a[236:239], v[92:95]
    s_waitcnt lgkmcnt(6)
    v_mfma_f32_16x16x32_bf16 v[96:99], a[20:23], a[224:227], v[96:99]
    ds_read_b64_tr_b16 a[4:5], v229 offset:2048
    v_mfma_f32_16x16x32_bf16 v[100:103], a[20:23], a[228:231], v[100:103]
    ds_read_b64_tr_b16 a[6:7], v229 offset:2560
    v_mfma_f32_16x16x32_bf16 v[104:107], a[20:23], a[232:235], v[104:107]
    s_add_u32 m0, s89, 8192
    s_nop 0
    buffer_load_dwordx4 v248, s[20:23], s71 offen offset:0 lds
    v_mfma_f32_16x16x32_bf16 v[108:111], a[20:23], a[236:239], v[108:111]
    s_waitcnt lgkmcnt(6)
    v_mfma_f32_16x16x32_bf16 v[112:115], a[24:27], a[224:227], v[112:115]
    ds_read_b64_tr_b16 a[8:9], v228 offset:6144
    v_mfma_f32_16x16x32_bf16 v[116:119], a[24:27], a[228:231], v[116:119]
    ds_read_b64_tr_b16 a[10:11], v228 offset:6656
    v_mfma_f32_16x16x32_bf16 v[120:123], a[24:27], a[232:235], v[120:123]
    buffer_load_dwordx4 a[220:223], v227, s[8:11], s70 offen sc1
    v_mfma_f32_16x16x32_bf16 v[124:127], a[24:27], a[236:239], v[124:127]
    s_waitcnt lgkmcnt(6)
    v_mfma_f32_16x16x32_bf16 v[128:131], a[28:31], a[224:227], v[128:131]
    ds_read_b64_tr_b16 a[12:13], v229 offset:6144
    v_mfma_f32_16x16x32_bf16 v[132:135], a[28:31], a[228:231], v[132:135]
    ds_read_b64_tr_b16 a[14:15], v229 offset:6656
    v_mfma_f32_16x16x32_bf16 v[136:139], a[28:31], a[232:235], v[136:139]
    s_add_u32 m0, s89, 12224
    s_nop 0
    buffer_load_dwordx4 v248, s[20:23], s71 offen offset:64 lds
    s_add_u32 s70, s70, 1024
    v_mfma_f32_16x16x32_bf16 v[140:143], a[28:31], a[236:239], v[140:143]
    s_waitcnt vmcnt(13)
    s_waitcnt lgkmcnt(6)
    v_mfma_f32_16x16x32_bf16 v[16:19], a[0:3], a[240:243], v[16:19]
    ds_read_b64_tr_b16 a[16:17], v228 offset:10240
    v_mfma_f32_16x16x32_bf16 v[20:23], a[0:3], a[244:247], v[20:23]
    ds_read_b64_tr_b16 a[18:19], v228 offset:10752
    v_mfma_f32_16x16x32_bf16 v[24:27], a[0:3], a[248:251], v[24:27]
    s_add_u32 s71, s71, 131072
    s_add_u32 s89, s89, 16384
    s_sub_u32 s39, s89, 65536
    s_cmp_ge_u32 s39, 98304
    s_cselect_b32 s39, 98304, 0
    s_sub_u32 s89, s89, s39
    buffer_load_dwordx4 a[224:227], v224, s[8:11], s70 offen sc1
    v_mfma_f32_16x16x32_bf16 v[28:31], a[0:3], a[252:255], v[28:31]
    s_waitcnt lgkmcnt(6)
    v_mfma_f32_16x16x32_bf16 v[32:35], a[4:7], a[240:243], v[32:35]
    ds_read_b64_tr_b16 a[20:21], v229 offset:10240
    v_mfma_f32_16x16x32_bf16 v[36:39], a[4:7], a[244:247], v[36:39]
    ds_read_b64_tr_b16 a[22:23], v229 offset:10752
    v_mfma_f32_16x16x32_bf16 v[40:43], a[4:7], a[248:251], v[40:43]
    v_mfma_f32_16x16x32_bf16 v[44:47], a[4:7], a[252:255], v[44:47]
    s_add_u32 s67, s67, 16384
    s_cmp_ge_u32 s67, 163840
    s_cselect_b32 s39, 98304, 0
    s_sub_u32 s67, s67, s39
    s_waitcnt lgkmcnt(6)
    v_mfma_f32_16x16x32_bf16 v[48:51], a[8:11], a[240:243], v[48:51]
    ds_read_b64_tr_b16 a[24:25], v228 offset:14336
    v_mfma_f32_16x16x32_bf16 v[52:55], a[8:11], a[244:247], v[52:55]
    ds_read_b64_tr_b16 a[26:27], v228 offset:14848
    v_mfma_f32_16x16x32_bf16 v[56:59], a[8:11], a[248:251], v[56:59]
    buffer_load_dwordx4 a[228:231], v225, s[8:11], s70 offen sc1
    v_mfma_f32_16x16x32_bf16 v[60:63], a[8:11], a[252:255], v[60:63]
    s_waitcnt lgkmcnt(6)
    v_mfma_f32_16x16x32_bf16 v[64:67], a[12:15], a[240:243], v[64:67]
    ds_read_b64_tr_b16 a[28:29], v229 offset:14336
    v_mfma_f32_16x16x32_bf16 v[68:71], a[12:15], a[244:247], v[68:71]
    ds_read_b64_tr_b16 a[30:31], v229 offset:14848
    v_mfma_f32_16x16x32_bf16 v[72:75], a[12:15], a[248:251], v[72:75]
    v_mfma_f32_16x16x32_bf16 v[76:79], a[12:15], a[252:255], v[76:79]
    s_barrier
    s_cmp_lg_u32 s3, 0
    s_cbranch_scc1 L_sig5
    v_mov_b32 v242, s61
    v_mov_b32 v243, 0
    s_mov_b64 exec, 1
    buffer_store_dword v242, v243, s[8:11], s59 offen sc1
    s_mov_b64 exec, -1
L_sig5:
    v_add_u32 v228, s67, v249
    v_add_u32 v229, s67, v250
    s_waitcnt lgkmcnt(6)
    v_mfma_f32_16x16x32_bf16 v[80:83], a[16:19], a[240:243], v[80:83]
    ds_read_b64_tr_b16 a[0:1], v228 offset:0
    v_mfma_f32_16x16x32_bf16 v[84:87], a[16:19], a[244:247], v[84:87]
    ds_read_b64_tr_b16 a[2:3], v228 offset:512
    v_mfma_f32_16x16x32_bf16 v[88:91], a[16:19], a[248:251], v[88:91]
    buffer_load_dwordx4 a[232:235], v226, s[8:11], s70 offen sc1
    v_mfma_f32_16x16x32_bf16 v[92:95], a[16:19], a[252:255], v[92:95]
    s_waitcnt lgkmcnt(6)
    v_mfma_f32_16x16x32_bf16 v[96:99], a[20:23], a[240:243], v[96:99]
    ds_read_b64_tr_b16 a[4:5], v229 offset:0
    v_mfma_f32_16x16x32_bf16 v[100:103], a[20:23], a[244:247], v[100:103]
    ds_read_b64_tr_b16 a[6:7], v229 offset:512
    v_mfma_f32_16x16x32_bf16 v[104:107], a[20:23], a[248:251], v[104:107]
    v_mfma_f32_16x16x32_bf16 v[108:111], a[20:23], a[252:255], v[108:111]
    s_waitcnt lgkmcnt(6)
    v_mfma_f32_16x16x32_bf16 v[112:115], a[24:27], a[240:243], v[112:115]
    ds_read_b64_tr_b16 a[8:9], v228 offset:4096
    v_mfma_f32_16x16x32_bf16 v[116:119], a[24:27], a[244:247], v[116:119]
    ds_read_b64_tr_b16 a[10:11], v228 offset:4608
    v_mfma_f32_16x16x32_bf16 v[120:123], a[24:27], a[248:251], v[120:123]
    buffer_load_dwordx4 a[236:239], v227, s[8:11], s70 offen sc1
    v_mfma_f32_16x16x32_bf16 v[124:127], a[24:27], a[252:255], v[124:127]
    s_waitcnt lgkmcnt(6)
    v_mfma_f32_16x16x32_bf16 v[128:131], a[28:31], a[240:243], v[128:131]
    ds_read_b64_tr_b16 a[12:13], v229 offset:4096
    v_mfma_f32_16x16x32_bf16 v[132:135], a[28:31], a[244:247], v[132:135]
    ds_read_b64_tr_b16 a[14:15], v229 offset:4608
    v_mfma_f32_16x16x32_bf16 v[136:139], a[28:31], a[248:251], v[136:139]
    s_add_u32 s70, s70, 1024
    v_mfma_f32_16x16x32_bf16 v[140:143], a[28:31], a[252:255], v[140:143]
    s_mov_b32 s33, 3
.p2align 4
L_W2_loop:
    s_waitcnt vmcnt(12)
    s_waitcnt lgkmcnt(6)
    v_mfma_f32_16x16x32_bf16 v[16:19], a[0:3], a[192:195], v[16:19]
    ds_read_b64_tr_b16 a[16:17], v228 offset:8192
    v_mfma_f32_16x16x32_bf16 v[20:23], a[0:3], a[196:199], v[20:23]
    ds_read_b64_tr_b16 a[18:19], v228 offset:8704
    v_mfma_f32_16x16x32_bf16 v[24:27], a[0:3], a[200:203], v[24:27]
    buffer_load_dwordx4 a[240:243], v224, s[8:11], s70 offen sc1
    v_mfma_f32_16x16x32_bf16 v[28:31], a[0:3], a[204:207], v[28:31]
    s_waitcnt lgkmcnt(6)
    v_mfma_f32_16x16x32_bf16 v[32:35], a[4:7], a[192:195], v[32:35]
    ds_read_b64_tr_b16 a[20:21], v229 offset:8192
    v_mfma_f32_16x16x32_bf16 v[36:39], a[4:7], a[196:199], v[36:39]
    ds_read_b64_tr_b16 a[22:23], v229 offset:8704
    v_mfma_f32_16x16x32_bf16 v[40:43], a[4:7], a[200:203], v[40:43]
    s_add_u32 m0, s89, 0
    s_nop 0
    buffer_load_dwordx4 v247, s[20:23], s71 offen offset:0 lds
    v_mfma_f32_16x16x32_bf16 v[44:47], a[4:7], a[204:207], v[44:47]
    s_waitcnt lgkmcnt(6)
    v_mfma_f32_16x16x32_bf16 v[48:51], a[8:11], a[192:195], v[48:51]
    ds_read_b64_tr_b16 a[24:25], v228 offset:12288
    v_mfma_f32_16x16x32_bf16 v[52:55], a[8:11], a[196:199], v[52:55]
    ds_read_b64_tr_b16 a[26:27], v228 offset:12800
    v_mfma_f32_16x16x32_bf16 v[56:59], a[8:11], a[200:203], v[56:59]
    buffer_load_dwordx4 a[244:247], v225, s[8:11], s70 offen sc1
    v_mfma_f32_16x16x32_bf16 v[60:63], a[8:11], a[204:207], v[60:63]
    s_waitcnt lgkmcnt(6)
    v_mfma_f32_16x16x32_bf16 v[64:67], a[12:15], a[192:195], v[64:67]
    ds_read_b64_tr_b16 a[28:29], v229 offset:12288
    v_mfma_f32_16x16x32_bf16 v[68:71], a[12:15], a[196:199], v[68:71]
    ds_read_b64_tr_b16 a[30:31], v229 offset:12800
    v_mfma_f32_16x16x32_bf16 v[72:75], a[12:15], a[200:203], v[72:75]
    s_add_u32 m0, s89, 4032
    s_nop 0
    buffer_load_dwordx4 v247, s[20:23], s71 offen offset:64 lds
    v_mfma_f32_16x16x32_bf16 v[76:79], a[12:15], a[204:207], v[76:79]
    s_waitcnt lgkmcnt(6)
    v_mfma_f32_16x16x32_bf16 v[80:83], a[16:19], a[192:195], v[80:83]
    ds_read_b64_tr_b16 a[0:1], v228 offset:2048
    v_mfma_f32_16x16x32_bf16 v[84:87], a[16:19], a[196:199], v[84:87]
    ds_read_b64_tr_b16 a[2:3], v228 offset:2560
    v_mfma_f32_16x16x32_bf16 v[88:91], a[16:19], a[200:203], v[88:91]
    buffer_load_dwordx4 a[248:251], v226, s[8:11], s70 offen sc1
    v_mfma_f32_16x16x32_bf16 v[92:95], a[16:19], a[204:207], v[92:95]
    s_waitcnt lgkmcnt(6)
    v_mfma_f32_16x16x32_bf16 v[96:99], a[20:23], a[192:195], v[96:99]
    ds_read_b64_tr_b16 a[4:5], v229 offset:2048
    v_mfma_f32_16x16x32_bf16 v[100:103], a[20:23], a[196:199], v[100:103]
    ds_read_b64_tr_b16 a[6:7], v229 offset:2560
    v_mfma_f32_16x16x32_bf16 v[104:107], a[20:23], a[200:203], v[104:107]
    s_add_u32 m0, s89, 8192
    s_nop 0
    buffer_load_dwordx4 v248, s[20:23], s71 offen offset:0 lds
    v_mfma_f32_16x16x32_bf16 v[108:111], a[20:23], a[204:207], v[108:111]
    s_waitcnt lgkmcnt(6)
    v_mfma_f32_16x16x32_bf16 v[112:115], a[24:27], a[192:195], v[112:115]
    ds_read_b64_tr_b16 a[8:9], v228 offset:6144
    v_mfma_f32_16x16x32_bf16 v[116:119], a[24:27], a[196:199], v[116:119]
    ds_read_b64_tr_b16 a[10:11], v228 offset:6656
    v_mfma_f32_16x16x32_bf16 v[120:123], a[24:27], a[200:203], v[120:123]
    buffer_load_dwordx4 a[252:255], v227, s[8:11], s70 offen sc1
    v_mfma_f32_16x16x32_bf16 v[124:127], a[24:27], a[204:207], v[124:127]
    s_waitcnt lgkmcnt(6)
    v_mfma_f32_16x16x32_bf16 v[128:131], a[28:31], a[192:195], v[128:131]
    ds_read_b64_tr_b16 a[12:13], v229 offset:6144
    v_mfma_f32_16x16x32_bf16 v[132:135], a[28:31], a[196:199], v[132:135]
    ds_read_b64_tr_b16 a[14:15], v229 offset:6656
    v_mfma_f32_16x16x32_bf16 v[136:139], a[28:31], a[200:203], v[136:139]
    s_add_u32 m0, s89, 12224
    s_nop 0
    buffer_load_dwordx4 v248, s[20:23], s71 offen offset:64 lds
    s_add_u32 s70, s70, 1024
    v_mfma_f32_16x16x32_bf16 v[140:143], a[28:31], a[204:207], v[140:143]
    s_waitcnt vmcnt(13)
    s_waitcnt lgkmcnt(6)
    v_mfma_f32_16x16x32_bf16 v[16:19], a[0:3], a[208:211], v[16:19]
    ds_read_b64_tr_b16 a[16:17], v228 offset:10240
    v_mfma_f32_16x16x32_bf16 v[20:23], a[0:3], a[212:215], v[20:23]
    ds_read_b64_tr_b16 a[18:19], v228 offset:10752
    v_mfma_f32_16x16x32_bf16 v[24:27], a[0:3], a[216:219], v[24:27]
    s_add_u32 s71, s71, 131072
    s_add_u32 s89, s89, 16384
    s_sub_u32 s39, s89, 65536
    s_cmp_ge_u32 s39, 98304
    s_cselect_b32 s39, 98304, 0
    s_sub_u32 s89, s89, s39
    buffer_load_dwordx4 a[192:195], v224, s[8:11], s70 offen sc1
    v_mfma_f32_16x16x32_bf16 v[28:31], a[0:3], a[220:223], v[28:31]
    s_waitcnt lgkmcnt(6)
    v_mfma_f32_16x16x32_bf16 v[32:35], a[4:7], a[208:211], v[32:35]
    ds_read_b64_tr_b16 a[20:21], v229 offset:10240
    v_mfma_f32_16x16x32_bf16 v[36:39], a[4:7], a[212:215], v[36:39]
    ds_read_b64_tr_b16 a[22:23], v229 offset:10752
    v_mfma_f32_16x16x32_bf16 v[40:43], a[4:7], a[216:219], v[40:43]
    v_mfma_f32_16x16x32_bf16 v[44:47], a[4:7], a[220:223], v[44:47]
    s_add_u32 s67, s67, 16384
    s_cmp_ge_u32 s67, 163840
    s_cselect_b32 s39, 98304, 0
    s_sub_u32 s67, s67, s39
    s_waitcnt lgkmcnt(6)
    v_mfma_f32_16x16x32_bf16 v[48:51], a[8:11], a[208:211], v[48:51]
    ds_read_b64_tr_b16 a[24:25], v228 offset:14336
    v_mfma_f32_16x16x32_bf16 v[52:55], a[8:11], a[212:215], v[52:55]
    ds_read_b64_tr_b16 a[26:27], v228 offset:14848
    v_mfma_f32_16x16x32_bf16 v[56:59], a[8:11], a[216:219], v[56:59]
    buffer_load_dwordx4 a[196:199], v225, s[8:11], s70 offen sc1
    v_mfma_f32_16x16x32_bf16 v[60:63], a[8:11], a[220:223], v[60:63]
    s_waitcnt lgkmcnt(6)
    v_mfma_f32_16x16x32_bf16 v[64:67], a[12:15], a[208:211], v[64:67]
    ds_read_b64_tr_b16 a[28:29], v229 offset:14336
    v_mfma_f32_16x16x32_bf16 v[68:71], a[12:15], a[212:215], v[68:71]
    ds_read_b64_tr_b16 a[30:31], v229 offset:14848
    v_mfma_f32_16x16x32_bf16 v[72:75], a[12:15], a[216:219], v[72:75]
    v_mfma_f32_16x16x32_bf16 v[76:79], a[12:15], a[220:223], v[76:79]
    s_barrier
    v_add_u32 v228, s67, v249
    v_add_u32 v229, s67, v250
    s_waitcnt lgkmcnt(6)
    v_mfma_f32_16x16x32_bf16 v[80:83], a[16:19], a[208:211], v[80:83]
    ds_read_b64_tr_b16 a[0:1], v228 offset:0
    v_mfma_f32_16x16x32_bf16 v[84:87], a[16:19], a[212:215], v[84:87]
    ds_read_b64_tr_b16 a[2:3], v228 offset:512
    v_mfma_f32_16x16x32_bf16 v[88:91], a[16:19], a[216:219], v[88:91]
    buffer_load_dwordx4 a[200:203], v226, s[8:11], s70 offen sc1
    v_mfma_f32_16x16x32_bf16 v[92:95], a[16:19], a[220:223], v[92:95]
    s_waitcnt lgkmcnt(6)
    v_mfma_f32_16x16x32_bf16 v[96:99], a[20:23], a[208:211], v[96:99]
    ds_read_b64_tr_b16 a[4:5], v229 offset:0
    v_mfma_f32_16x16x32_bf16 v[100:103], a[20:23], a[212:215], v[100:103]
    ds_read_b64_tr_b16 a[6:7], v229 offset:512
    v_mfma_f32_16x16x32_bf16 v[104:107], a[20:23], a[216:219], v[104:107]
    v_mfma_f32_16x16x32_bf16 v[108:111], a[20:23], a[220:223], v[108:111]
    s_waitcnt lgkmcnt(6)
    v_mfma_f32_16x16x32_bf16 v[112:115], a[24:27], a[208:211], v[112:115]
    ds_read_b64_tr_b16 a[8:9], v228 offset:4096
    v_mfma_f32_16x16x32_bf16 v[116:119], a[24:27], a[212:215], v[116:119]
    ds_read_b64_tr_b16 a[10:11], v228 offset:4608
    v_mfma_f32_16x16x32_bf16 v[120:123], a[24:27], a[216:219], v[120:123]
    buffer_load_dwordx4 a[204:207], v227, s[8:11], s70 offen sc1
    v_mfma_f32_16x16x32_bf16 v[124:127], a[24:27], a[220:223], v[124:127]
    s_waitcnt lgkmcnt(6)
    v_mfma_f32_16x16x32_bf16 v[128:131], a[28:31], a[208:211], v[128:131]
    ds_read_b64_tr_b16 a[12:13], v229 offset:4096
    v_mfma_f32_16x16x32_bf16 v[132:135], a[28:31], a[212:215], v[132:135]
    ds_read_b64_tr_b16 a[14:15], v229 offset:4608
    v_mfma_f32_16x16x32_bf16 v[136:139], a[28:31], a[216:219], v[136:139]
    s_add_u32 s70, s70, 1024
    v_mfma_f32_16x16x32_bf16 v[140:143], a[28:31], a[220:223], v[140:143]
    s_waitcnt vmcnt(12)
    s_waitcnt lgkmcnt(6)
    v_mfma_f32_16x16x32_bf16 v[16:19], a[0:3], a[224:227], v[16:19]
    ds_read_b64_tr_b16 a[16:17], v228 offset:8192
    v_mfma_f32_16x16x32_bf16 v[20:23], a[0:3], a[228:231], v[20:23]
    ds_read_b64_tr_b16 a[18:19], v228 offset:8704
    v_mfma_f32_16x16x32_bf16 v[24:27], a[0:3], a[232:235], v[24:27]
    buffer_load_dwordx4 a[208:211], v224, s[8:11], s70 offen sc1
    v_mfma_f32_16x16x32_bf16 v[28:31], a[0:3], a[236:239], v[28:31]
    s_waitcnt lgkmcnt(6)
    v_mfma_f32_16x16x32_bf16 v[32:35], a[4:7], a[224:227], v[32:35]
    ds_read_b64_tr_b16 a[20:21], v229 offset:8192
    v_mfma_f32_16x16x32_bf16 v[36:39], a[4:7], a[228:231], v[36:39]
    ds_read_b64_tr_b16 a[22:23], v229 offset:8704
    v_mfma_f32_16x16x32_bf16 v[40:43], a[4:7], a[232:235], v[40:43]
    s_add_u32 m0, s89, 0
    s_nop 0
    buffer_load_dwordx4 v247, s[20:23], s71 offen offset:0 lds
    v_mfma_f32_16x16x32_bf16 v[44:47], a[4:7], a[236:239], v[44:47]
    s_waitcnt lgkmcnt(6)
    v_mfma_f32_16x16x32_bf16 v[48:51], a[8:11], a[224:227], v[48:51]
    ds_read_b64_tr_b16 a[24:25], v228 offset:12288
    v_mfma_f32_16x16x32_bf16 v[52:55], a[8:11], a[228:231], v[52:55]
    ds_read_b64_tr_b16 a[26:27], v228 offset:12800
    v_mfma_f32_16x16x32_bf16 v[56:59], a[8:11], a[232:235], v[56:59]
    buffer_load_dwordx4 a[212:215], v225, s[8:11], s70 offen sc1
    v_mfma_f32_16x16x32_bf16 v[60:63], a[8:11], a[236:239], v[60:63]
    s_waitcnt lgkmcnt(6)
    v_mfma_f32_16x16x32_bf16 v[64:67], a[12:15], a[224:227], v[64:67]
    ds_read_b64_tr_b16 a[28:29], v229 offset:12288
    v_mfma_f32_16x16x32_bf16 v[68:71], a[12:15], a[228:231], v[68:71]
    ds_read_b64_tr_b16 a[30:31], v229 offset:12800
    v_mfma_f32_16x16x32_bf16 v[72:75], a[12:15], a[232:235], v[72:75]
    s_add_u32 m0, s89, 4032
    s_nop 0
    buffer_load_dwordx4 v247, s[20:23], s71 offen offset:64 lds
    v_mfma_f32_16x16x32_bf16 v[76:79], a[12:15], a[236:239], v[76:79]
    s_waitcnt lgkmcnt(6)
    v_mfma_f32_16x16x32_bf16 v[80:83], a[16:19], a[224:227], v[80:83]
    ds_read_b64_tr_b16 a[0:1], v228 offset:2048
    v_mfma_f32_16x16x32_bf16 v[84:87], a[16:19], a[228:231], v[84:87]
    ds_read_b64_tr_b16 a[2:3], v228 offset:2560
    v_mfma_f32_16x16x32_bf16 v[88:91], a[16:19], a[232:235], v[88:91]
    buffer_load_dwordx4 a[216:219], v226, s[8:11], s70 offen sc1
    v_mfma_f32_16x16x32_bf16 v[92:95], a[16:19], a[236:239], v[92:95]
    s_waitcnt lgkmcnt(6)
    v_mfma_f32_16x16x32_bf16 v[96:99], a[20:23], a[224:227], v[96:99]
    ds_read_b64_tr_b16 a[4:5], v229 offset:2048
    v_mfma_f32_16x16x32_bf16 v[100:103], a[20:23], a[228:231], v[100:103]
    ds_read_b64_tr_b16 a[6:7], v229 offset:2560
    v_mfma_f32_16x16x32_bf16 v[104:107], a[20:23], a[232:235], v[104:107]
    s_add_u32 m0, s89, 8192
    s_nop 0
    buffer_load_dwordx4 v248, s[20:23], s71 offen offset:0 lds
    v_mfma_f32_16x16x32_bf16 v[108:111], a[20:23], a[236:239], v[108:111]
    s_waitcnt lgkmcnt(6)
    v_mfma_f32_16x16x32_bf16 v[112:115], a[24:27], a[224:227], v[112:115]
    ds_read_b64_tr_b16 a[8:9], v228 offset:6144
    v_mfma_f32_16x16x32_bf16 v[116:119], a[24:27], a[228:231], v[116:119]
    ds_read_b64_tr_b16 a[10:11], v228 offset:6656
    v_mfma_f32_16x16x32_bf16 v[120:123], a[24:27], a[232:235], v[120:123]
    buffer_load_dwordx4 a[220:223], v227, s[8:11], s70 offen sc1
    v_mfma_f32_16x16x32_bf16 v[124:127], a[24:27], a[236:239], v[124:127]
    s_waitcnt lgkmcnt(6)
    v_mfma_f32_16x16x32_bf16 v[128:131], a[28:31], a[224:227], v[128:131]
    ds_read_b64_tr_b16 a[12:13], v229 offset:6144
    v_mfma_f32_16x16x32_bf16 v[132:135], a[28:31], a[228:231], v[132:135]
    ds_read_b64_tr_b16 a[14:15], v229 offset:6656
    v_mfma_f32_16x16x32_bf16 v[136:139], a[28:31], a[232:235], v[136:139]
    s_add_u32 m0, s89, 12224
    s_nop 0
    buffer_load_dwordx4 v248, s[20:23], s71 offen offset:64 lds
    s_add_u32 s70, s70, 1024
    v_mfma_f32_16x16x32_bf16 v[140:143], a[28:31], a[236:239], v[140:143]
L_pad_11:
    s_cbranch_execz L_pad_14
    s_waitcnt vmcnt(13)
    s_waitcnt lgkmcnt(6)
    v_mfma_f32_16x16x32_bf16 v[16:19], a[0:3], a[240:243], v[16:19]
    ds_read_b64_tr_b16 a[16:17], v228 offset:10240
    v_mfma_f32_16x16x32_bf16 v[20:23], a[0:3], a[244:247], v[20:23]
    ds_read_b64_tr_b16 a[18:19], v228 offset:10752
    v_mfma_f32_16x16x32_bf16 v[24:27], a[0:3], a[248:251], v[24:27]
    s_add_u32 s71, s71, 131072
    s_add_u32 s89, s89, 16384
    s_sub_u32 s39, s89, 65536
    s_cmp_ge_u32 s39, 98304
    s_cselect_b32 s39, 98304, 0
    s_sub_u32 s89, s89, s39
    buffer_load_dwordx4 a[224:227], v224, s[8:11], s70 offen sc1
    v_mfma_f32_16x16x32_bf16 v[28:31], a[0:3], a[252:255], v[28:31]
    s_waitcnt lgkmcnt(6)
    v_mfma_f32_16x16x32_bf16 v[32:35], a[4:7], a[240:243], v[32:35]
    ds_read_b64_tr_b16 a[20:21], v229 offset:10240
    v_mfma_f32_16x16x32_bf16 v[36:39], a[4:7], a[244:247], v[36:39]
    ds_read_b64_tr_b16 a[22:23], v229 offset:10752
    v_mfma_f32_16x16x32_bf16 v[40:43], a[4:7], a[248:251], v[40:43]
    v_mfma_f32_16x16x32_bf16 v[44:47], a[4:7], a[252:255], v[44:47]
    s_add_u32 s67, s67, 16384
    s_cmp_ge_u32 s67, 163840
    s_cselect_b32 s39, 98304, 0
    s_sub_u32 s67, s67, s39
    s_waitcnt lgkmcnt(6)
    v_mfma_f32_16x16x32_bf16 v[48:51], a[8:11], a[240:243], v[48:51]
    ds_read_b64_tr_b16 a[24:25], v228 offset:14336
    v_mfma_f32_16x16x32_bf16 v[52:55], a[8:11], a[244:247], v[52:55]
    ds_read_b64_tr_b16 a[26:27], v228 offset:14848
    v_mfma_f32_16x16x32_bf16 v[56:59], a[8:11], a[248:251], v[56:59]
    buffer_load_dwordx4 a[228:231], v225, s[8:11], s70 offen sc1
    v_mfma_f32_16x16x32_bf16 v[60:63], a[8:11], a[252:255], v[60:63]
    s_waitcnt lgkmcnt(6)
    v_mfma_f32_16x16x32_bf16 v[64:67], a[12:15], a[240:243], v[64:67]
    ds_read_b64_tr_b16 a[28:29], v229 offset:14336
    v_mfma_f32_16x16x32_bf16 v[68:71], a[12:15], a[244:247], v[68:71]
    ds_read_b64_tr_b16 a[30:31], v229 offset:14848
    v_mfma_f32_16x16x32_bf16 v[72:75], a[12:15], a[248:251], v[72:75]
    v_mfma_f32_16x16x32_bf16 v[76:79], a[12:15], a[252:255], v[76:79]
    s_barrier
    v_add_u32 v228, s67, v249
    v_add_u32 v229, s67, v250
    s_waitcnt lgkmcnt(6)
    v_mfma_f32_16x16x32_bf16 v[80:83], a[16:19], a[240:243], v[80:83]
    ds_read_b64_tr_b16 a[0:1], v228 offset:0
    v_mfma_f32_16x16x32_bf16 v[84:87], a[16:19], a[244:247], v[84:87]
    ds_read_b64_tr_b16 a[2:3], v228 offset:512
    v_mfma_f32_16x16x32_bf16 v[88:91], a[16:19], a[248:251], v[88:91]
    buffer_load_dwordx4 a[232:235], v226, s[8:11], s70 offen sc1
    v_mfma_f32_16x16x32_bf16 v[92:95], a[16:19], a[252:255], v[92:95]
    s_waitcnt lgkmcnt(6)
    v_mfma_f32_16x16x32_bf16 v[96:99], a[20:23], a[240:243], v[96:99]
    ds_read_b64_tr_b16 a[4:5], v229 offset:0
    v_mfma_f32_16x16x32_bf16 v[100:103], a[20:23], a[244:247], v[100:103]
    ds_read_b64_tr_b16 a[6:7], v229 offset:512
    v_mfma_f32_16x16x32_bf16 v[104:107], a[20:23], a[248:251], v[104:107]
    v_mfma_f32_16x16x32_bf16 v[108:111], a[20:23], a[252:255], v[108:111]
    s_waitcnt lgkmcnt(6)
    v_mfma_f32_16x16x32_bf16 v[112:115], a[24:27], a[240:243], v[112:115]
    ds_read_b64_tr_b16 a[8:9], v228 offset:4096
    v_mfma_f32_16x16x32_bf16 v[116:119], a[24:27], a[244:247], v[116:119]
    ds_read_b64_tr_b16 a[10:11], v228 offset:4608
    v_mfma_f32_16x16x32_bf16 v[120:123], a[24:27], a[248:251], v[120:123]
    buffer_load_dwordx4 a[236:239], v227, s[8:11], s70 offen sc1
    v_mfma_f32_16x16x32_bf16 v[124:127], a[24:27], a[252:255], v[124:127]
    s_waitcnt lgkmcnt(6)
    v_mfma_f32_16x16x32_bf16 v[128:131], a[28:31], a[240:243], v[128:131]
    ds_read_b64_tr_b16 a[12:13], v229 offset:4096
    v_mfma_f32_16x16x32_bf16 v[132:135], a[28:31], a[244:247], v[132:135]
    ds_read_b64_tr_b16 a[14:15], v229 offset:4608
    v_mfma_f32_16x16x32_bf16 v[136:139], a[28:31], a[248:251], v[136:139]
    s_add_u32 s70, s70, 1024
    v_mfma_f32_16x16x32_bf16 v[140:143], a[28:31], a[252:255], v[140:143]
    s_sub_u32 s33, s33, 1
    s_cmp_lg_u32 s33, 0
    s_cbranch_scc1 L_W2_loop
    s_waitcnt vmcnt(12)
    s_waitcnt lgkmcnt(6)
    v_mfma_f32_16x16x32_bf16 v[16:19], a[0:3], a[192:195], v[16:19]
    ds_read_b64_tr_b16 a[16:17], v228 offset:8192
    v_mfma_f32_16x16x32_bf16 v[20:23], a[0:3], a[196:199], v[20:23]
    ds_read_b64_tr_b16 a[18:19], v228 offset:8704
    v_mfma_f32_16x16x32_bf16 v[24:27], a[0:3], a[200:203], v[24:27]
    buffer_load_dwordx4 a[240:243], v224, s[8:11], s70 offen sc1
    v_mfma_f32_16x16x32_bf16 v[28:31], a[0:3], a[204:207], v[28:31]
    s_waitcnt lgkmcnt(6)
    v_mfma_f32_16x16x32_bf16 v[32:35], a[4:7], a[192:195], v[32:35]
    ds_read_b64_tr_b16 a[20:21], v229 offset:8192
    v_mfma_f32_16x16x32_bf16 v[36:39], a[4:7], a[196:199], v[36:39]
    ds_read_b64_tr_b16 a[22:23], v229 offset:8704
    v_mfma_f32_16x16x32_bf16 v[40:43], a[4:7], a[200:203], v[40:43]
    s_add_u32 m0, s89, 0
    s_nop 0
    buffer_load_dwordx4 v247, s[20:23], s71 offen offset:0 lds
    v_mfma_f32_16x16x32_bf16 v[44:47], a[4:7], a[204:207], v[44:47]
    s_waitcnt lgkmcnt(6)
    v_mfma_f32_16x16x32_bf16 v[48:51], a[8:11], a[192:195], v[48:51]
    ds_read_b64_tr_b16 a[24:25], v228 offset:12288
    v_mfma_f32_16x16x32_bf16 v[52:55], a[8:11], a[196:199], v[52:55]
    ds_read_b64_tr_b16 a[26:27], v228 offset:12800
    v_mfma_f32_16x16x32_bf16 v[56:59], a[8:11], a[200:203], v[56:59]
    buffer_load_dwordx4 a[244:247], v225, s[8:11], s70 offen sc1
    v_mfma_f32_16x16x32_bf16 v[60:63], a[8:11], a[204:207], v[60:63]
    s_waitcnt lgkmcnt(6)
    v_mfma_f32_16x16x32_bf16 v[64:67], a[12:15], a[192:195], v[64:67]
    ds_read_b64_tr_b16 a[28:29], v229 offset:12288
    v_mfma_f32_16x16x32_bf16 v[68:71], a[12:15], a[196:199], v[68:71]
    ds_read_b64_tr_b16 a[30:31], v229 offset:12800
    v_mfma_f32_16x16x32_bf16 v[72:75], a[12:15], a[200:203], v[72:75]
    s_add_u32 m0, s89, 4032
    s_nop 0
    buffer_load_dwordx4 v247, s[20:23], s71 offen offset:64 lds
    v_mfma_f32_16x16x32_bf16 v[76:79], a[12:15], a[204:207], v[76:79]
    s_waitcnt lgkmcnt(6)
    v_mfma_f32_16x16x32_bf16 v[80:83], a[16:19], a[192:195], v[80:83]
    ds_read_b64_tr_b16 a[0:1], v228 offset:2048
    v_mfma_f32_16x16x32_bf16 v[84:87], a[16:19], a[196:199], v[84:87]
    ds_read_b64_tr_b16 a[2:3], v228 offset:2560
    v_mfma_f32_16x16x32_bf16 v[88:91], a[16:19], a[200:203], v[88:91]
    buffer_load_dwordx4 a[248:251], v226, s[8:11], s70 offen sc1
    v_mfma_f32_16x16x32_bf16 v[92:95], a[16:19], a[204:207], v[92:95]
    s_waitcnt lgkmcnt(6)
    v_mfma_f32_16x16x32_bf16 v[96:99], a[20:23], a[192:195], v[96:99]
    ds_read_b64_tr_b16 a[4:5], v229 offset:2048
    v_mfma_f32_16x16x32_bf16 v[100:103], a[20:23], a[196:199], v[100:103]
    ds_read_b64_tr_b16 a[6:7], v229 offset:2560
    v_mfma_f32_16x16x32_bf16 v[104:107], a[20:23], a[200:203], v[104:107]
    s_add_u32 m0, s89, 8192
    s_nop 0
    buffer_load_dwordx4 v248, s[20:23], s71 offen offset:0 lds
    v_mfma_f32_16x16x32_bf16 v[108:111], a[20:23], a[204:207], v[108:111]
    s_waitcnt lgkmcnt(6)
    v_mfma_f32_16x16x32_bf16 v[112:115], a[24:27], a[192:195], v[112:115]
    ds_read_b64_tr_b16 a[8:9], v228 offset:6144
    v_mfma_f32_16x16x32_bf16 v[116:119], a[24:27], a[196:199], v[116:119]
    ds_read_b64_tr_b16 a[10:11], v228 offset:6656
    v_mfma_f32_16x16x32_bf16 v[120:123], a[24:27], a[200:203], v[120:123]
    buffer_load_dwordx4 a[252:255], v227, s[8:11], s70 offen sc1
    v_mfma_f32_16x16x32_bf16 v[124:127], a[24:27], a[204:207], v[124:127]
    s_waitcnt lgkmcnt(6)
    v_mfma_f32_16x16x32_bf16 v[128:131], a[28:31], a[192:195], v[128:131]
    ds_read_b64_tr_b16 a[12:13], v229 offset:6144
    v_mfma_f32_16x16x32_bf16 v[132:135], a[28:31], a[196:199], v[132:135]
    ds_read_b64_tr_b16 a[14:15], v229 offset:6656
    v_mfma_f32_16x16x32_bf16 v[136:139], a[28:31], a[200:203], v[136:139]
    s_add_u32 m0, s89, 12224
    s_nop 0
    buffer_load_dwordx4 v248, s[20:23], s71 offen offset:64 lds
    s_add_u32 s70, s70, 1024
    v_mfma_f32_16x16x32_bf16 v[140:143], a[28:31], a[204:207], v[140:143]
    s_waitcnt vmcnt(13)
    s_waitcnt lgkmcnt(6)
    v_mfma_f32_16x16x32_bf16 v[16:19], a[0:3], a[208:211], v[16:19]
    ds_read_b64_tr_b16 a[16:17], v228 offset:10240
    v_mfma_f32_16x16x32_bf16 v[20:23], a[0:3], a[212:215], v[20:23]
    ds_read_b64_tr_b16 a[18:19], v228 offset:10752
    v_mfma_f32_16x16x32_bf16 v[24:27], a[0:3], a[216:219], v[24:27]
    s_add_u32 s71, s71, 131072
    s_add_u32 s89, s89, 16384
    s_sub_u32 s39, s89, 65536
    s_cmp_ge_u32 s39, 98304
    s_cselect_b32 s39, 98304, 0
    s_sub_u32 s89, s89, s39
    buffer_load_dwordx4 a[192:195], v224, s[8:11], s70 offen sc1
    v_mfma_f32_16x16x32_bf16 v[28:31], a[0:3], a[220:223], v[28:31]
    s_waitcnt lgkmcnt(6)
    v_mfma_f32_16x16x32_bf16 v[32:35], a[4:7], a[208:211], v[32:35]
    ds_read_b64_tr_b16 a[20:21], v229 offset:10240
    v_mfma_f32_16x16x32_bf16 v[36:39], a[4:7], a[212:215], v[36:39]
    ds_read_b64_tr_b16 a[22:23], v229 offset:10752
    v_mfma_f32_16x16x32_bf16 v[40:43], a[4:7], a[216:219], v[40:43]
    v_mfma_f32_16x16x32_bf16 v[44:47], a[4:7], a[220:223], v[44:47]
    s_add_u32 s67, s67, 16384
    s_cmp_ge_u32 s67, 163840
    s_cselect_b32 s39, 98304, 0
    s_sub_u32 s67, s67, s39
    s_waitcnt lgkmcnt(6)
    v_mfma_f32_16x16x32_bf16 v[48:51], a[8:11], a[208:211], v[48:51]
    ds_read_b64_tr_b16 a[24:25], v228 offset:14336
    v_mfma_f32_16x16x32_bf16 v[52:55], a[8:11], a[212:215], v[52:55]
    ds_read_b64_tr_b16 a[26:27], v228 offset:14848
    v_mfma_f32_16x16x32_bf16 v[56:59], a[8:11], a[216:219], v[56:59]
    buffer_load_dwordx4 a[196:199], v225, s[8:11], s70 offen sc1
    v_mfma_f32_16x16x32_bf16 v[60:63], a[8:11], a[220:223], v[60:63]
    s_waitcnt lgkmcnt(6)
    v_mfma_f32_16x16x32_bf16 v[64:67], a[12:15], a[208:211], v[64:67]
    ds_read_b64_tr_b16 a[28:29], v229 offset:14336
    v_mfma_f32_16x16x32_bf16 v[68:71], a[12:15], a[212:215], v[68:71]
    ds_read_b64_tr_b16 a[30:31], v229 offset:14848
    v_mfma_f32_16x16x32_bf16 v[72:75], a[12:15], a[216:219], v[72:75]
    v_mfma_f32_16x16x32_bf16 v[76:79], a[12:15], a[220:223], v[76:79]
    s_barrier
    v_add_u32 v228, s67, v249
    v_add_u32 v229, s67, v250
    s_waitcnt lgkmcnt(6)
    v_mfma_f32_16x16x32_bf16 v[80:83], a[16:19], a[208:211], v[80:83]
    ds_read_b64_tr_b16 a[0:1], v228 offset:0
    v_mfma_f32_16x16x32_bf16 v[84:87], a[16:19], a[212:215], v[84:87]
    ds_read_b64_tr_b16 a[2:3], v228 offset:512
    v_mfma_f32_16x16x32_bf16 v[88:91], a[16:19], a[216:219], v[88:91]
    buffer_load_dwordx4 a[200:203], v226, s[8:11], s70 offen sc1
    v_mfma_f32_16x16x32_bf16 v[92:95], a[16:19], a[220:223], v[92:95]
    s_waitcnt lgkmcnt(6)
    v_mfma_f32_16x16x32_bf16 v[96:99], a[20:23], a[208:211], v[96:99]
    ds_read_b64_tr_b16 a[4:5], v229 offset:0
    v_mfma_f32_16x16x32_bf16 v[100:103], a[20:23], a[212:215], v[100:103]
    ds_read_b64_tr_b16 a[6:7], v229 offset:512
    v_mfma_f32_16x16x32_bf16 v[104:107], a[20:23], a[216:219], v[104:107]
    v_mfma_f32_16x16x32_bf16 v[108:111], a[20:23], a[220:223], v[108:111]
    s_waitcnt lgkmcnt(6)
    v_mfma_f32_16x16x32_bf16 v[112:115], a[24:27], a[208:211], v[112:115]
    ds_read_b64_tr_b16 a[8:9], v228 offset:4096
    v_mfma_f32_16x16x32_bf16 v[116:119], a[24:27], a[212:215], v[116:119]
    ds_read_b64_tr_b16 a[10:11], v228 offset:4608
    v_mfma_f32_16x16x32_bf16 v[120:123], a[24:27], a[216:219], v[120:123]
    buffer_load_dwordx4 a[204:207], v227, s[8:11], s70 offen sc1
    v_mfma_f32_16x16x32_bf16 v[124:127], a[24:27], a[220:223], v[124:127]
    s_waitcnt lgkmcnt(6)
    v_mfma_f32_16x16x32_bf16 v[128:131], a[28:31], a[208:211], v[128:131]
    ds_read_b64_tr_b16 a[12:13], v229 offset:4096
    v_mfma_f32_16x16x32_bf16 v[132:135], a[28:31], a[212:215], v[132:135]
    ds_read_b64_tr_b16 a[14:15], v229 offset:4608
    v_mfma_f32_16x16x32_bf16 v[136:139], a[28:31], a[216:219], v[136:139]
    s_add_u32 s70, s70, 1024
    v_mfma_f32_16x16x32_bf16 v[140:143], a[28:31], a[220:223], v[140:143]
    s_waitcnt vmcnt(12)
    s_waitcnt lgkmcnt(6)
    v_mfma_f32_16x16x32_bf16 v[16:19], a[0:3], a[224:227], v[16:19]
    ds_read_b64_tr_b16 a[16:17], v228 offset:8192
    v_mfma_f32_16x16x32_bf16 v[20:23], a[0:3], a[228:231], v[20:23]
    ds_read_b64_tr_b16 a[18:19], v228 offset:8704
    v_mfma_f32_16x16x32_bf16 v[24:27], a[0:3], a[232:235], v[24:27]
    buffer_load_dwordx4 a[208:211], v224, s[8:11], s70 offen sc1
    v_mfma_f32_16x16x32_bf16 v[28:31], a[0:3], a[236:239], v[28:31]
    s_waitcnt lgkmcnt(6)
    v_mfma_f32_16x16x32_bf16 v[32:35], a[4:7], a[224:227], v[32:35]
    ds_read_b64_tr_b16 a[20:21], v229 offset:8192
    v_mfma_f32_16x16x32_bf16 v[36:39], a[4:7], a[228:231], v[36:39]
    ds_read_b64_tr_b16 a[22:23], v229 offset:8704
    v_mfma_f32_16x16x32_bf16 v[40:43], a[4:7], a[232:235], v[40:43]
    s_add_u32 m0, s89, 0
    s_nop 0
    buffer_load_dwordx4 v247, s[20:23], s71 offen offset:0 lds
    v_mfma_f32_16x16x32_bf16 v[44:47], a[4:7], a[236:239], v[44:47]
    s_waitcnt lgkmcnt(6)
    v_mfma_f32_16x16x32_bf16 v[48:51], a[8:11], a[224:227], v[48:51]
    ds_read_b64_tr_b16 a[24:25], v228 offset:12288
    v_mfma_f32_16x16x32_bf16 v[52:55], a[8:11], a[228:231], v[52:55]
    ds_read_b64_tr_b16 a[26:27], v228 offset:12800
    v_mfma_f32_16x16x32_bf16 v[56:59], a[8:11], a[232:235], v[56:59]
    buffer_load_dwordx4 a[212:215], v225, s[8:11], s70 offen sc1
    v_mfma_f32_16x16x32_bf16 v[60:63], a[8:11], a[236:239], v[60:63]
    s_waitcnt lgkmcnt(6)
    v_mfma_f32_16x16x32_bf16 v[64:67], a[12:15], a[224:227], v[64:67]
    ds_read_b64_tr_b16 a[28:29], v229 offset:12288
    v_mfma_f32_16x16x32_bf16 v[68:71], a[12:15], a[228:231], v[68:71]
    ds_read_b64_tr_b16 a[30:31], v229 offset:12800
    v_mfma_f32_16x16x32_bf16 v[72:75], a[12:15], a[232:235], v[72:75]
    s_add_u32 m0, s89, 4032
    s_nop 0
    buffer_load_dwordx4 v247, s[20:23], s71 offen offset:64 lds
    v_mfma_f32_16x16x32_bf16 v[76:79], a[12:15], a[236:239], v[76:79]
    s_waitcnt lgkmcnt(6)
    v_mfma_f32_16x16x32_bf16 v[80:83], a[16:19], a[224:227], v[80:83]
    ds_read_b64_tr_b16 a[0:1], v228 offset:2048
    v_mfma_f32_16x16x32_bf16 v[84:87], a[16:19], a[228:231], v[84:87]
    ds_read_b64_tr_b16 a[2:3], v228 offset:2560
    v_mfma_f32_16x16x32_bf16 v[88:91], a[16:19], a[232:235], v[88:91]
    buffer_load_dwordx4 a[216:219], v226, s[8:11], s70 offen sc1
    v_mfma_f32_16x16x32_bf16 v[92:95], a[16:19], a[236:239], v[92:95]
    s_waitcnt lgkmcnt(6)
    v_mfma_f32_16x16x32_bf16 v[96:99], a[20:23], a[224:227], v[96:99]
    ds_read_b64_tr_b16 a[4:5], v229 offset:2048
    v_mfma_f32_16x16x32_bf16 v[100:103], a[20:23], a[228:231], v[100:103]
    ds_read_b64_tr_b16 a[6:7], v229 offset:2560
    v_mfma_f32_16x16x32_bf16 v[104:107], a[20:23], a[232:235], v[104:107]
    s_add_u32 m0, s89, 8192
    s_nop 0
    buffer_load_dwordx4 v248, s[20:23], s71 offen offset:0 lds
    v_mfma_f32_16x16x32_bf16 v[108:111], a[20:23], a[236:239], v[108:111]
    s_waitcnt lgkmcnt(6)
    v_mfma_f32_16x16x32_bf16 v[112:115], a[24:27], a[224:227], v[112:115]
    ds_read_b64_tr_b16 a[8:9], v228 offset:6144
    v_mfma_f32_16x16x32_bf16 v[116:119], a[24:27], a[228:231], v[116:119]
    ds_read_b64_tr_b16 a[10:11], v228 offset:6656
    v_mfma_f32_16x16x32_bf16 v[120:123], a[24:27], a[232:235], v[120:123]
    buffer_load_dwordx4 a[220:223], v227, s[8:11], s70 offen sc1
    v_mfma_f32_16x16x32_bf16 v[124:127], a[24:27], a[236:239], v[124:127]
    s_waitcnt lgkmcnt(6)
    v_mfma_f32_16x16x32_bf16 v[128:131], a[28:31], a[224:227], v[128:131]
    ds_read_b64_tr_b16 a[12:13], v229 offset:6144
    v_mfma_f32_16x16x32_bf16 v[132:135], a[28:31], a[228:231], v[132:135]
    ds_read_b64_tr_b16 a[14:15], v229 offset:6656
    v_mfma_f32_16x16x32_bf16 v[136:139], a[28:31], a[232:235], v[136:139]
    s_add_u32 m0, s89, 12224
    s_nop 0
    buffer_load_dwordx4 v248, s[20:23], s71 offen offset:64 lds
    s_add_u32 s70, s70, 1024
    v_mfma_f32_16x16x32_bf16 v[140:143], a[28:31], a[236:239], v[140:143]
    s_waitcnt vmcnt(13)
    s_waitcnt lgkmcnt(6)
    v_mfma_f32_16x16x32_bf16 v[16:19], a[0:3], a[240:243], v[16:19]
    ds_read_b64_tr_b16 a[16:17], v228 offset:10240
    v_mfma_f32_16x16x32_bf16 v[20:23], a[0:3], a[244:247], v[20:23]
    ds_read_b64_tr_b16 a[18:19], v228 offset:10752
    v_mfma_f32_16x16x32_bf16 v[24:27], a[0:3], a[248:251], v[24:27]
    s_add_u32 s71, s71, 131072
    s_add_u32 s89, s89, 16384
    s_sub_u32 s39, s89, 65536
    s_cmp_ge_u32 s39, 98304
    s_cselect_b32 s39, 98304, 0
    s_sub_u32 s89, s89, s39
    buffer_load_dwordx4 a[224:227], v224, s[8:11], s70 offen sc1
    v_mfma_f32_16x16x32_bf16 v[28:31], a[0:3], a[252:255], v[28:31]
    s_waitcnt lgkmcnt(6)
    v_mfma_f32_16x16x32_bf16 v[32:35], a[4:7], a[240:243], v[32:35]
    ds_read_b64_tr_b16 a[20:21], v229 offset:10240
    v_mfma_f32_16x16x32_bf16 v[36:39], a[4:7], a[244:247], v[36:39]
    ds_read_b64_tr_b16 a[22:23], v229 offset:10752
    v_mfma_f32_16x16x32_bf16 v[40:43], a[4:7], a[248:251], v[40:43]
    v_min_u32 v243, 31, v0
    v_lshlrev_b32 v243, 2, v243
    buffer_load_dword v242, v243, s[8:11], s63 offen sc1
    v_mfma_f32_16x16x32_bf16 v[44:47], a[4:7], a[252:255], v[44:47]
    s_add_u32 s67, s67, 16384
    s_cmp_ge_u32 s67, 163840
    s_cselect_b32 s39, 98304, 0
    s_sub_u32 s67, s67, s39
    s_waitcnt lgkmcnt(6)
    v_mfma_f32_16x16x32_bf16 v[48:51], a[8:11], a[240:243], v[48:51]
    ds_read_b64_tr_b16 a[24:25], v228 offset:14336
    v_mfma_f32_16x16x32_bf16 v[52:55], a[8:11], a[244:247], v[52:55]
    ds_read_b64_tr_b16 a[26:27], v228 offset:14848
    v_mfma_f32_16x16x32_bf16 v[56:59], a[8:11], a[248:251], v[56:59]
    buffer_load_dwordx4 a[228:231], v225, s[8:11], s70 offen sc1
    v_mfma_f32_16x16x32_bf16 v[60:63], a[8:11], a[252:255], v[60:63]
    s_waitcnt lgkmcnt(6)
    v_mfma_f32_16x16x32_bf16 v[64:67], a[12:15], a[240:243], v[64:67]
    ds_read_b64_tr_b16 a[28:29], v229 offset:14336
    v_mfma_f32_16x16x32_bf16 v[68:71], a[12:15], a[244:247], v[68:71]
    ds_read_b64_tr_b16 a[30:31], v229 offset:14848
    v_mfma_f32_16x16x32_bf16 v[72:75], a[12:15], a[248:251], v[72:75]
    v_mfma_f32_16x16x32_bf16 v[76:79], a[12:15], a[252:255], v[76:79]
    s_barrier
    v_add_u32 v228, s67, v249
    v_add_u32 v229, s67, v250
    s_waitcnt lgkmcnt(6)
    v_mfma_f32_16x16x32_bf16 v[80:83], a[16:19], a[240:243], v[80:83]
    ds_read_b64_tr_b16 a[0:1], v228 offset:0
    v_mfma_f32_16x16x32_bf16 v[84:87], a[16:19], a[244:247], v[84:87]
    ds_read_b64_tr_b16 a[2:3], v228 offset:512
    v_mfma_f32_16x16x32_bf16 v[88:91], a[16:19], a[248:251], v[88:91]
    buffer_load_dwordx4 a[232:235], v226, s[8:11], s70 offen sc1
    v_mfma_f32_16x16x32_bf16 v[92:95], a[16:19], a[252:255], v[92:95]
    s_waitcnt lgkmcnt(6)
    v_mfma_f32_16x16x32_bf16 v[96:99], a[20:23], a[240:243], v[96:99]
    ds_read_b64_tr_b16 a[4:5], v229 offset:0
    v_mfma_f32_16x16x32_bf16 v[100:103], a[20:23], a[244:247], v[100:103]
    ds_read_b64_tr_b16 a[6:7], v229 offset:512
    v_mfma_f32_16x16x32_bf16 v[104:107], a[20:23], a[248:251], v[104:107]
    v_mfma_f32_16x16x32_bf16 v[108:111], a[20:23], a[252:255], v[108:111]
    s_waitcnt lgkmcnt(6)
    v_mfma_f32_16x16x32_bf16 v[112:115], a[24:27], a[240:243], v[112:115]
    ds_read_b64_tr_b16 a[8:9], v228 offset:4096
    v_mfma_f32_16x16x32_bf16 v[116:119], a[24:27], a[244:247], v[116:119]
    ds_read_b64_tr_b16 a[10:11], v228 offset:4608
    v_mfma_f32_16x16x32_bf16 v[120:123], a[24:27], a[248:251], v[120:123]
    buffer_load_dwordx4 a[236:239], v227, s[8:11], s70 offen sc1
    v_mfma_f32_16x16x32_bf16 v[124:127], a[24:27], a[252:255], v[124:127]
    s_waitcnt lgkmcnt(6)
    v_mfma_f32_16x16x32_bf16 v[128:131], a[28:31], a[240:243], v[128:131]
    ds_read_b64_tr_b16 a[12:13], v229 offset:4096
    v_mfma_f32_16x16x32_bf16 v[132:135], a[28:31], a[244:247], v[132:135]
    ds_read_b64_tr_b16 a[14:15], v229 offset:4608
    v_mfma_f32_16x16x32_bf16 v[136:139], a[28:31], a[248:251], v[136:139]
    s_add_u32 s70, s70, 1024
    v_mfma_f32_16x16x32_bf16 v[140:143], a[28:31], a[252:255], v[140:143]
    s_waitcnt vmcnt(13)
    s_waitcnt lgkmcnt(6)
    v_mfma_f32_16x16x32_bf16 v[16:19], a[0:3], a[192:195], v[16:19]
    ds_read_b64_tr_b16 a[16:17], v228 offset:8192
    v_mfma_f32_16x16x32_bf16 v[20:23], a[0:3], a[196:199], v[20:23]
    ds_read_b64_tr_b16 a[18:19], v228 offset:8704
    v_mfma_f32_16x16x32_bf16 v[24:27], a[0:3], a[200:203], v[24:27]
    buffer_load_dwordx4 a[240:243], v224, s[8:11], s70 offen sc1
    v_mfma_f32_16x16x32_bf16 v[28:31], a[0:3], a[204:207], v[28:31]
    s_waitcnt lgkmcnt(6)
    v_mfma_f32_16x16x32_bf16 v[32:35], a[4:7], a[192:195], v[32:35]
    ds_read_b64_tr_b16 a[20:21], v229 offset:8192
    v_mfma_f32_16x16x32_bf16 v[36:39], a[4:7], a[196:199], v[36:39]
    ds_read_b64_tr_b16 a[22:23], v229 offset:8704
    v_mfma_f32_16x16x32_bf16 v[40:43], a[4:7], a[200:203], v[40:43]
    v_mfma_f32_16x16x32_bf16 v[44:47], a[4:7], a[204:207], v[44:47]
    s_waitcnt lgkmcnt(6)
    v_mfma_f32_16x16x32_bf16 v[48:51], a[8:11], a[192:195], v[48:51]
    ds_read_b64_tr_b16 a[24:25], v228 offset:12288
    v_mfma_f32_16x16x32_bf16 v[52:55], a[8:11], a[196:199], v[52:55]
    ds_read_b64_tr_b16 a[26:27], v228 offset:12800
    v_mfma_f32_16x16x32_bf16 v[56:59], a[8:11], a[200:203], v[56:59]
    buffer_load_dwordx4 a[244:247], v225, s[8:11], s70 offen sc1
    v_mfma_f32_16x16x32_bf16 v[60:63], a[8:11], a[204:207], v[60:63]
    s_waitcnt lgkmcnt(6)
    v_mfma_f32_16x16x32_bf16 v[64:67], a[12:15], a[192:195], v[64:67]
    ds_read_b64_tr_b16 a[28:29], v229 offset:12288
    v_mfma_f32_16x16x32_bf16 v[68:71], a[12:15], a[196:199], v[68:71]
    ds_read_b64_tr_b16 a[30:31], v229 offset:12800
    v_mfma_f32_16x16x32_bf16 v[72:75], a[12:15], a[200:203], v[72:75]
    v_mfma_f32_16x16x32_bf16 v[76:79], a[12:15], a[204:207], v[76:79]
    s_waitcnt lgkmcnt(6)
    v_mfma_f32_16x16x32_bf16 v[80:83], a[16:19], a[192:195], v[80:83]
    ds_read_b64_tr_b16 a[0:1], v228 offset:2048
    v_mfma_f32_16x16x32_bf16 v[84:87], a[16:19], a[196:199], v[84:87]
    ds_read_b64_tr_b16 a[2:3], v228 offset:2560
    v_mfma_f32_16x16x32_bf16 v[88:91], a[16:19], a[200:203], v[88:91]
    buffer_load_dwordx4 a[248:251], v226, s[8:11], s70 offen sc1
    v_mfma_f32_16x16x32_bf16 v[92:95], a[16:19], a[204:207], v[92:95]
    s_waitcnt lgkmcnt(6)
    v_mfma_f32_16x16x32_bf16 v[96:99], a[20:23], a[192:195], v[96:99]
    ds_read_b64_tr_b16 a[4:5], v229 offset:2048
    v_mfma_f32_16x16x32_bf16 v[100:103], a[20:23], a[196:199], v[100:103]
    ds_read_b64_tr_b16 a[6:7], v229 offset:2560
    v_mfma_f32_16x16x32_bf16 v[104:107], a[20:23], a[200:203], v[104:107]
    v_mfma_f32_16x16x32_bf16 v[108:111], a[20:23], a[204:207], v[108:111]
    s_waitcnt lgkmcnt(6)
    v_mfma_f32_16x16x32_bf16 v[112:115], a[24:27], a[192:195], v[112:115]
    ds_read_b64_tr_b16 a[8:9], v228 offset:6144
    v_mfma_f32_16x16x32_bf16 v[116:119], a[24:27], a[196:199], v[116:119]
    ds_read_b64_tr_b16 a[10:11], v228 offset:6656
    v_mfma_f32_16x16x32_bf16 v[120:123], a[24:27], a[200:203], v[120:123]
    buffer_load_dwordx4 a[252:255], v227, s[8:11], s70 offen sc1
    v_mfma_f32_16x16x32_bf16 v[124:127], a[24:27], a[204:207], v[124:127]
    s_waitcnt lgkmcnt(6)
    v_mfma_f32_16x16x32_bf16 v[128:131], a[28:31], a[192:195], v[128:131]
    ds_read_b64_tr_b16 a[12:13], v229 offset:6144
    v_mfma_f32_16x16x32_bf16 v[132:135], a[28:31], a[196:199], v[132:135]
    ds_read_b64_tr_b16 a[14:15], v229 offset:6656
    v_mfma_f32_16x16x32_bf16 v[136:139], a[28:31], a[200:203], v[136:139]
    s_add_u32 s70, s70, 1024
    v_mfma_f32_16x16x32_bf16 v[140:143], a[28:31], a[204:207], v[140:143]
    s_waitcnt vmcnt(10)
    s_waitcnt lgkmcnt(6)
    v_mfma_f32_16x16x32_bf16 v[16:19], a[0:3], a[208:211], v[16:19]
    ds_read_b64_tr_b16 a[16:17], v228 offset:10240
    v_mfma_f32_16x16x32_bf16 v[20:23], a[0:3], a[212:215], v[20:23]
    ds_read_b64_tr_b16 a[18:19], v228 offset:10752
    v_mfma_f32_16x16x32_bf16 v[24:27], a[0:3], a[216:219], v[24:27]
    buffer_load_dwordx4 a[192:195], v224, s[8:11], s70 offen sc1
    v_mfma_f32_16x16x32_bf16 v[28:31], a[0:3], a[220:223], v[28:31]
    s_waitcnt lgkmcnt(6)
    v_mfma_f32_16x16x32_bf16 v[32:35], a[4:7], a[208:211], v[32:35]
    ds_read_b64_tr_b16 a[20:21], v229 offset:10240
    v_mfma_f32_16x16x32_bf16 v[36:39], a[4:7], a[212:215], v[36:39]
    ds_read_b64_tr_b16 a[22:23], v229 offset:10752
    v_mfma_f32_16x16x32_bf16 v[40:43], a[4:7], a[216:219], v[40:43]
    v_mfma_f32_16x16x32_bf16 v[44:47], a[4:7], a[220:223], v[44:47]
    s_add_u32 s67, s67, 16384
    s_cmp_ge_u32 s67, 163840
    s_cselect_b32 s39, 98304, 0
    s_sub_u32 s67, s67, s39
    s_waitcnt lgkmcnt(6)
    v_mfma_f32_16x16x32_bf16 v[48:51], a[8:11], a[208:211], v[48:51]
    ds_read_b64_tr_b16 a[24:25], v228 offset:14336
    v_mfma_f32_16x16x32_bf16 v[52:55], a[8:11], a[212:215], v[52:55]
    ds_read_b64_tr_b16 a[26:27], v228 offset:14848
    v_mfma_f32_16x16x32_bf16 v[56:59], a[8:11], a[216:219], v[56:59]
    buffer_load_dwordx4 a[196:199], v225, s[8:11], s70 offen sc1
    v_mfma_f32_16x16x32_bf16 v[60:63], a[8:11], a[220:223], v[60:63]
    s_waitcnt lgkmcnt(6)
    v_mfma_f32_16x16x32_bf16 v[64:67], a[12:15], a[208:211], v[64:67]
    ds_read_b64_tr_b16 a[28:29], v229 offset:14336
    v_mfma_f32_16x16x32_bf16 v[68:71], a[12:15], a[212:215], v[68:71]
    ds_read_b64_tr_b16 a[30:31], v229 offset:14848
    v_mfma_f32_16x16x32_bf16 v[72:75], a[12:15], a[216:219], v[72:75]
    s_add_u32 m0, s86, 0
    s_add_u32 s91, s85, 0
    buffer_load_dwordx4 v251, s[52:55], s91 offen offset:0 lds
    s_add_u32 m0, s86, 4032
    s_nop 0
    buffer_load_dwordx4 v251, s[52:55], s91 offen offset:64 lds
    v_mfma_f32_16x16x32_bf16 v[76:79], a[12:15], a[220:223], v[76:79]
    s_barrier
    v_add_u32 v228, s67, v249
    v_add_u32 v229, s67, v250
    s_waitcnt lgkmcnt(6)
    v_mfma_f32_16x16x32_bf16 v[80:83], a[16:19], a[208:211], v[80:83]
    ds_read_b64_tr_b16 a[0:1], v228 offset:0
    v_mfma_f32_16x16x32_bf16 v[84:87], a[16:19], a[212:215], v[84:87]
    ds_read_b64_tr_b16 a[2:3], v228 offset:512
    v_mfma_f32_16x16x32_bf16 v[88:91], a[16:19], a[216:219], v[88:91]
    buffer_load_dwordx4 a[200:203], v226, s[8:11], s70 offen sc1
    v_mfma_f32_16x16x32_bf16 v[92:95], a[16:19], a[220:223], v[92:95]
    s_waitcnt lgkmcnt(6)
    v_mfma_f32_16x16x32_bf16 v[96:99], a[20:23], a[208:211], v[96:99]
    ds_read_b64_tr_b16 a[4:5], v229 offset:0
    v_mfma_f32_16x16x32_bf16 v[100:103], a[20:23], a[212:215], v[100:103]
    ds_read_b64_tr_b16 a[6:7], v229 offset:512
    v_mfma_f32_16x16x32_bf16 v[104:107], a[20:23], a[216:219], v[104:107]
    s_waitcnt vmcnt(12)
    v_cmp_ne_u32 vcc, s61, v242
    s_nop 0
    s_cbranch_vccz L_apoll6_ok
    s_mov_b32 s34, 0x40000
L_apoll6:
    s_sleep 1
    buffer_load_dword v242, v243, s[8:11], s63 offen sc1
    s_waitcnt vmcnt(0)
    v_cmp_ne_u32 vcc, s61, v242
    s_sub_u32 s34, s34, 1
    s_cbranch_scc1 L_apoll6_ok
    s_nop 0
    s_cbranch_vccnz L_apoll6
L_apoll6_ok:
    v_mfma_f32_16x16x32_bf16 v[108:111], a[20:23], a[220:223], v[108:111]
    s_waitcnt lgkmcnt(6)
    v_mfma_f32_16x16x32_bf16 v[112:115], a[24:27], a[208:211], v[112:115]
    ds_read_b64_tr_b16 a[8:9], v228 offset:4096
    v_mfma_f32_16x16x32_bf16 v[116:119], a[24:27], a[212:215], v[116:119]
    ds_read_b64_tr_b16 a[10:11], v228 offset:4608
    v_mfma_f32_16x16x32_bf16 v[120:123], a[24:27], a[216:219], v[120:123]
    buffer_load_dwordx4 a[204:207], v227, s[8:11], s70 offen sc1
    s_add_u32 m0, s86, 8192
    s_add_u32 s91, s85, 131072
    buffer_load_dwordx4 v251, s[52:55], s91 offen offset:0 lds
    s_add_u32 m0, s86, 12224
    s_nop 0
    buffer_load_dwordx4 v251, s[52:55], s91 offen offset:64 lds
    v_mfma_f32_16x16x32_bf16 v[124:127], a[24:27], a[220:223], v[124:127]
    s_waitcnt lgkmcnt(6)
    v_mfma_f32_16x16x32_bf16 v[128:131], a[28:31], a[208:211], v[128:131]
    ds_read_b64_tr_b16 a[12:13], v229 offset:4096
    v_mfma_f32_16x16x32_bf16 v[132:135], a[28:31], a[212:215], v[132:135]
    ds_read_b64_tr_b16 a[14:15], v229 offset:4608
    v_mfma_f32_16x16x32_bf16 v[136:139], a[28:31], a[216:219], v[136:139]
    s_add_u32 s70, s70, 1024
    v_mfma_f32_16x16x32_bf16 v[140:143], a[28:31], a[220:223], v[140:143]
    s_waitcnt vmcnt(12)
    s_waitcnt lgkmcnt(6)
    v_mfma_f32_16x16x32_bf16 v[16:19], a[0:3], a[224:227], v[16:19]
    ds_read_b64_tr_b16 a[16:17], v228 offset:8192
    v_mfma_f32_16x16x32_bf16 v[20:23], a[0:3], a[228:231], v[20:23]
    ds_read_b64_tr_b16 a[18:19], v228 offset:8704
    v_mfma_f32_16x16x32_bf16 v[24:27], a[0:3], a[232:235], v[24:27]
    buffer_load_dwordx4 a[208:211], v224, s[8:11], s70 offen sc1
    v_mfma_f32_16x16x32_bf16 v[28:31], a[0:3], a[236:239], v[28:31]
    s_waitcnt lgkmcnt(6)
    v_mfma_f32_16x16x32_bf16 v[32:35], a[4:7], a[224:227], v[32:35]
    ds_read_b64_tr_b16 a[20:21], v229 offset:8192
    v_mfma_f32_16x16x32_bf16 v[36:39], a[4:7], a[228:231], v[36:39]
    ds_read_b64_tr_b16 a[22:23], v229 offset:8704
    v_mfma_f32_16x16x32_bf16 v[40:43], a[4:7], a[232:235], v[40:43]
    v_mfma_f32_16x16x32_bf16 v[44:47], a[4:7], a[236:239], v[44:47]
    s_waitcnt lgkmcnt(6)
    v_mfma_f32_16x16x32_bf16 v[48:51], a[8:11], a[224:227], v[48:51]
    ds_read_b64_tr_b16 a[24:25], v228 offset:12288
    v_mfma_f32_16x16x32_bf16 v[52:55], a[8:11], a[228:231], v[52:55]
    ds_read_b64_tr_b16 a[26:27], v228 offset:12800
    v_mfma_f32_16x16x32_bf16 v[56:59], a[8:11], a[232:235], v[56:59]
    buffer_load_dwordx4 a[212:215], v225, s[8:11], s70 offen sc1
    v_mfma_f32_16x16x32_bf16 v[60:63], a[8:11], a[236:239], v[60:63]
    s_waitcnt lgkmcnt(6)
    v_mfma_f32_16x16x32_bf16 v[64:67], a[12:15], a[224:227], v[64:67]
    ds_read_b64_tr_b16 a[28:29], v229 offset:12288
    v_mfma_f32_16x16x32_bf16 v[68:71], a[12:15], a[228:231], v[68:71]
    ds_read_b64_tr_b16 a[30:31], v229 offset:12800
    v_mfma_f32_16x16x32_bf16 v[72:75], a[12:15], a[232:235], v[72:75]
    v_mfma_f32_16x16x32_bf16 v[76:79], a[12:15], a[236:239], v[76:79]
    s_waitcnt lgkmcnt(6)
    v_mfma_f32_16x16x32_bf16 v[80:83], a[16:19], a[224:227], v[80:83]
    ds_read_b64_tr_b16 a[0:1], v228 offset:2048
    v_mfma_f32_16x16x32_bf16 v[84:87], a[16:19], a[228:231], v[84:87]
    ds_read_b64_tr_b16 a[2:3], v228 offset:2560
L_pad_12:
    s_cbranch_execz L_walk_done
    v_mfma_f32_16x16x32_bf16 v[88:91], a[16:19], a[232:235], v[88:91]
    buffer_load_dwordx4 a[216:219], v226, s[8:11], s70 offen sc1
    v_mfma_f32_16x16x32_bf16 v[92:95], a[16:19], a[236:239], v[92:95]
    s_waitcnt lgkmcnt(6)
    v_mfma_f32_16x16x32_bf16 v[96:99], a[20:23], a[224:227], v[96:99]
    ds_read_b64_tr_b16 a[4:5], v229 offset:2048
    v_mfma_f32_16x16x32_bf16 v[100:103], a[20:23], a[228:231], v[100:103]
    ds_read_b64_tr_b16 a[6:7], v229 offset:2560
    v_mfma_f32_16x16x32_bf16 v[104:107], a[20:23], a[232:235], v[104:107]
    v_mfma_f32_16x16x32_bf16 v[108:111], a[20:23], a[236:239], v[108:111]
    s_waitcnt lgkmcnt(6)
    v_mfma_f32_16x16x32_bf16 v[112:115], a[24:27], a[224:227], v[112:115]
    ds_read_b64_tr_b16 a[8:9], v228 offset:6144
    v_mfma_f32_16x16x32_bf16 v[116:119], a[24:27], a[228:231], v[116:119]
    ds_read_b64_tr_b16 a[10:11], v228 offset:6656
    v_mfma_f32_16x16x32_bf16 v[120:123], a[24:27], a[232:235], v[120:123]
    buffer_load_dwordx4 a[220:223], v227, s[8:11], s70 offen sc1
    v_mfma_f32_16x16x32_bf16 v[124:127], a[24:27], a[236:239], v[124:127]
    s_waitcnt lgkmcnt(6)
    v_mfma_f32_16x16x32_bf16 v[128:131], a[28:31], a[224:227], v[128:131]
    ds_read_b64_tr_b16 a[12:13], v229 offset:6144
    v_mfma_f32_16x16x32_bf16 v[132:135], a[28:31], a[228:231], v[132:135]
    ds_read_b64_tr_b16 a[14:15], v229 offset:6656
    v_mfma_f32_16x16x32_bf16 v[136:139], a[28:31], a[232:235], v[136:139]
    s_add_u32 s70, s70, 1024
    v_mfma_f32_16x16x32_bf16 v[140:143], a[28:31], a[236:239], v[140:143]
    s_waitcnt vmcnt(12)
    s_waitcnt lgkmcnt(6)
    v_mfma_f32_16x16x32_bf16 v[16:19], a[0:3], a[240:243], v[16:19]
    ds_read_b64_tr_b16 a[16:17], v228 offset:10240
    v_mfma_f32_16x16x32_bf16 v[20:23], a[0:3], a[244:247], v[20:23]
    ds_read_b64_tr_b16 a[18:19], v228 offset:10752
    v_mfma_f32_16x16x32_bf16 v[24:27], a[0:3], a[248:251], v[24:27]
    buffer_load_dwordx4 a[224:227], v224, s[8:11], s70 offen sc1
    v_mfma_f32_16x16x32_bf16 v[28:31], a[0:3], a[252:255], v[28:31]
    s_waitcnt lgkmcnt(6)
    v_mfma_f32_16x16x32_bf16 v[32:35], a[4:7], a[240:243], v[32:35]
    ds_read_b64_tr_b16 a[20:21], v229 offset:10240
    v_mfma_f32_16x16x32_bf16 v[36:39], a[4:7], a[244:247], v[36:39]
    ds_read_b64_tr_b16 a[22:23], v229 offset:10752
    v_mfma_f32_16x16x32_bf16 v[40:43], a[4:7], a[248:251], v[40:43]
    s_mov_b32 s12, s68
    s_mov_b32 s13, s69
    s_mov_b32 s14, 4194304
    s_mov_b32 s15, 0x00020000
    s_add_u32 s34, s87, 0
    buffer_load_dwordx4 v[208:211], v252, s[12:15], s34 offen
    s_add_u32 s34, s87, 16384
    buffer_load_dwordx4 v[212:215], v252, s[12:15], s34 offen
    s_add_u32 s34, s87, 32768
    buffer_load_dwordx4 v[216:219], v252, s[12:15], s34 offen
    s_add_u32 s34, s87, 49152
    buffer_load_dwordx4 v[220:223], v252, s[12:15], s34 offen
    v_mfma_f32_16x16x32_bf16 v[44:47], a[4:7], a[252:255], v[44:47]
    s_add_u32 s67, s67, 16384
    s_cmp_ge_u32 s67, 163840
    s_cselect_b32 s39, 98304, 0
    s_sub_u32 s67, s67, s39
    s_waitcnt lgkmcnt(6)
    v_mfma_f32_16x16x32_bf16 v[48:51], a[8:11], a[240:243], v[48:51]
    ds_read_b64_tr_b16 a[24:25], v228 offset:14336
    v_mfma_f32_16x16x32_bf16 v[52:55], a[8:11], a[244:247], v[52:55]
    ds_read_b64_tr_b16 a[26:27], v228 offset:14848
    v_mfma_f32_16x16x32_bf16 v[56:59], a[8:11], a[248:251], v[56:59]
    buffer_load_dwordx4 a[228:231], v225, s[8:11], s70 offen sc1
    v_mfma_f32_16x16x32_bf16 v[60:63], a[8:11], a[252:255], v[60:63]
    s_waitcnt lgkmcnt(6)
    v_mfma_f32_16x16x32_bf16 v[64:67], a[12:15], a[240:243], v[64:67]
    ds_read_b64_tr_b16 a[28:29], v229 offset:14336
    v_mfma_f32_16x16x32_bf16 v[68:71], a[12:15], a[244:247], v[68:71]
    ds_read_b64_tr_b16 a[30:31], v229 offset:14848
    v_mfma_f32_16x16x32_bf16 v[72:75], a[12:15], a[248:251], v[72:75]
    s_add_u32 m0, s86, 16384
    s_add_u32 s91, s85, 262144
    buffer_load_dwordx4 v251, s[52:55], s91 offen offset:0 lds
    s_add_u32 m0, s86, 20416
    s_nop 0
    buffer_load_dwordx4 v251, s[52:55], s91 offen offset:64 lds
    v_mfma_f32_16x16x32_bf16 v[76:79], a[12:15], a[252:255], v[76:79]
    s_barrier
    v_add_u32 v228, s67, v249
    v_add_u32 v229, s67, v250
    s_waitcnt lgkmcnt(6)
    v_mfma_f32_16x16x32_bf16 v[80:83], a[16:19], a[240:243], v[80:83]
    ds_read_b64_tr_b16 a[0:1], v228 offset:0
    v_mfma_f32_16x16x32_bf16 v[84:87], a[16:19], a[244:247], v[84:87]
    ds_read_b64_tr_b16 a[2:3], v228 offset:512
    v_mfma_f32_16x16x32_bf16 v[88:91], a[16:19], a[248:251], v[88:91]
    buffer_load_dwordx4 a[232:235], v226, s[8:11], s70 offen sc1
    v_mfma_f32_16x16x32_bf16 v[92:95], a[16:19], a[252:255], v[92:95]
    s_waitcnt lgkmcnt(6)
    v_mfma_f32_16x16x32_bf16 v[96:99], a[20:23], a[240:243], v[96:99]
    ds_read_b64_tr_b16 a[4:5], v229 offset:0
    v_mfma_f32_16x16x32_bf16 v[100:103], a[20:23], a[244:247], v[100:103]
    ds_read_b64_tr_b16 a[6:7], v229 offset:512
    v_mfma_f32_16x16x32_bf16 v[104:107], a[20:23], a[248:251], v[104:107]
    v_mfma_f32_16x16x32_bf16 v[108:111], a[20:23], a[252:255], v[108:111]
    s_waitcnt lgkmcnt(6)
    v_mfma_f32_16x16x32_bf16 v[112:115], a[24:27], a[240:243], v[112:115]
    ds_read_b64_tr_b16 a[8:9], v228 offset:4096
    v_mfma_f32_16x16x32_bf16 v[116:119], a[24:27], a[244:247], v[116:119]
    ds_read_b64_tr_b16 a[10:11], v228 offset:4608
    v_mfma_f32_16x16x32_bf16 v[120:123], a[24:27], a[248:251], v[120:123]
    buffer_load_dwordx4 a[236:239], v227, s[8:11], s70 offen sc1
    s_add_u32 m0, s86, 24576
    s_add_u32 s91, s85, 393216
    buffer_load_dwordx4 v251, s[52:55], s91 offen offset:0 lds
    s_add_u32 m0, s86, 28608
    s_nop 0
    buffer_load_dwordx4 v251, s[52:55], s91 offen offset:64 lds
    v_mfma_f32_16x16x32_bf16 v[124:127], a[24:27], a[252:255], v[124:127]
    s_waitcnt lgkmcnt(6)
    v_mfma_f32_16x16x32_bf16 v[128:131], a[28:31], a[240:243], v[128:131]
    ds_read_b64_tr_b16 a[12:13], v229 offset:4096
    v_mfma_f32_16x16x32_bf16 v[132:135], a[28:31], a[244:247], v[132:135]
    ds_read_b64_tr_b16 a[14:15], v229 offset:4608
    v_mfma_f32_16x16x32_bf16 v[136:139], a[28:31], a[248:251], v[136:139]
    s_add_u32 s70, s70, 1024
    v_mfma_f32_16x16x32_bf16 v[140:143], a[28:31], a[252:255], v[140:143]
    s_waitcnt vmcnt(18)
    s_waitcnt lgkmcnt(6)
    v_mfma_f32_16x16x32_bf16 v[16:19], a[0:3], a[192:195], v[16:19]
    ds_read_b64_tr_b16 a[16:17], v228 offset:8192
    v_mfma_f32_16x16x32_bf16 v[20:23], a[0:3], a[196:199], v[20:23]
    ds_read_b64_tr_b16 a[18:19], v228 offset:8704
    v_mfma_f32_16x16x32_bf16 v[24:27], a[0:3], a[200:203], v[24:27]
    buffer_load_dwordx4 a[240:243], v224, s[8:11], s70 offen sc1
    v_mfma_f32_16x16x32_bf16 v[28:31], a[0:3], a[204:207], v[28:31]
    s_waitcnt lgkmcnt(6)
    v_mfma_f32_16x16x32_bf16 v[32:35], a[4:7], a[192:195], v[32:35]
    ds_read_b64_tr_b16 a[20:21], v229 offset:8192
    v_mfma_f32_16x16x32_bf16 v[36:39], a[4:7], a[196:199], v[36:39]
    ds_read_b64_tr_b16 a[22:23], v229 offset:8704
    v_mfma_f32_16x16x32_bf16 v[40:43], a[4:7], a[200:203], v[40:43]
    buffer_load_dwordx4 a[32:35], v1, s[8:11], s84 offen offset:0 sc1
    v_mfma_f32_16x16x32_bf16 v[44:47], a[4:7], a[204:207], v[44:47]
    s_waitcnt lgkmcnt(6)
    v_mfma_f32_16x16x32_bf16 v[48:51], a[8:11], a[192:195], v[48:51]
    ds_read_b64_tr_b16 a[24:25], v228 offset:12288
    v_mfma_f32_16x16x32_bf16 v[52:55], a[8:11], a[196:199], v[52:55]
    ds_read_b64_tr_b16 a[26:27], v228 offset:12800
    v_mfma_f32_16x16x32_bf16 v[56:59], a[8:11], a[200:203], v[56:59]
    buffer_load_dwordx4 a[244:247], v225, s[8:11], s70 offen sc1
    v_mfma_f32_16x16x32_bf16 v[60:63], a[8:11], a[204:207], v[60:63]
    s_waitcnt lgkmcnt(6)
    v_mfma_f32_16x16x32_bf16 v[64:67], a[12:15], a[192:195], v[64:67]
    ds_read_b64_tr_b16 a[28:29], v229 offset:12288
    v_mfma_f32_16x16x32_bf16 v[68:71], a[12:15], a[196:199], v[68:71]
    ds_read_b64_tr_b16 a[30:31], v229 offset:12800
    v_mfma_f32_16x16x32_bf16 v[72:75], a[12:15], a[200:203], v[72:75]
    buffer_load_dwordx4 a[36:39], v1, s[8:11], s84 offen offset:1024 sc1
    v_mfma_f32_16x16x32_bf16 v[76:79], a[12:15], a[204:207], v[76:79]
    s_waitcnt lgkmcnt(6)
    v_mfma_f32_16x16x32_bf16 v[80:83], a[16:19], a[192:195], v[80:83]
    ds_read_b64_tr_b16 a[0:1], v228 offset:2048
    v_mfma_f32_16x16x32_bf16 v[84:87], a[16:19], a[196:199], v[84:87]
    ds_read_b64_tr_b16 a[2:3], v228 offset:2560
    v_mfma_f32_16x16x32_bf16 v[88:91], a[16:19], a[200:203], v[88:91]
    buffer_load_dwordx4 a[248:251], v226, s[8:11], s70 offen sc1
    v_mfma_f32_16x16x32_bf16 v[92:95], a[16:19], a[204:207], v[92:95]
    s_waitcnt lgkmcnt(6)
    v_mfma_f32_16x16x32_bf16 v[96:99], a[20:23], a[192:195], v[96:99]
    ds_read_b64_tr_b16 a[4:5], v229 offset:2048
    v_mfma_f32_16x16x32_bf16 v[100:103], a[20:23], a[196:199], v[100:103]
    ds_read_b64_tr_b16 a[6:7], v229 offset:2560
    v_mfma_f32_16x16x32_bf16 v[104:107], a[20:23], a[200:203], v[104:107]
    buffer_load_dwordx4 a[40:43], v1, s[8:11], s84 offen offset:2048 sc1
    v_mfma_f32_16x16x32_bf16 v[108:111], a[20:23], a[204:207], v[108:111]
    s_waitcnt lgkmcnt(6)
    v_mfma_f32_16x16x32_bf16 v[112:115], a[24:27], a[192:195], v[112:115]
    ds_read_b64_tr_b16 a[8:9], v228 offset:6144
    v_mfma_f32_16x16x32_bf16 v[116:119], a[24:27], a[196:199], v[116:119]
    ds_read_b64_tr_b16 a[10:11], v228 offset:6656
    v_mfma_f32_16x16x32_bf16 v[120:123], a[24:27], a[200:203], v[120:123]
    buffer_load_dwordx4 a[252:255], v227, s[8:11], s70 offen sc1
    v_mfma_f32_16x16x32_bf16 v[124:127], a[24:27], a[204:207], v[124:127]
    s_waitcnt lgkmcnt(6)
    v_mfma_f32_16x16x32_bf16 v[128:131], a[28:31], a[192:195], v[128:131]
    ds_read_b64_tr_b16 a[12:13], v229 offset:6144
    v_mfma_f32_16x16x32_bf16 v[132:135], a[28:31], a[196:199], v[132:135]
    ds_read_b64_tr_b16 a[14:15], v229 offset:6656
    v_mfma_f32_16x16x32_bf16 v[136:139], a[28:31], a[200:203], v[136:139]
    s_add_u32 s70, s70, 1024
    buffer_load_dwordx4 a[44:47], v1, s[8:11], s84 offen offset:3072 sc1
    s_add_u32 s84, s84, 4096
    v_mfma_f32_16x16x32_bf16 v[140:143], a[28:31], a[204:207], v[140:143]
    s_waitcnt vmcnt(20)
    s_waitcnt lgkmcnt(6)
    v_mfma_f32_16x16x32_bf16 v[16:19], a[0:3], a[208:211], v[16:19]
    ds_read_b64_tr_b16 a[16:17], v228 offset:10240
    v_mfma_f32_16x16x32_bf16 v[20:23], a[0:3], a[212:215], v[20:23]
    ds_read_b64_tr_b16 a[18:19], v228 offset:10752
    v_mfma_f32_16x16x32_bf16 v[24:27], a[0:3], a[216:219], v[24:27]
    v_mfma_f32_16x16x32_bf16 v[28:31], a[0:3], a[220:223], v[28:31]
    s_waitcnt lgkmcnt(6)
    v_mfma_f32_16x16x32_bf16 v[32:35], a[4:7], a[208:211], v[32:35]
    ds_read_b64_tr_b16 a[20:21], v229 offset:10240
    v_mfma_f32_16x16x32_bf16 v[36:39], a[4:7], a[212:215], v[36:39]
    ds_read_b64_tr_b16 a[22:23], v229 offset:10752
    v_mfma_f32_16x16x32_bf16 v[40:43], a[4:7], a[216:219], v[40:43]
    buffer_load_dwordx4 a[48:51], v1, s[8:11], s84 offen offset:0 sc1
    v_mfma_f32_16x16x32_bf16 v[44:47], a[4:7], a[220:223], v[44:47]
    s_add_u32 s67, s67, 16384
    s_cmp_ge_u32 s67, 163840
    s_cselect_b32 s39, 98304, 0
    s_sub_u32 s67, s67, s39
    s_waitcnt lgkmcnt(6)
    v_mfma_f32_16x16x32_bf16 v[48:51], a[8:11], a[208:211], v[48:51]
    ds_read_b64_tr_b16 a[24:25], v228 offset:14336
    v_mfma_f32_16x16x32_bf16 v[52:55], a[8:11], a[212:215], v[52:55]
    ds_read_b64_tr_b16 a[26:27], v228 offset:14848
    v_mfma_f32_16x16x32_bf16 v[56:59], a[8:11], a[216:219], v[56:59]
    buffer_load_dwordx4 a[52:55], v1, s[8:11], s84 offen offset:1024 sc1
    v_mfma_f32_16x16x32_bf16 v[60:63], a[8:11], a[220:223], v[60:63]
    s_waitcnt lgkmcnt(6)
    v_mfma_f32_16x16x32_bf16 v[64:67], a[12:15], a[208:211], v[64:67]
    ds_read_b64_tr_b16 a[28:29], v229 offset:14336
    v_mfma_f32_16x16x32_bf16 v[68:71], a[12:15], a[212:215], v[68:71]
    ds_read_b64_tr_b16 a[30:31], v229 offset:14848
    v_mfma_f32_16x16x32_bf16 v[72:75], a[12:15], a[216:219], v[72:75]
    s_add_u32 m0, s86, 32768
    s_add_u32 s91, s85, 524288
    buffer_load_dwordx4 v251, s[52:55], s91 offen offset:0 lds
    s_add_u32 m0, s86, 36800
    s_nop 0
    buffer_load_dwordx4 v251, s[52:55], s91 offen offset:64 lds
    v_mfma_f32_16x16x32_bf16 v[76:79], a[12:15], a[220:223], v[76:79]
    s_barrier
    v_add_u32 v228, s67, v249
    v_add_u32 v229, s67, v250
    s_waitcnt lgkmcnt(6)
    v_mfma_f32_16x16x32_bf16 v[80:83], a[16:19], a[208:211], v[80:83]
    ds_read_b64_tr_b16 a[0:1], v228 offset:0
    v_mfma_f32_16x16x32_bf16 v[84:87], a[16:19], a[212:215], v[84:87]
    ds_read_b64_tr_b16 a[2:3], v228 offset:512
    v_mfma_f32_16x16x32_bf16 v[88:91], a[16:19], a[216:219], v[88:91]
    buffer_load_dwordx4 a[56:59], v1, s[8:11], s84 offen offset:2048 sc1
    v_mfma_f32_16x16x32_bf16 v[92:95], a[16:19], a[220:223], v[92:95]
    s_waitcnt lgkmcnt(6)
    v_mfma_f32_16x16x32_bf16 v[96:99], a[20:23], a[208:211], v[96:99]
    ds_read_b64_tr_b16 a[4:5], v229 offset:0
    v_mfma_f32_16x16x32_bf16 v[100:103], a[20:23], a[212:215], v[100:103]
    ds_read_b64_tr_b16 a[6:7], v229 offset:512
    v_mfma_f32_16x16x32_bf16 v[104:107], a[20:23], a[216:219], v[104:107]
    buffer_load_dwordx4 a[60:63], v1, s[8:11], s84 offen offset:3072 sc1
    s_add_u32 s84, s84, 4096
    v_mfma_f32_16x16x32_bf16 v[108:111], a[20:23], a[220:223], v[108:111]
    s_waitcnt lgkmcnt(6)
    v_mfma_f32_16x16x32_bf16 v[112:115], a[24:27], a[208:211], v[112:115]
    ds_read_b64_tr_b16 a[8:9], v228 offset:4096
    v_mfma_f32_16x16x32_bf16 v[116:119], a[24:27], a[212:215], v[116:119]
    ds_read_b64_tr_b16 a[10:11], v228 offset:4608
    v_mfma_f32_16x16x32_bf16 v[120:123], a[24:27], a[216:219], v[120:123]
    s_add_u32 m0, s86, 40960
    s_add_u32 s91, s85, 655360
    buffer_load_dwordx4 v251, s[52:55], s91 offen offset:0 lds
    s_add_u32 m0, s86, 44992
    s_nop 0
    buffer_load_dwordx4 v251, s[52:55], s91 offen offset:64 lds
    v_mfma_f32_16x16x32_bf16 v[124:127], a[24:27], a[220:223], v[124:127]
    s_waitcnt lgkmcnt(6)
    v_mfma_f32_16x16x32_bf16 v[128:131], a[28:31], a[208:211], v[128:131]
    ds_read_b64_tr_b16 a[12:13], v229 offset:4096
    v_mfma_f32_16x16x32_bf16 v[132:135], a[28:31], a[212:215], v[132:135]
    ds_read_b64_tr_b16 a[14:15], v229 offset:4608
    v_mfma_f32_16x16x32_bf16 v[136:139], a[28:31], a[216:219], v[136:139]
    v_mfma_f32_16x16x32_bf16 v[140:143], a[28:31], a[220:223], v[140:143]
    s_waitcnt vmcnt(18)
    s_waitcnt lgkmcnt(6)
    v_mfma_f32_16x16x32_bf16 v[16:19], a[0:3], a[224:227], v[16:19]
    ds_read_b64_tr_b16 a[16:17], v228 offset:8192
    v_mfma_f32_16x16x32_bf16 v[20:23], a[0:3], a[228:231], v[20:23]
    ds_read_b64_tr_b16 a[18:19], v228 offset:8704
    v_mfma_f32_16x16x32_bf16 v[24:27], a[0:3], a[232:235], v[24:27]
    v_mfma_f32_16x16x32_bf16 v[28:31], a[0:3], a[236:239], v[28:31]
    s_waitcnt lgkmcnt(6)
    v_mfma_f32_16x16x32_bf16 v[32:35], a[4:7], a[224:227], v[32:35]
    ds_read_b64_tr_b16 a[20:21], v229 offset:8192
    v_mfma_f32_16x16x32_bf16 v[36:39], a[4:7], a[228:231], v[36:39]
    ds_read_b64_tr_b16 a[22:23], v229 offset:8704
    v_mfma_f32_16x16x32_bf16 v[40:43], a[4:7], a[232:235], v[40:43]
    buffer_load_dwordx4 a[64:67], v1, s[8:11], s84 offen offset:0 sc1
    v_mfma_f32_16x16x32_bf16 v[44:47], a[4:7], a[236:239], v[44:47]
    s_waitcnt lgkmcnt(6)
    v_mfma_f32_16x16x32_bf16 v[48:51], a[8:11], a[224:227], v[48:51]
    ds_read_b64_tr_b16 a[24:25], v228 offset:12288
    v_mfma_f32_16x16x32_bf16 v[52:55], a[8:11], a[228:231], v[52:55]
    ds_read_b64_tr_b16 a[26:27], v228 offset:12800
    v_mfma_f32_16x16x32_bf16 v[56:59], a[8:11], a[232:235], v[56:59]
    v_mfma_f32_16x16x32_bf16 v[60:63], a[8:11], a[236:239], v[60:63]
    s_waitcnt lgkmcnt(6)
    v_mfma_f32_16x16x32_bf16 v[64:67], a[12:15], a[224:227], v[64:67]
    ds_read_b64_tr_b16 a[28:29], v229 offset:12288
    v_mfma_f32_16x16x32_bf16 v[68:71], a[12:15], a[228:231], v[68:71]
    ds_read_b64_tr_b16 a[30:31], v229 offset:12800
    v_mfma_f32_16x16x32_bf16 v[72:75], a[12:15], a[232:235], v[72:75]
    buffer_load_dwordx4 a[68:71], v1, s[8:11], s84 offen offset:1024 sc1
    v_mfma_f32_16x16x32_bf16 v[76:79], a[12:15], a[236:239], v[76:79]
    s_waitcnt lgkmcnt(6)
    v_mfma_f32_16x16x32_bf16 v[80:83], a[16:19], a[224:227], v[80:83]
    ds_read_b64_tr_b16 a[0:1], v228 offset:2048
    v_mfma_f32_16x16x32_bf16 v[84:87], a[16:19], a[228:231], v[84:87]
    ds_read_b64_tr_b16 a[2:3], v228 offset:2560
    v_mfma_f32_16x16x32_bf16 v[88:91], a[16:19], a[232:235], v[88:91]
    v_mfma_f32_16x16x32_bf16 v[92:95], a[16:19], a[236:239], v[92:95]
    s_waitcnt lgkmcnt(6)
    v_mfma_f32_16x16x32_bf16 v[96:99], a[20:23], a[224:227], v[96:99]
    ds_read_b64_tr_b16 a[4:5], v229 offset:2048
    v_mfma_f32_16x16x32_bf16 v[100:103], a[20:23], a[228:231], v[100:103]
    ds_read_b64_tr_b16 a[6:7], v229 offset:2560
    v_mfma_f32_16x16x32_bf16 v[104:107], a[20:23], a[232:235], v[104:107]
    buffer_load_dwordx4 a[72:75], v1, s[8:11], s84 offen offset:2048 sc1
    v_mfma_f32_16x16x32_bf16 v[108:111], a[20:23], a[236:239], v[108:111]
    s_waitcnt lgkmcnt(6)
    v_mfma_f32_16x16x32_bf16 v[112:115], a[24:27], a[224:227], v[112:115]
    ds_read_b64_tr_b16 a[8:9], v228 offset:6144
    v_mfma_f32_16x16x32_bf16 v[116:119], a[24:27], a[228:231], v[116:119]
    ds_read_b64_tr_b16 a[10:11], v228 offset:6656
    v_mfma_f32_16x16x32_bf16 v[120:123], a[24:27], a[232:235], v[120:123]
    v_mfma_f32_16x16x32_bf16 v[124:127], a[24:27], a[236:239], v[124:127]
    s_waitcnt lgkmcnt(6)
    v_mfma_f32_16x16x32_bf16 v[128:131], a[28:31], a[224:227], v[128:131]
    ds_read_b64_tr_b16 a[12:13], v229 offset:6144
    v_mfma_f32_16x16x32_bf16 v[132:135], a[28:31], a[228:231], v[132:135]
    ds_read_b64_tr_b16 a[14:15], v229 offset:6656
    v_mfma_f32_16x16x32_bf16 v[136:139], a[28:31], a[232:235], v[136:139]
    buffer_load_dwordx4 a[76:79], v1, s[8:11], s84 offen offset:3072 sc1
    s_add_u32 s84, s84, 4096
    v_mfma_f32_16x16x32_bf16 v[140:143], a[28:31], a[236:239], v[140:143]
    s_waitcnt vmcnt(13)
    s_waitcnt lgkmcnt(6)
    v_mfma_f32_16x16x32_bf16 v[16:19], a[0:3], a[240:243], v[16:19]
    ds_read_b64_tr_b16 a[16:17], v228 offset:10240
    v_mfma_f32_16x16x32_bf16 v[20:23], a[0:3], a[244:247], v[20:23]
    ds_read_b64_tr_b16 a[18:19], v228 offset:10752
    v_mfma_f32_16x16x32_bf16 v[24:27], a[0:3], a[248:251], v[24:27]
    s_lshl_b32 s34, s7, 3
    s_add_u32 s34, s34, s56
    s_lshl_b32 s34, s34, 2
    s_and_b32 s35, s3, 2
    s_add_u32 s34, s34, s35
    s_and_b32 s35, s6, 1
    s_add_u32 s38, s34, s35
    s_xor_b32 s35, s35, 1
    s_add_u32 s39, s34, s35
    s_lshl_b32 s34, s6, 14
    s_and_b32 s35, s3, 1
    s_lshl_b32 s35, s35, 13
    s_add_u32 s34, s34, s35
    s_add_u32 s34, s34, 32505856
    s_lshl_b32 s38, s38, 16
    s_add_u32 s38, s38, s34
    s_lshl_b32 s39, s39, 16
    s_add_u32 s39, s39, s34
    s_lshr_b32 s34, s6, 1
    s_lshr_b32 s35, s3, 1
    s_cmp_eq_u32 s34, s35
    s_cselect_b64 s[40:41], 0, -1
    s_cselect_b64 s[42:43], -1, 0
    s_and_b32 s35, s3, 1
    s_lshl_b32 s35, s35, 13
    s_add_u32 s35, s35, 147456
    v_add_u32 v230, s35, v1
    v_mfma_f32_16x16x32_bf16 v[28:31], a[0:3], a[252:255], v[28:31]
    s_waitcnt lgkmcnt(6)
    v_mfma_f32_16x16x32_bf16 v[32:35], a[4:7], a[240:243], v[32:35]
    ds_read_b64_tr_b16 a[20:21], v229 offset:10240
    v_mfma_f32_16x16x32_bf16 v[36:39], a[4:7], a[244:247], v[36:39]
    ds_read_b64_tr_b16 a[22:23], v229 offset:10752
    v_mfma_f32_16x16x32_bf16 v[40:43], a[4:7], a[248:251], v[40:43]
    buffer_load_dwordx4 a[80:83], v1, s[8:11], s84 offen offset:0 sc1
    v_mfma_f32_16x16x32_bf16 v[44:47], a[4:7], a[252:255], v[44:47]
    s_waitcnt lgkmcnt(6)
    v_mfma_f32_16x16x32_bf16 v[48:51], a[8:11], a[240:243], v[48:51]
    ds_read_b64_tr_b16 a[24:25], v228 offset:14336
    v_mfma_f32_16x16x32_bf16 v[52:55], a[8:11], a[244:247], v[52:55]
    ds_read_b64_tr_b16 a[26:27], v228 offset:14848
    v_mfma_f32_16x16x32_bf16 v[56:59], a[8:11], a[248:251], v[56:59]
    buffer_load_dwordx4 a[84:87], v1, s[8:11], s84 offen offset:1024 sc1
    v_mfma_f32_16x16x32_bf16 v[60:63], a[8:11], a[252:255], v[60:63]
    s_waitcnt lgkmcnt(6)
    v_mfma_f32_16x16x32_bf16 v[64:67], a[12:15], a[240:243], v[64:67]
    ds_read_b64_tr_b16 a[28:29], v229 offset:14336
    v_mfma_f32_16x16x32_bf16 v[68:71], a[12:15], a[244:247], v[68:71]
    ds_read_b64_tr_b16 a[30:31], v229 offset:14848
    v_mfma_f32_16x16x32_bf16 v[72:75], a[12:15], a[248:251], v[72:75]
    s_add_u32 m0, s86, 49152
    s_add_u32 s91, s85, 786432
    buffer_load_dwordx4 v251, s[52:55], s91 offen offset:0 lds
    s_add_u32 m0, s86, 53184
    s_nop 0
    buffer_load_dwordx4 v251, s[52:55], s91 offen offset:64 lds
    v_mfma_f32_16x16x32_bf16 v[76:79], a[12:15], a[252:255], v[76:79]
    s_waitcnt lgkmcnt(6)
    v_mfma_f32_16x16x32_bf16 v[80:83], a[16:19], a[240:243], v[80:83]
    v_mfma_f32_16x16x32_bf16 v[84:87], a[16:19], a[244:247], v[84:87]
    v_mfma_f32_16x16x32_bf16 v[88:91], a[16:19], a[248:251], v[88:91]
    buffer_load_dwordx4 a[88:91], v1, s[8:11], s84 offen offset:2048 sc1
    v_mfma_f32_16x16x32_bf16 v[92:95], a[16:19], a[252:255], v[92:95]
    s_waitcnt lgkmcnt(4)
    v_mfma_f32_16x16x32_bf16 v[96:99], a[20:23], a[240:243], v[96:99]
    v_mfma_f32_16x16x32_bf16 v[100:103], a[20:23], a[244:247], v[100:103]
    v_mfma_f32_16x16x32_bf16 v[104:107], a[20:23], a[248:251], v[104:107]
    buffer_load_dwordx4 a[92:95], v1, s[8:11], s84 offen offset:3072 sc1
    s_add_u32 s84, s84, 4096
    v_mfma_f32_16x16x32_bf16 v[108:111], a[20:23], a[252:255], v[108:111]
    s_waitcnt lgkmcnt(2)
    v_mfma_f32_16x16x32_bf16 v[112:115], a[24:27], a[240:243], v[112:115]
    v_mfma_f32_16x16x32_bf16 v[116:119], a[24:27], a[244:247], v[116:119]
    v_mfma_f32_16x16x32_bf16 v[120:123], a[24:27], a[248:251], v[120:123]
    s_add_u32 m0, s86, 57344
    s_add_u32 s91, s85, 917504
    buffer_load_dwordx4 v251, s[52:55], s91 offen offset:0 lds
    s_add_u32 m0, s86, 61376
    s_nop 0
    buffer_load_dwordx4 v251, s[52:55], s91 offen offset:64 lds
    v_mfma_f32_16x16x32_bf16 v[124:127], a[24:27], a[252:255], v[124:127]
    s_waitcnt lgkmcnt(0)
    v_mfma_f32_16x16x32_bf16 v[128:131], a[28:31], a[240:243], v[128:131]
    v_mfma_f32_16x16x32_bf16 v[132:135], a[28:31], a[244:247], v[132:135]
    v_mfma_f32_16x16x32_bf16 v[136:139], a[28:31], a[248:251], v[136:139]
    v_mfma_f32_16x16x32_bf16 v[140:143], a[28:31], a[252:255], v[140:143]
    s_nop 7
    v_cvt_pk_bf16_f32 v144, v16, v17
    v_cvt_pk_bf16_f32 v145, v18, v19
    v_cvt_pk_bf16_f32 v146, v32, v33
    v_cvt_pk_bf16_f32 v147, v34, v35
    s_add_u32 s35, s38, 0
    s_mov_b64 exec, s[40:41]
    buffer_store_dwordx4 v[144:147], v1, s[8:11], s35 offen offset:0 sc1
    s_mov_b64 exec, s[42:43]
    ds_write_b128 v230, v[144:147] offset:0
    s_mov_b64 exec, -1
    v_cvt_pk_bf16_f32 v160, v20, v21
    v_cvt_pk_bf16_f32 v161, v22, v23
    v_cvt_pk_bf16_f32 v162, v36, v37
    v_cvt_pk_bf16_f32 v163, v38, v39
    s_add_u32 s35, s38, 0
    s_mov_b64 exec, s[40:41]
    buffer_store_dwordx4 v[160:163], v1, s[8:11], s35 offen offset:2048 sc1
    s_mov_b64 exec, s[42:43]
    ds_write_b128 v230, v[160:163] offset:2048
    s_mov_b64 exec, -1
    v_cvt_pk_bf16_f32 v176, v24, v25
    v_cvt_pk_bf16_f32 v177, v26, v27
    v_cvt_pk_bf16_f32 v178, v40, v41
    v_cvt_pk_bf16_f32 v179, v42, v43
    s_add_u32 s35, s38, 4096
    s_mov_b64 exec, s[40:41]
    buffer_store_dwordx4 v[176:179], v1, s[8:11], s35 offen offset:0 sc1
    s_mov_b64 exec, s[42:43]
    ds_write_b128 v230, v[176:179] offset:4096
    s_mov_b64 exec, -1
    v_cvt_pk_bf16_f32 v192, v28, v29
    v_cvt_pk_bf16_f32 v193, v30, v31
    v_cvt_pk_bf16_f32 v194, v44, v45
    v_cvt_pk_bf16_f32 v195, v46, v47
    s_add_u32 s35, s38, 4096
    s_mov_b64 exec, s[40:41]
    buffer_store_dwordx4 v[192:195], v1, s[8:11], s35 offen offset:2048 sc1
    s_mov_b64 exec, s[42:43]
    ds_write_b128 v230, v[192:195] offset:6144
    s_mov_b64 exec, -1
    buffer_load_dwordx4 a[96:99], v1, s[8:11], s84 offen offset:0 sc1
    buffer_load_dwordx4 a[100:103], v1, s[8:11], s84 offen offset:1024 sc1
    buffer_load_dwordx4 a[104:107], v1, s[8:11], s84 offen offset:2048 sc1
    buffer_load_dwordx4 a[108:111], v1, s[8:11], s84 offen offset:3072 sc1
    s_add_u32 s84, s84, 4096
    buffer_load_dwordx4 a[112:115], v1, s[8:11], s84 offen offset:0 sc1
    buffer_load_dwordx4 a[116:119], v1, s[8:11], s84 offen offset:1024 sc1
    buffer_load_dwordx4 a[120:123], v1, s[8:11], s84 offen offset:2048 sc1
    s_barrier
    ds_read_b64_tr_b16 a[0:1], v253 offset:0
    ds_read_b64_tr_b16 a[2:3], v253 offset:512
    ds_read_b64_tr_b16 a[4:5], v253 offset:4096
    ds_read_b64_tr_b16 a[6:7], v253 offset:4608
    ds_read_b64_tr_b16 a[8:9], v253 offset:1024
    ds_read_b64_tr_b16 a[10:11], v253 offset:1536
    ds_read_b64_tr_b16 a[12:13], v253 offset:5120
    ds_read_b64_tr_b16 a[14:15], v253 offset:5632
    ds_read_b64_tr_b16 a[16:17], v253 offset:2048
    ds_read_b64_tr_b16 a[18:19], v253 offset:2560
    ds_read_b64_tr_b16 a[20:21], v253 offset:6144
    ds_read_b64_tr_b16 a[22:23], v253 offset:6656
    s_waitcnt vmcnt(27)
    s_waitcnt lgkmcnt(10)
    v_mfma_f32_32x32x16_bf16 v[16:31], a[0:3], a[32:35], 0
    ds_read_b64_tr_b16 a[24:25], v253 offset:3072
    ds_read_b64_tr_b16 a[26:27], v253 offset:3584
    buffer_load_dwordx4 a[124:127], v1, s[8:11], s84 offen offset:3072 sc1
    s_add_u32 s84, s84, 4096
    v_cvt_pk_bf16_f32 v148, v48, v49
    v_cvt_pk_bf16_f32 v149, v50, v51
    v_cvt_pk_bf16_f32 v150, v64, v65
    v_cvt_pk_bf16_f32 v151, v66, v67
    s_add_u32 s35, s38, 0
    s_mov_b64 exec, s[40:41]
    buffer_store_dwordx4 v[148:151], v1, s[8:11], s35 offen offset:1024 sc1
    s_mov_b64 exec, s[42:43]
    ds_write_b128 v230, v[148:151] offset:1024
    s_mov_b64 exec, -1
    s_waitcnt lgkmcnt(10)
    v_mfma_f32_32x32x16_bf16 v[32:47], a[4:7], a[32:35], 0
    ds_read_b64_tr_b16 a[28:29], v253 offset:7168
    ds_read_b64_tr_b16 a[30:31], v253 offset:7680
    s_mov_b32 s36, 0xbfb8aa3b
    s_mov_b32 s37, 0xbfb8aa3b
    s_waitcnt lgkmcnt(10)
    v_mfma_f32_32x32x16_bf16 v[16:31], a[8:11], a[36:39], v[16:31]
    ds_read_b64_tr_b16 a[0:1], v253 offset:8192
    ds_read_b64_tr_b16 a[2:3], v253 offset:8704
    buffer_load_dwordx4 a[32:35], v1, s[8:11], s84 offen offset:0 sc1
    v_cvt_pk_bf16_f32 v164, v52, v53
    v_cvt_pk_bf16_f32 v165, v54, v55
    v_cvt_pk_bf16_f32 v166, v68, v69
    v_cvt_pk_bf16_f32 v167, v70, v71
    s_add_u32 s35, s38, 0
    s_mov_b64 exec, s[40:41]
    buffer_store_dwordx4 v[164:167], v1, s[8:11], s35 offen offset:3072 sc1
    s_mov_b64 exec, s[42:43]
    ds_write_b128 v230, v[164:167] offset:3072
    s_mov_b64 exec, -1
    s_waitcnt lgkmcnt(10)
    v_mfma_f32_32x32x16_bf16 v[32:47], a[12:15], a[36:39], v[32:47]
    ds_read_b64_tr_b16 a[4:5], v253 offset:12288
    ds_read_b64_tr_b16 a[6:7], v253 offset:12800
    s_add_u32 m0, s86, 65536
    s_add_u32 s91, s85, 1048576
    buffer_load_dwordx4 v251, s[52:55], s91 offen offset:0 lds
    s_add_u32 m0, s86, 69568
    s_nop 0
    buffer_load_dwordx4 v251, s[52:55], s91 offen offset:64 lds
    s_waitcnt lgkmcnt(10)
    v_mfma_f32_32x32x16_bf16 v[16:31], a[16:19], a[40:43], v[16:31]
    ds_read_b64_tr_b16 a[8:9], v253 offset:9216
    ds_read_b64_tr_b16 a[10:11], v253 offset:9728
    buffer_load_dwordx4 a[36:39], v1, s[8:11], s84 offen offset:1024 sc1
    v_cvt_pk_bf16_f32 v180, v56, v57
    v_cvt_pk_bf16_f32 v181, v58, v59
    v_cvt_pk_bf16_f32 v182, v72, v73
    v_cvt_pk_bf16_f32 v183, v74, v75
    s_add_u32 s35, s38, 4096
    s_mov_b64 exec, s[40:41]
    buffer_store_dwordx4 v[180:183], v1, s[8:11], s35 offen offset:1024 sc1
    s_mov_b64 exec, s[42:43]
    ds_write_b128 v230, v[180:183] offset:5120
    s_mov_b64 exec, -1
    s_waitcnt lgkmcnt(10)
    v_mfma_f32_32x32x16_bf16 v[32:47], a[20:23], a[40:43], v[32:47]
    ds_read_b64_tr_b16 a[12:13], v253 offset:13312
    ds_read_b64_tr_b16 a[14:15], v253 offset:13824
    s_waitcnt lgkmcnt(10)
    v_mfma_f32_32x32x16_bf16 v[16:31], a[24:27], a[44:47], v[16:31]
    ds_read_b64_tr_b16 a[16:17], v253 offset:10240
    ds_read_b64_tr_b16 a[18:19], v253 offset:10752
    buffer_load_dwordx4 a[40:43], v1, s[8:11], s84 offen offset:2048 sc1
    v_cvt_pk_bf16_f32 v196, v60, v61
    v_cvt_pk_bf16_f32 v197, v62, v63
    v_cvt_pk_bf16_f32 v198, v76, v77
    v_cvt_pk_bf16_f32 v199, v78, v79
    s_add_u32 s35, s38, 4096
    s_mov_b64 exec, s[40:41]
    buffer_store_dwordx4 v[196:199], v1, s[8:11], s35 offen offset:3072 sc1
    s_mov_b64 exec, s[42:43]
    ds_write_b128 v230, v[196:199] offset:7168
    s_mov_b64 exec, -1
    s_waitcnt lgkmcnt(10)
    v_mfma_f32_32x32x16_bf16 v[32:47], a[28:31], a[44:47], v[32:47]
    ds_read_b64_tr_b16 a[20:21], v253 offset:14336
    ds_read_b64_tr_b16 a[22:23], v253 offset:14848
    s_waitcnt vmcnt(27)
    s_waitcnt lgkmcnt(10)
    v_mfma_f32_32x32x16_bf16 v[16:31], a[0:3], a[48:51], v[16:31]
    ds_read_b64_tr_b16 a[24:25], v253 offset:11264
    ds_read_b64_tr_b16 a[26:27], v253 offset:11776
    buffer_load_dwordx4 a[44:47], v1, s[8:11], s84 offen offset:3072 sc1
    s_add_u32 s84, s84, 4096
L_pad_13:
    s_cbranch_execz L_walk_done
    v_cvt_pk_bf16_f32 v152, v80, v81
    v_cvt_pk_bf16_f32 v153, v82, v83
    v_cvt_pk_bf16_f32 v154, v96, v97
    v_cvt_pk_bf16_f32 v155, v98, v99
    s_add_u32 s35, s39, 0
    buffer_store_dwordx4 v[152:155], v1, s[8:11], s35 offen offset:0 sc1
    s_waitcnt lgkmcnt(10)
    v_mfma_f32_32x32x16_bf16 v[32:47], a[4:7], a[48:51], v[32:47]
    ds_read_b64_tr_b16 a[28:29], v253 offset:15360
    ds_read_b64_tr_b16 a[30:31], v253 offset:15872
    s_barrier
    s_waitcnt lgkmcnt(10)
    v_mfma_f32_32x32x16_bf16 v[16:31], a[8:11], a[52:55], v[16:31]
    ds_read_b64_tr_b16 a[0:1], v253 offset:16384
    ds_read_b64_tr_b16 a[2:3], v253 offset:16896
    buffer_load_dwordx4 a[48:51], v1, s[8:11], s84 offen offset:0 sc1
    v_cvt_pk_bf16_f32 v168, v84, v85
    v_cvt_pk_bf16_f32 v169, v86, v87
    v_cvt_pk_bf16_f32 v170, v100, v101
    v_cvt_pk_bf16_f32 v171, v102, v103
    s_add_u32 s35, s39, 0
    buffer_store_dwordx4 v[168:171], v1, s[8:11], s35 offen offset:2048 sc1
    s_waitcnt lgkmcnt(10)
    v_mfma_f32_32x32x16_bf16 v[32:47], a[12:15], a[52:55], v[32:47]
    ds_read_b64_tr_b16 a[4:5], v253 offset:20480
    ds_read_b64_tr_b16 a[6:7], v253 offset:20992
    s_add_u32 m0, s86, 73728
    s_add_u32 s91, s85, 1179648
    buffer_load_dwordx4 v251, s[52:55], s91 offen offset:0 lds
    s_add_u32 m0, s86, 77760
    s_nop 0
    buffer_load_dwordx4 v251, s[52:55], s91 offen offset:64 lds
    s_waitcnt lgkmcnt(10)
    v_mfma_f32_32x32x16_bf16 v[16:31], a[16:19], a[56:59], v[16:31]
    ds_read_b64_tr_b16 a[8:9], v253 offset:17408
    ds_read_b64_tr_b16 a[10:11], v253 offset:17920
    buffer_load_dwordx4 a[52:55], v1, s[8:11], s84 offen offset:1024 sc1
    v_cvt_pk_bf16_f32 v184, v88, v89
    v_cvt_pk_bf16_f32 v185, v90, v91
    v_cvt_pk_bf16_f32 v186, v104, v105
    v_cvt_pk_bf16_f32 v187, v106, v107
    s_add_u32 s35, s39, 4096
    buffer_store_dwordx4 v[184:187], v1, s[8:11], s35 offen offset:0 sc1
    s_waitcnt lgkmcnt(10)
    v_mfma_f32_32x32x16_bf16 v[32:47], a[20:23], a[56:59], v[32:47]
    ds_read_b64_tr_b16 a[12:13], v253 offset:21504
    ds_read_b64_tr_b16 a[14:15], v253 offset:22016
    s_waitcnt lgkmcnt(10)
    v_mfma_f32_32x32x16_bf16 v[16:31], a[24:27], a[60:63], v[16:31]
    ds_read_b64_tr_b16 a[16:17], v253 offset:18432
    ds_read_b64_tr_b16 a[18:19], v253 offset:18944
    buffer_load_dwordx4 a[56:59], v1, s[8:11], s84 offen offset:2048 sc1
    v_cvt_pk_bf16_f32 v200, v92, v93
    v_cvt_pk_bf16_f32 v201, v94, v95
    v_cvt_pk_bf16_f32 v202, v108, v109
    v_cvt_pk_bf16_f32 v203, v110, v111
    s_add_u32 s35, s39, 4096
    buffer_store_dwordx4 v[200:203], v1, s[8:11], s35 offen offset:2048 sc1
    s_waitcnt lgkmcnt(10)
    v_mfma_f32_32x32x16_bf16 v[32:47], a[28:31], a[60:63], v[32:47]
    ds_read_b64_tr_b16 a[20:21], v253 offset:22528
    ds_read_b64_tr_b16 a[22:23], v253 offset:23040
    s_waitcnt vmcnt(31)
    s_waitcnt lgkmcnt(10)
    v_mfma_f32_32x32x16_bf16 v[16:31], a[0:3], a[64:67], v[16:31]
    ds_read_b64_tr_b16 a[24:25], v253 offset:19456
    ds_read_b64_tr_b16 a[26:27], v253 offset:19968
    buffer_load_dwordx4 a[60:63], v1, s[8:11], s84 offen offset:3072 sc1
    s_add_u32 s84, s84, 4096
    v_cvt_pk_bf16_f32 v156, v112, v113
    v_cvt_pk_bf16_f32 v157, v114, v115
    v_cvt_pk_bf16_f32 v158, v128, v129
    v_cvt_pk_bf16_f32 v159, v130, v131
    s_add_u32 s35, s39, 0
    buffer_store_dwordx4 v[156:159], v1, s[8:11], s35 offen offset:1024 sc1
    s_waitcnt lgkmcnt(10)
    v_mfma_f32_32x32x16_bf16 v[32:47], a[4:7], a[64:67], v[32:47]
    ds_read_b64_tr_b16 a[28:29], v253 offset:23552
    ds_read_b64_tr_b16 a[30:31], v253 offset:24064
    s_waitcnt lgkmcnt(10)
    v_mfma_f32_32x32x16_bf16 v[16:31], a[8:11], a[68:71], v[16:31]
    ds_read_b64_tr_b16 a[0:1], v253 offset:24576
    ds_read_b64_tr_b16 a[2:3], v253 offset:25088
    buffer_load_dwordx4 a[64:67], v1, s[8:11], s84 offen offset:0 sc1
    v_cvt_pk_bf16_f32 v172, v116, v117
    v_cvt_pk_bf16_f32 v173, v118, v119
    v_cvt_pk_bf16_f32 v174, v132, v133
    v_cvt_pk_bf16_f32 v175, v134, v135
    s_add_u32 s35, s39, 0
    buffer_store_dwordx4 v[172:175], v1, s[8:11], s35 offen offset:3072 sc1
    s_waitcnt lgkmcnt(10)
    v_mfma_f32_32x32x16_bf16 v[32:47], a[12:15], a[68:71], v[32:47]
    ds_read_b64_tr_b16 a[4:5], v253 offset:28672
    ds_read_b64_tr_b16 a[6:7], v253 offset:29184
    s_add_u32 m0, s86, 81920
    s_add_u32 s91, s85, 1310720
    buffer_load_dwordx4 v251, s[52:55], s91 offen offset:0 lds
    s_add_u32 m0, s86, 85952
    s_nop 0
    buffer_load_dwordx4 v251, s[52:55], s91 offen offset:64 lds
    s_waitcnt lgkmcnt(10)
    v_mfma_f32_32x32x16_bf16 v[16:31], a[16:19], a[72:75], v[16:31]
    ds_read_b64_tr_b16 a[8:9], v253 offset:25600
    ds_read_b64_tr_b16 a[10:11], v253 offset:26112
    buffer_load_dwordx4 a[68:71], v1, s[8:11], s84 offen offset:1024 sc1
    v_cvt_pk_bf16_f32 v188, v120, v121
    v_cvt_pk_bf16_f32 v189, v122, v123
    v_cvt_pk_bf16_f32 v190, v136, v137
    v_cvt_pk_bf16_f32 v191, v138, v139
    s_add_u32 s35, s39, 4096
    buffer_store_dwordx4 v[188:191], v1, s[8:11], s35 offen offset:1024 sc1
    s_waitcnt lgkmcnt(10)
    v_mfma_f32_32x32x16_bf16 v[32:47], a[20:23], a[72:75], v[32:47]
    ds_read_b64_tr_b16 a[12:13], v253 offset:29696
    ds_read_b64_tr_b16 a[14:15], v253 offset:30208
    s_waitcnt lgkmcnt(10)
    v_mfma_f32_32x32x16_bf16 v[16:31], a[24:27], a[76:79], v[16:31]
    ds_read_b64_tr_b16 a[16:17], v253 offset:26624
    ds_read_b64_tr_b16 a[18:19], v253 offset:27136
    buffer_load_dwordx4 a[72:75], v1, s[8:11], s84 offen offset:2048 sc1
    v_cvt_pk_bf16_f32 v204, v124, v125
    v_cvt_pk_bf16_f32 v205, v126, v127
    v_cvt_pk_bf16_f32 v206, v140, v141
    v_cvt_pk_bf16_f32 v207, v142, v143
    s_add_u32 s35, s39, 4096
    buffer_store_dwordx4 v[204:207], v1, s[8:11], s35 offen offset:3072 sc1
    s_waitcnt lgkmcnt(10)
    v_mfma_f32_32x32x16_bf16 v[32:47], a[28:31], a[76:79], v[32:47]
    ds_read_b64_tr_b16 a[20:21], v253 offset:30720
    ds_read_b64_tr_b16 a[22:23], v253 offset:31232
    s_waitcnt vmcnt(35)
    s_waitcnt lgkmcnt(10)
    v_mfma_f32_32x32x16_bf16 v[16:31], a[0:3], a[80:83], v[16:31]
    ds_read_b64_tr_b16 a[24:25], v253 offset:27648
    ds_read_b64_tr_b16 a[26:27], v253 offset:28160
    buffer_load_dwordx4 a[76:79], v1, s[8:11], s84 offen offset:3072 sc1
    s_add_u32 s84, s84, 4096
    s_mov_b32 s12, s100
    s_mov_b32 s13, s101
    s_mov_b32 s14, 2048
    s_mov_b32 s15, 0x00020000
    v_lshrrev_b32 v240, 5, v0
    v_lshlrev_b32 v240, 3, v240
    s_lshl_b32 s34, s82, 1
    s_add_u32 s34, s34, s83
    s_lshl_b32 s34, s34, 7
    buffer_load_dwordx2 v[112:113], v240, s[12:15], s34 offen offset:0
    buffer_load_dwordx2 v[114:115], v240, s[12:15], s34 offen offset:16
    buffer_load_dwordx2 v[116:117], v240, s[12:15], s34 offen offset:32
    buffer_load_dwordx2 v[118:119], v240, s[12:15], s34 offen offset:48
    buffer_load_dwordx2 v[120:121], v240, s[12:15], s34 offen offset:64
    buffer_load_dwordx2 v[122:123], v240, s[12:15], s34 offen offset:80
    buffer_load_dwordx2 v[124:125], v240, s[12:15], s34 offen offset:96
    buffer_load_dwordx2 v[126:127], v240, s[12:15], s34 offen offset:112
    s_waitcnt lgkmcnt(10)
    v_mfma_f32_32x32x16_bf16 v[32:47], a[4:7], a[80:83], v[32:47]
    ds_read_b64_tr_b16 a[28:29], v253 offset:31744
    ds_read_b64_tr_b16 a[30:31], v253 offset:32256
    s_barrier
    s_waitcnt lgkmcnt(10)
    v_mfma_f32_32x32x16_bf16 v[16:31], a[8:11], a[84:87], v[16:31]
    ds_read_b64_tr_b16 a[0:1], v253 offset:32768
    ds_read_b64_tr_b16 a[2:3], v253 offset:33280
    buffer_load_dwordx4 a[80:83], v1, s[8:11], s84 offen offset:0 sc1
    s_waitcnt lgkmcnt(10)
    v_mfma_f32_32x32x16_bf16 v[32:47], a[12:15], a[84:87], v[32:47]
    ds_read_b64_tr_b16 a[4:5], v253 offset:36864
    ds_read_b64_tr_b16 a[6:7], v253 offset:37376
    s_add_u32 m0, s86, 90112
    s_add_u32 s91, s85, 1441792
    buffer_load_dwordx4 v251, s[52:55], s91 offen offset:0 lds
    s_add_u32 m0, s86, 94144
    s_nop 0
    buffer_load_dwordx4 v251, s[52:55], s91 offen offset:64 lds
    s_waitcnt lgkmcnt(10)
    v_mfma_f32_32x32x16_bf16 v[16:31], a[16:19], a[88:91], v[16:31]
    ds_read_b64_tr_b16 a[8:9], v253 offset:33792
    ds_read_b64_tr_b16 a[10:11], v253 offset:34304
    buffer_load_dwordx4 a[84:87], v1, s[8:11], s84 offen offset:1024 sc1
    s_mov_b32 s12, s92
    s_mov_b32 s13, s93
    s_mov_b32 s14, 4194304
    s_mov_b32 s15, 0x00020000
    v_and_b32 v12, 31, v0
    v_mul_u32_u24 v12, 272, v12
    v_lshrrev_b32 v13, 5, v0
    v_lshl_add_u32 v12, v13, 4, v12
    s_mul_i32 s34, s3, 8704
    v_add_u32 v12, s34, v12
    v_lshrrev_b32 v13, 3, v0
    v_mul_u32_u24 v13, 272, v13
    v_and_b32 v14, 7, v0
    v_lshl_add_u32 v13, v14, 5, v13
    v_add_u32 v13, s34, v13
    s_waitcnt lgkmcnt(10)
    v_mfma_f32_32x32x16_bf16 v[32:47], a[20:23], a[88:91], v[32:47]
    ds_read_b64_tr_b16 a[12:13], v253 offset:37888
    ds_read_b64_tr_b16 a[14:15], v253 offset:38400
    s_waitcnt lgkmcnt(10)
    v_mfma_f32_32x32x16_bf16 v[16:31], a[24:27], a[92:95], v[16:31]
    ds_read_b64_tr_b16 a[16:17], v253 offset:34816
    ds_read_b64_tr_b16 a[18:19], v253 offset:35328
    buffer_load_dwordx4 a[88:91], v1, s[8:11], s84 offen offset:2048 sc1
    s_waitcnt lgkmcnt(10)
    v_mfma_f32_32x32x16_bf16 v[32:47], a[28:31], a[92:95], v[32:47]
    ds_read_b64_tr_b16 a[20:21], v253 offset:38912
    ds_read_b64_tr_b16 a[22:23], v253 offset:39424
    s_waitcnt vmcnt(43)
    s_waitcnt lgkmcnt(10)
    v_mfma_f32_32x32x16_bf16 v[16:31], a[0:3], a[96:99], v[16:31]
    ds_read_b64_tr_b16 a[24:25], v253 offset:35840
    ds_read_b64_tr_b16 a[26:27], v253 offset:36352
    buffer_load_dwordx4 a[92:95], v1, s[8:11], s84 offen offset:3072 sc1
    s_add_u32 s84, s84, 4096
    s_waitcnt lgkmcnt(10)
    v_mfma_f32_32x32x16_bf16 v[32:47], a[4:7], a[96:99], v[32:47]
    ds_read_b64_tr_b16 a[28:29], v253 offset:39936
    ds_read_b64_tr_b16 a[30:31], v253 offset:40448
    s_waitcnt vmcnt(15)
    s_barrier
    s_cmp_lg_u32 s3, 0
    s_cbranch_scc1 L_sig7
    v_mov_b32 v242, s61
    v_mov_b32 v243, 0
    s_mov_b64 exec, 1
    buffer_store_dword v242, v243, s[8:11], s60 offen sc1
    s_mov_b64 exec, -1
L_sig7:
    s_waitcnt lgkmcnt(10)
    v_mfma_f32_32x32x16_bf16 v[16:31], a[8:11], a[100:103], v[16:31]
    ds_read_b64_tr_b16 a[0:1], v253 offset:40960
    ds_read_b64_tr_b16 a[2:3], v253 offset:41472
    buffer_load_dwordx4 a[96:99], v1, s[8:11], s84 offen offset:0 sc1
    s_waitcnt lgkmcnt(10)
    v_mfma_f32_32x32x16_bf16 v[32:47], a[12:15], a[100:103], v[32:47]
    ds_read_b64_tr_b16 a[4:5], v253 offset:45056
    ds_read_b64_tr_b16 a[6:7], v253 offset:45568
    s_add_u32 m0, s86, 98304
    s_add_u32 s91, s85, 1572864
    buffer_load_dwordx4 v251, s[52:55], s91 offen offset:0 lds
    s_add_u32 m0, s86, 102336
    s_nop 0
    buffer_load_dwordx4 v251, s[52:55], s91 offen offset:64 lds
    s_waitcnt lgkmcnt(10)
    v_mfma_f32_32x32x16_bf16 v[16:31], a[16:19], a[104:107], v[16:31]
    ds_read_b64_tr_b16 a[8:9], v253 offset:41984
    ds_read_b64_tr_b16 a[10:11], v253 offset:42496
    buffer_load_dwordx4 a[100:103], v1, s[8:11], s84 offen offset:1024 sc1
    s_waitcnt lgkmcnt(10)
    v_mfma_f32_32x32x16_bf16 v[32:47], a[20:23], a[104:107], v[32:47]
    ds_read_b64_tr_b16 a[12:13], v253 offset:46080
    ds_read_b64_tr_b16 a[14:15], v253 offset:46592
    s_waitcnt lgkmcnt(10)
    v_mfma_f32_32x32x16_bf16 v[16:31], a[24:27], a[108:111], v[16:31]
    ds_read_b64_tr_b16 a[16:17], v253 offset:43008
    ds_read_b64_tr_b16 a[18:19], v253 offset:43520
    buffer_load_dwordx4 a[104:107], v1, s[8:11], s84 offen offset:2048 sc1
    s_waitcnt lgkmcnt(10)
    v_mfma_f32_32x32x16_bf16 v[32:47], a[28:31], a[108:111], v[32:47]
    ds_read_b64_tr_b16 a[20:21], v253 offset:47104
    ds_read_b64_tr_b16 a[22:23], v253 offset:47616
    s_waitcnt lgkmcnt(10)
    v_mfma_f32_32x32x16_bf16 v[16:31], a[0:3], a[112:115], v[16:31]
    ds_read_b64_tr_b16 a[24:25], v253 offset:44032
    ds_read_b64_tr_b16 a[26:27], v253 offset:44544
    buffer_load_dwordx4 a[108:111], v1, s[8:11], s84 offen offset:3072 sc1
    s_add_u32 s84, s84, 4096
    s_waitcnt lgkmcnt(10)
    v_mfma_f32_32x32x16_bf16 v[32:47], a[4:7], a[112:115], v[32:47]
    ds_read_b64_tr_b16 a[28:29], v253 offset:48128
    ds_read_b64_tr_b16 a[30:31], v253 offset:48640
    s_barrier
    s_waitcnt lgkmcnt(10)
    v_mfma_f32_32x32x16_bf16 v[16:31], a[8:11], a[116:119], v[16:31]
    ds_read_b64_tr_b16 a[0:1], v253 offset:49152
    ds_read_b64_tr_b16 a[2:3], v253 offset:49664
    buffer_load_dwordx4 a[112:115], v1, s[8:11], s84 offen offset:0 sc1
    s_waitcnt lgkmcnt(10)
    v_mfma_f32_32x32x16_bf16 v[32:47], a[12:15], a[116:119], v[32:47]
    ds_read_b64_tr_b16 a[4:5], v253 offset:53248
    ds_read_b64_tr_b16 a[6:7], v253 offset:53760
    s_add_u32 m0, s86, 106496
    s_add_u32 s91, s85, 1703936
    buffer_load_dwordx4 v251, s[52:55], s91 offen offset:0 lds
    s_add_u32 m0, s86, 110528
    s_nop 0
    buffer_load_dwordx4 v251, s[52:55], s91 offen offset:64 lds
    s_waitcnt lgkmcnt(10)
    v_mfma_f32_32x32x16_bf16 v[16:31], a[16:19], a[120:123], v[16:31]
    ds_read_b64_tr_b16 a[8:9], v253 offset:50176
    ds_read_b64_tr_b16 a[10:11], v253 offset:50688
    buffer_load_dwordx4 a[116:119], v1, s[8:11], s84 offen offset:1024 sc1
    s_waitcnt lgkmcnt(10)
    v_mfma_f32_32x32x16_bf16 v[32:47], a[20:23], a[120:123], v[32:47]
    ds_read_b64_tr_b16 a[12:13], v253 offset:54272
    ds_read_b64_tr_b16 a[14:15], v253 offset:54784
    s_waitcnt lgkmcnt(10)
    v_mfma_f32_32x32x16_bf16 v[16:31], a[24:27], a[124:127], v[16:31]
    ds_read_b64_tr_b16 a[16:17], v253 offset:51200
    ds_read_b64_tr_b16 a[18:19], v253 offset:51712
    buffer_load_dwordx4 a[120:123], v1, s[8:11], s84 offen offset:2048 sc1
    s_waitcnt lgkmcnt(10)
    v_mfma_f32_32x32x16_bf16 v[32:47], a[28:31], a[124:127], v[32:47]
    ds_read_b64_tr_b16 a[20:21], v253 offset:55296
    ds_read_b64_tr_b16 a[22:23], v253 offset:55808
    s_waitcnt lgkmcnt(10)
    v_mfma_f32_32x32x16_bf16 v[16:31], a[0:3], a[32:35], v[16:31]
    ds_read_b64_tr_b16 a[24:25], v253 offset:52224
    ds_read_b64_tr_b16 a[26:27], v253 offset:52736
    buffer_load_dwordx4 a[124:127], v1, s[8:11], s84 offen offset:3072 sc1
    s_add_u32 s84, s84, 4096
    s_waitcnt lgkmcnt(10)
    v_mfma_f32_32x32x16_bf16 v[32:47], a[4:7], a[32:35], v[32:47]
    ds_read_b64_tr_b16 a[28:29], v253 offset:56320
    ds_read_b64_tr_b16 a[30:31], v253 offset:56832
    s_waitcnt lgkmcnt(10)
    v_mfma_f32_32x32x16_bf16 v[16:31], a[8:11], a[36:39], v[16:31]
    ds_read_b64_tr_b16 a[0:1], v253 offset:57344
    ds_read_b64_tr_b16 a[2:3], v253 offset:57856
    buffer_load_dwordx4 a[32:35], v1, s[8:11], s84 offen offset:0 sc1
    s_waitcnt lgkmcnt(10)
    v_mfma_f32_32x32x16_bf16 v[32:47], a[12:15], a[36:39], v[32:47]
    ds_read_b64_tr_b16 a[4:5], v253 offset:61440
    ds_read_b64_tr_b16 a[6:7], v253 offset:61952
    s_add_u32 m0, s86, 114688
    s_add_u32 s91, s85, 1835008
    buffer_load_dwordx4 v251, s[52:55], s91 offen offset:0 lds
    s_add_u32 m0, s86, 118720
    s_nop 0
    buffer_load_dwordx4 v251, s[52:55], s91 offen offset:64 lds
    s_waitcnt lgkmcnt(10)
    v_mfma_f32_32x32x16_bf16 v[16:31], a[16:19], a[40:43], v[16:31]
    ds_read_b64_tr_b16 a[8:9], v253 offset:58368
    ds_read_b64_tr_b16 a[10:11], v253 offset:58880
    buffer_load_dwordx4 a[36:39], v1, s[8:11], s84 offen offset:1024 sc1
    s_waitcnt lgkmcnt(10)
    v_mfma_f32_32x32x16_bf16 v[32:47], a[20:23], a[40:43], v[32:47]
    ds_read_b64_tr_b16 a[12:13], v253 offset:62464
    ds_read_b64_tr_b16 a[14:15], v253 offset:62976
    s_waitcnt lgkmcnt(10)
    v_mfma_f32_32x32x16_bf16 v[16:31], a[24:27], a[44:47], v[16:31]
    ds_read_b64_tr_b16 a[16:17], v253 offset:59392
    ds_read_b64_tr_b16 a[18:19], v253 offset:59904
    buffer_load_dwordx4 a[40:43], v1, s[8:11], s84 offen offset:2048 sc1
    s_waitcnt lgkmcnt(10)
    v_mfma_f32_32x32x16_bf16 v[32:47], a[28:31], a[44:47], v[32:47]
    ds_read_b64_tr_b16 a[20:21], v253 offset:63488
    ds_read_b64_tr_b16 a[22:23], v253 offset:64000
    s_waitcnt lgkmcnt(10)
    v_mfma_f32_32x32x16_bf16 v[16:31], a[0:3], a[48:51], v[16:31]
    ds_read_b64_tr_b16 a[24:25], v253 offset:60416
    ds_read_b64_tr_b16 a[26:27], v253 offset:60928
    buffer_load_dwordx4 a[44:47], v1, s[8:11], s84 offen offset:3072 sc1
    s_add_u32 s84, s84, 4096
    s_waitcnt lgkmcnt(10)
    v_mfma_f32_32x32x16_bf16 v[32:47], a[4:7], a[48:51], v[32:47]
    ds_read_b64_tr_b16 a[28:29], v253 offset:64512
    ds_read_b64_tr_b16 a[30:31], v253 offset:65024
    s_barrier
    v_add_u32 v253, 65536, v253
    s_waitcnt lgkmcnt(10)
    v_mfma_f32_32x32x16_bf16 v[16:31], a[8:11], a[52:55], v[16:31]
    ds_read_b64_tr_b16 a[0:1], v253 offset:0
    ds_read_b64_tr_b16 a[2:3], v253 offset:512
    buffer_load_dwordx4 a[48:51], v1, s[8:11], s84 offen offset:0 sc1
    s_waitcnt lgkmcnt(10)
    v_mfma_f32_32x32x16_bf16 v[32:47], a[12:15], a[52:55], v[32:47]
    ds_read_b64_tr_b16 a[4:5], v253 offset:4096
    ds_read_b64_tr_b16 a[6:7], v253 offset:4608
    s_add_u32 m0, s86, 122880
    s_add_u32 s91, s85, 1966080
    buffer_load_dwordx4 v251, s[52:55], s91 offen offset:0 lds
    s_add_u32 m0, s86, 126912
    s_nop 0
    buffer_load_dwordx4 v251, s[52:55], s91 offen offset:64 lds
    s_waitcnt lgkmcnt(10)
    v_mfma_f32_32x32x16_bf16 v[16:31], a[16:19], a[56:59], v[16:31]
    ds_read_b64_tr_b16 a[8:9], v253 offset:1024
    ds_read_b64_tr_b16 a[10:11], v253 offset:1536
    buffer_load_dwordx4 a[52:55], v1, s[8:11], s84 offen offset:1024 sc1
    s_waitcnt lgkmcnt(10)
    v_mfma_f32_32x32x16_bf16 v[32:47], a[20:23], a[56:59], v[32:47]
    ds_read_b64_tr_b16 a[12:13], v253 offset:5120
    ds_read_b64_tr_b16 a[14:15], v253 offset:5632
    s_waitcnt lgkmcnt(10)
    v_mfma_f32_32x32x16_bf16 v[16:31], a[24:27], a[60:63], v[16:31]
    ds_read_b64_tr_b16 a[16:17], v253 offset:2048
    ds_read_b64_tr_b16 a[18:19], v253 offset:2560
    buffer_load_dwordx4 a[56:59], v1, s[8:11], s84 offen offset:2048 sc1
    s_waitcnt lgkmcnt(10)
    v_mfma_f32_32x32x16_bf16 v[32:47], a[28:31], a[60:63], v[32:47]
    ds_read_b64_tr_b16 a[20:21], v253 offset:6144
    ds_read_b64_tr_b16 a[22:23], v253 offset:6656
    s_waitcnt vmcnt(37)
    s_waitcnt lgkmcnt(10)
    v_mfma_f32_32x32x16_bf16 v[16:31], a[0:3], a[64:67], v[16:31]
    ds_read_b64_tr_b16 a[24:25], v253 offset:3072
    ds_read_b64_tr_b16 a[26:27], v253 offset:3584
    buffer_load_dwordx4 a[60:63], v1, s[8:11], s84 offen offset:3072 sc1
    s_add_u32 s84, s84, 4096
    s_waitcnt lgkmcnt(10)
    v_mfma_f32_32x32x16_bf16 v[32:47], a[4:7], a[64:67], v[32:47]
    ds_read_b64_tr_b16 a[28:29], v253 offset:7168
    ds_read_b64_tr_b16 a[30:31], v253 offset:7680
    s_waitcnt lgkmcnt(10)
    v_mfma_f32_32x32x16_bf16 v[16:31], a[8:11], a[68:71], v[16:31]
    ds_read_b64_tr_b16 a[0:1], v253 offset:8192
    ds_read_b64_tr_b16 a[2:3], v253 offset:8704
    buffer_load_dwordx4 a[64:67], v1, s[8:11], s84 offen offset:0 sc1
    s_waitcnt lgkmcnt(10)
    v_mfma_f32_32x32x16_bf16 v[32:47], a[12:15], a[68:71], v[32:47]
    ds_read_b64_tr_b16 a[4:5], v253 offset:12288
    ds_read_b64_tr_b16 a[6:7], v253 offset:12800
    s_waitcnt lgkmcnt(10)
    v_mfma_f32_32x32x16_bf16 v[16:31], a[16:19], a[72:75], v[16:31]
    ds_read_b64_tr_b16 a[8:9], v253 offset:9216
    ds_read_b64_tr_b16 a[10:11], v253 offset:9728
    buffer_load_dwordx4 a[68:71], v1, s[8:11], s84 offen offset:1024 sc1
    s_waitcnt lgkmcnt(10)
    v_mfma_f32_32x32x16_bf16 v[32:47], a[20:23], a[72:75], v[32:47]
    ds_read_b64_tr_b16 a[12:13], v253 offset:13312
    ds_read_b64_tr_b16 a[14:15], v253 offset:13824
    s_waitcnt lgkmcnt(10)
    v_mfma_f32_32x32x16_bf16 v[16:31], a[24:27], a[76:79], v[16:31]
    ds_read_b64_tr_b16 a[16:17], v253 offset:10240
    ds_read_b64_tr_b16 a[18:19], v253 offset:10752
    buffer_load_dwordx4 a[72:75], v1, s[8:11], s84 offen offset:2048 sc1
    s_waitcnt lgkmcnt(10)
    v_mfma_f32_32x32x16_bf16 v[32:47], a[28:31], a[76:79], v[32:47]
    ds_read_b64_tr_b16 a[20:21], v253 offset:14336
    ds_read_b64_tr_b16 a[22:23], v253 offset:14848
    s_waitcnt vmcnt(27)
    s_waitcnt lgkmcnt(10)
    v_mfma_f32_32x32x16_bf16 v[16:31], a[0:3], a[80:83], v[16:31]
    ds_read_b64_tr_b16 a[24:25], v253 offset:11264
    ds_read_b64_tr_b16 a[26:27], v253 offset:11776
    buffer_load_dwordx4 a[76:79], v1, s[8:11], s84 offen offset:3072 sc1
    s_add_u32 s84, s84, 4096
    s_waitcnt lgkmcnt(10)
    v_mfma_f32_32x32x16_bf16 v[32:47], a[4:7], a[80:83], v[32:47]
    ds_read_b64_tr_b16 a[28:29], v253 offset:15360
    ds_read_b64_tr_b16 a[30:31], v253 offset:15872
    s_barrier
    s_waitcnt lgkmcnt(10)
    v_mfma_f32_32x32x16_bf16 v[16:31], a[8:11], a[84:87], v[16:31]
    ds_read_b64_tr_b16 a[0:1], v253 offset:16384
    ds_read_b64_tr_b16 a[2:3], v253 offset:16896
    buffer_load_dwordx4 a[80:83], v1, s[8:11], s84 offen offset:0 sc1
    s_waitcnt lgkmcnt(10)
    v_mfma_f32_32x32x16_bf16 v[32:47], a[12:15], a[84:87], v[32:47]
    ds_read_b64_tr_b16 a[4:5], v253 offset:20480
    ds_read_b64_tr_b16 a[6:7], v253 offset:20992
    s_waitcnt lgkmcnt(10)
    v_mfma_f32_32x32x16_bf16 v[16:31], a[16:19], a[88:91], v[16:31]
    ds_read_b64_tr_b16 a[8:9], v253 offset:17408
    ds_read_b64_tr_b16 a[10:11], v253 offset:17920
    buffer_load_dwordx4 a[84:87], v1, s[8:11], s84 offen offset:1024 sc1
    s_waitcnt lgkmcnt(10)
    v_mfma_f32_32x32x16_bf16 v[32:47], a[20:23], a[88:91], v[32:47]
    ds_read_b64_tr_b16 a[12:13], v253 offset:21504
    ds_read_b64_tr_b16 a[14:15], v253 offset:22016
    s_waitcnt lgkmcnt(10)
    v_mfma_f32_32x32x16_bf16 v[16:31], a[24:27], a[92:95], v[16:31]
    ds_read_b64_tr_b16 a[16:17], v253 offset:18432
    ds_read_b64_tr_b16 a[18:19], v253 offset:18944
    buffer_load_dwordx4 a[88:91], v1, s[8:11], s84 offen offset:2048 sc1
    s_waitcnt lgkmcnt(10)
    v_mfma_f32_32x32x16_bf16 v[32:47], a[28:31], a[92:95], v[32:47]
    ds_read_b64_tr_b16 a[20:21], v253 offset:22528
    ds_read_b64_tr_b16 a[22:23], v253 offset:23040
    s_waitcnt vmcnt(25)
    s_waitcnt lgkmcnt(10)
    v_mfma_f32_32x32x16_bf16 v[16:31], a[0:3], a[96:99], v[16:31]
    ds_read_b64_tr_b16 a[24:25], v253 offset:19456
    ds_read_b64_tr_b16 a[26:27], v253 offset:19968
    buffer_load_dwordx4 a[92:95], v1, s[8:11], s84 offen offset:3072 sc1
    s_add_u32 s84, s84, 4096
    s_waitcnt lgkmcnt(10)
    v_mfma_f32_32x32x16_bf16 v[32:47], a[4:7], a[96:99], v[32:47]
    ds_read_b64_tr_b16 a[28:29], v253 offset:23552
    ds_read_b64_tr_b16 a[30:31], v253 offset:24064
    s_waitcnt lgkmcnt(10)
    v_mfma_f32_32x32x16_bf16 v[16:31], a[8:11], a[100:103], v[16:31]
    ds_read_b64_tr_b16 a[0:1], v253 offset:24576
    ds_read_b64_tr_b16 a[2:3], v253 offset:25088
    s_waitcnt lgkmcnt(10)
    v_mfma_f32_32x32x16_bf16 v[32:47], a[12:15], a[100:103], v[32:47]
    ds_read_b64_tr_b16 a[4:5], v253 offset:28672
    ds_read_b64_tr_b16 a[6:7], v253 offset:29184
    s_waitcnt lgkmcnt(10)
    v_mfma_f32_32x32x16_bf16 v[16:31], a[16:19], a[104:107], v[16:31]
    ds_read_b64_tr_b16 a[8:9], v253 offset:25600
    ds_read_b64_tr_b16 a[10:11], v253 offset:26112
    s_waitcnt lgkmcnt(10)
    v_mfma_f32_32x32x16_bf16 v[32:47], a[20:23], a[104:107], v[32:47]
    ds_read_b64_tr_b16 a[12:13], v253 offset:29696
    ds_read_b64_tr_b16 a[14:15], v253 offset:30208
    s_waitcnt lgkmcnt(10)
    v_mfma_f32_32x32x16_bf16 v[16:31], a[24:27], a[108:111], v[16:31]
    ds_read_b64_tr_b16 a[16:17], v253 offset:26624
    ds_read_b64_tr_b16 a[18:19], v253 offset:27136
    s_waitcnt lgkmcnt(10)
    v_mfma_f32_32x32x16_bf16 v[32:47], a[28:31], a[108:111], v[32:47]
    ds_read_b64_tr_b16 a[20:21], v253 offset:30720
    ds_read_b64_tr_b16 a[22:23], v253 offset:31232
    s_waitcnt vmcnt(20)
    s_waitcnt lgkmcnt(10)
    v_mfma_f32_32x32x16_bf16 v[16:31], a[0:3], a[112:115], v[16:31]
    ds_read_b64_tr_b16 a[24:25], v253 offset:27648
    ds_read_b64_tr_b16 a[26:27], v253 offset:28160
    s_waitcnt lgkmcnt(10)
    v_mfma_f32_32x32x16_bf16 v[32:47], a[4:7], a[112:115], v[32:47]
    ds_read_b64_tr_b16 a[28:29], v253 offset:31744
    ds_read_b64_tr_b16 a[30:31], v253 offset:32256
    s_barrier
    v_min_u32 v243, 3, v0
    v_lshlrev_b32 v243, 2, v243
    buffer_load_dword v242, v243, s[8:11], s64 offen sc1
    s_waitcnt lgkmcnt(10)
    v_mfma_f32_32x32x16_bf16 v[16:31], a[8:11], a[116:119], v[16:31]
    ds_read_b64_tr_b16 a[0:1], v253 offset:32768
    ds_read_b64_tr_b16 a[2:3], v253 offset:33280
    s_waitcnt lgkmcnt(10)
    v_mfma_f32_32x32x16_bf16 v[32:47], a[12:15], a[116:119], v[32:47]
    ds_read_b64_tr_b16 a[4:5], v253 offset:36864
    ds_read_b64_tr_b16 a[6:7], v253 offset:37376
    s_waitcnt lgkmcnt(10)
    v_mfma_f32_32x32x16_bf16 v[16:31], a[16:19], a[120:123], v[16:31]
    ds_read_b64_tr_b16 a[8:9], v253 offset:33792
    ds_read_b64_tr_b16 a[10:11], v253 offset:34304
    s_waitcnt lgkmcnt(10)
    v_mfma_f32_32x32x16_bf16 v[32:47], a[20:23], a[120:123], v[32:47]
    ds_read_b64_tr_b16 a[12:13], v253 offset:37888
    ds_read_b64_tr_b16 a[14:15], v253 offset:38400
    s_waitcnt lgkmcnt(10)
    v_mfma_f32_32x32x16_bf16 v[16:31], a[24:27], a[124:127], v[16:31]
    ds_read_b64_tr_b16 a[16:17], v253 offset:34816
    ds_read_b64_tr_b16 a[18:19], v253 offset:35328
    s_waitcnt lgkmcnt(10)
    v_mfma_f32_32x32x16_bf16 v[32:47], a[28:31], a[124:127], v[32:47]
    ds_read_b64_tr_b16 a[20:21], v253 offset:38912
    ds_read_b64_tr_b16 a[22:23], v253 offset:39424
    s_waitcnt vmcnt(15)
    s_waitcnt lgkmcnt(10)
    v_mfma_f32_32x32x16_bf16 v[16:31], a[0:3], a[32:35], v[16:31]
    ds_read_b64_tr_b16 a[24:25], v253 offset:35840
    ds_read_b64_tr_b16 a[26:27], v253 offset:36352
    s_waitcnt lgkmcnt(10)
    v_mfma_f32_32x32x16_bf16 v[32:47], a[4:7], a[32:35], v[32:47]
    ds_read_b64_tr_b16 a[28:29], v253 offset:39936
    ds_read_b64_tr_b16 a[30:31], v253 offset:40448
    s_waitcnt lgkmcnt(10)
    v_mfma_f32_32x32x16_bf16 v[16:31], a[8:11], a[36:39], v[16:31]
    ds_read_b64_tr_b16 a[0:1], v253 offset:40960
    ds_read_b64_tr_b16 a[2:3], v253 offset:41472
    s_waitcnt lgkmcnt(10)
    v_mfma_f32_32x32x16_bf16 v[32:47], a[12:15], a[36:39], v[32:47]
    ds_read_b64_tr_b16 a[4:5], v253 offset:45056
    ds_read_b64_tr_b16 a[6:7], v253 offset:45568
    s_waitcnt lgkmcnt(10)
    v_mfma_f32_32x32x16_bf16 v[16:31], a[16:19], a[40:43], v[16:31]
    ds_read_b64_tr_b16 a[8:9], v253 offset:41984
    ds_read_b64_tr_b16 a[10:11], v253 offset:42496
    s_waitcnt lgkmcnt(10)
    v_mfma_f32_32x32x16_bf16 v[32:47], a[20:23], a[40:43], v[32:47]
    ds_read_b64_tr_b16 a[12:13], v253 offset:46080
    ds_read_b64_tr_b16 a[14:15], v253 offset:46592
    s_waitcnt lgkmcnt(10)
    v_mfma_f32_32x32x16_bf16 v[16:31], a[24:27], a[44:47], v[16:31]
    ds_read_b64_tr_b16 a[16:17], v253 offset:43008
    ds_read_b64_tr_b16 a[18:19], v253 offset:43520
    s_waitcnt lgkmcnt(10)
    v_mfma_f32_32x32x16_bf16 v[32:47], a[28:31], a[44:47], v[32:47]
    ds_read_b64_tr_b16 a[20:21], v253 offset:47104
    ds_read_b64_tr_b16 a[22:23], v253 offset:47616
    s_waitcnt vmcnt(9)
    s_waitcnt lgkmcnt(10)
    v_mfma_f32_32x32x16_bf16 v[16:31], a[0:3], a[48:51], v[16:31]
    ds_read_b64_tr_b16 a[24:25], v253 offset:44032
    ds_read_b64_tr_b16 a[26:27], v253 offset:44544
    s_waitcnt lgkmcnt(10)
    v_mfma_f32_32x32x16_bf16 v[32:47], a[4:7], a[48:51], v[32:47]
    ds_read_b64_tr_b16 a[28:29], v253 offset:48128
    ds_read_b64_tr_b16 a[30:31], v253 offset:48640
    s_barrier
    s_waitcnt vmcnt(0)
    v_cmp_ne_u32 vcc, s61, v242
    s_nop 0
    s_cbranch_vccz L_apoll8_ok
L_pad_14:
    s_cbranch_execz L_walk_done
    s_mov_b32 s34, 0x40000
L_apoll8:
    s_sleep 1
    buffer_load_dword v242, v243, s[8:11], s64 offen sc1
    s_waitcnt vmcnt(0)
    v_cmp_ne_u32 vcc, s61, v242
    s_sub_u32 s34, s34, 1
    s_cbranch_scc1 L_apoll8_ok
    s_nop 0
    s_cbranch_vccnz L_apoll8
L_apoll8_ok:
    v_bfe_u32 v230, v0, 4, 1
    v_lshlrev_b32 v230, 11, v230
    v_and_b32 v231, 15, v0
    v_lshl_add_u32 v230, v231, 4, v230
    v_lshrrev_b32 v231, 5, v0
    v_lshl_add_u32 v230, v231, 8, v230
    s_lshl_b32 s34, s7, 3
    s_add_u32 s34, s34, s56
    s_lshl_b32 s34, s34, 2
    s_add_u32 s34, s34, s6
    s_lshl_b32 s34, s34, 16
    s_lshl_b32 s35, s3, 12
    s_add_u32 s34, s34, s35
    s_add_u32 s34, s34, 32505856
    s_add_u32 s35, s6, 1
    s_and_b32 s35, s35, 3
    s_lshl_b32 s35, s35, 14
    s_add_u32 s35, s35, s34
    buffer_load_dwordx4 v[64:67], v230, s[8:11], s35 offen offset:0 sc1
    buffer_load_dwordx4 v[68:71], v230, s[8:11], s35 offen offset:512 sc1
    buffer_load_dwordx4 v[72:75], v230, s[8:11], s35 offen offset:1024 sc1
    buffer_load_dwordx4 v[76:79], v230, s[8:11], s35 offen offset:1536 sc1
    s_add_u32 s35, s6, 2
    s_and_b32 s35, s35, 3
    s_lshl_b32 s35, s35, 14
    s_add_u32 s35, s35, s34
    buffer_load_dwordx4 v[80:83], v230, s[8:11], s35 offen offset:0 sc1
    buffer_load_dwordx4 v[84:87], v230, s[8:11], s35 offen offset:512 sc1
    buffer_load_dwordx4 v[88:91], v230, s[8:11], s35 offen offset:1024 sc1
    buffer_load_dwordx4 v[92:95], v230, s[8:11], s35 offen offset:1536 sc1
    s_add_u32 s35, s6, 3
    s_and_b32 s35, s35, 3
    s_lshl_b32 s35, s35, 14
    s_add_u32 s35, s35, s34
    buffer_load_dwordx4 v[96:99], v230, s[8:11], s35 offen offset:0 sc1
    buffer_load_dwordx4 v[100:103], v230, s[8:11], s35 offen offset:512 sc1
    buffer_load_dwordx4 v[104:107], v230, s[8:11], s35 offen offset:1024 sc1
    buffer_load_dwordx4 v[108:111], v230, s[8:11], s35 offen offset:1536 sc1
    s_lshl_b32 s35, s3, 12
    s_add_u32 s35, s35, 147456
    v_add_u32 v231, s35, v230
    ds_read_b128 v[48:51], v231 offset:0
    ds_read_b128 v[52:55], v231 offset:512
    ds_read_b128 v[56:59], v231 offset:1024
    ds_read_b128 v[60:63], v231 offset:1536
    s_waitcnt lgkmcnt(14)
    v_mfma_f32_32x32x16_bf16 v[16:31], a[8:11], a[52:55], v[16:31]
    ds_read_b64_tr_b16 a[0:1], v253 offset:49152
    ds_read_b64_tr_b16 a[2:3], v253 offset:49664
    s_waitcnt lgkmcnt(14)
    v_mfma_f32_32x32x16_bf16 v[32:47], a[12:15], a[52:55], v[32:47]
    ds_read_b64_tr_b16 a[4:5], v253 offset:53248
    ds_read_b64_tr_b16 a[6:7], v253 offset:53760
    s_waitcnt lgkmcnt(14)
    v_mfma_f32_32x32x16_bf16 v[16:31], a[16:19], a[56:59], v[16:31]
    ds_read_b64_tr_b16 a[8:9], v253 offset:50176
    ds_read_b64_tr_b16 a[10:11], v253 offset:50688
    s_waitcnt lgkmcnt(14)
    v_mfma_f32_32x32x16_bf16 v[32:47], a[20:23], a[56:59], v[32:47]
    ds_read_b64_tr_b16 a[12:13], v253 offset:54272
    ds_read_b64_tr_b16 a[14:15], v253 offset:54784
    s_waitcnt lgkmcnt(14)
    v_mfma_f32_32x32x16_bf16 v[16:31], a[24:27], a[60:63], v[16:31]
    ds_read_b64_tr_b16 a[16:17], v253 offset:51200
    ds_read_b64_tr_b16 a[18:19], v253 offset:51712
    s_waitcnt lgkmcnt(14)
    v_mfma_f32_32x32x16_bf16 v[32:47], a[28:31], a[60:63], v[32:47]
    ds_read_b64_tr_b16 a[20:21], v253 offset:55296
    ds_read_b64_tr_b16 a[22:23], v253 offset:55808
    s_waitcnt lgkmcnt(10)
    v_mfma_f32_32x32x16_bf16 v[16:31], a[0:3], a[64:67], v[16:31]
    ds_read_b64_tr_b16 a[24:25], v253 offset:52224
    ds_read_b64_tr_b16 a[26:27], v253 offset:52736
    s_waitcnt lgkmcnt(10)
    v_mfma_f32_32x32x16_bf16 v[32:47], a[4:7], a[64:67], v[32:47]
    ds_read_b64_tr_b16 a[28:29], v253 offset:56320
    ds_read_b64_tr_b16 a[30:31], v253 offset:56832
    s_waitcnt lgkmcnt(10)
    v_mfma_f32_32x32x16_bf16 v[16:31], a[8:11], a[68:71], v[16:31]
    ds_read_b64_tr_b16 a[0:1], v253 offset:57344
    ds_read_b64_tr_b16 a[2:3], v253 offset:57856
    s_waitcnt lgkmcnt(10)
    v_mfma_f32_32x32x16_bf16 v[32:47], a[12:15], a[68:71], v[32:47]
    ds_read_b64_tr_b16 a[4:5], v253 offset:61440
    ds_read_b64_tr_b16 a[6:7], v253 offset:61952
    s_waitcnt lgkmcnt(10)
    v_mfma_f32_32x32x16_bf16 v[16:31], a[16:19], a[72:75], v[16:31]
    ds_read_b64_tr_b16 a[8:9], v253 offset:58368
    ds_read_b64_tr_b16 a[10:11], v253 offset:58880
    s_waitcnt lgkmcnt(10)
    v_mfma_f32_32x32x16_bf16 v[32:47], a[20:23], a[72:75], v[32:47]
    ds_read_b64_tr_b16 a[12:13], v253 offset:62464
    ds_read_b64_tr_b16 a[14:15], v253 offset:62976
    s_waitcnt lgkmcnt(10)
    v_mfma_f32_32x32x16_bf16 v[16:31], a[24:27], a[76:79], v[16:31]
    ds_read_b64_tr_b16 a[16:17], v253 offset:59392
    ds_read_b64_tr_b16 a[18:19], v253 offset:59904
    s_waitcnt lgkmcnt(10)
    v_mfma_f32_32x32x16_bf16 v[32:47], a[28:31], a[76:79], v[32:47]
    ds_read_b64_tr_b16 a[20:21], v253 offset:63488
    ds_read_b64_tr_b16 a[22:23], v253 offset:64000
    s_waitcnt lgkmcnt(10)
    v_mfma_f32_32x32x16_bf16 v[16:31], a[0:3], a[80:83], v[16:31]
    ds_read_b64_tr_b16 a[24:25], v253 offset:60416
    ds_read_b64_tr_b16 a[26:27], v253 offset:60928
    s_waitcnt lgkmcnt(10)
    v_mfma_f32_32x32x16_bf16 v[32:47], a[4:7], a[80:83], v[32:47]
    ds_read_b64_tr_b16 a[28:29], v253 offset:64512
    ds_read_b64_tr_b16 a[30:31], v253 offset:65024
    s_waitcnt lgkmcnt(10)
    v_mfma_f32_32x32x16_bf16 v[16:31], a[8:11], a[84:87], v[16:31]
    s_waitcnt lgkmcnt(8)
    v_mfma_f32_32x32x16_bf16 v[32:47], a[12:15], a[84:87], v[32:47]
    s_waitcnt lgkmcnt(6)
    v_mfma_f32_32x32x16_bf16 v[16:31], a[16:19], a[88:91], v[16:31]
    s_waitcnt lgkmcnt(4)
    v_mfma_f32_32x32x16_bf16 v[32:47], a[20:23], a[88:91], v[32:47]
    s_waitcnt lgkmcnt(2)
    v_mfma_f32_32x32x16_bf16 v[16:31], a[24:27], a[92:95], v[16:31]
    s_waitcnt lgkmcnt(0)
    v_mfma_f32_32x32x16_bf16 v[32:47], a[28:31], a[92:95], v[32:47]
    v_lshlrev_b32 v144, 16, v112
    v_and_b32 v145, 0xffff0000, v112
    v_lshlrev_b32 v146, 16, v113
    v_and_b32 v147, 0xffff0000, v113
    v_lshlrev_b32 v148, 16, v114
    v_and_b32 v149, 0xffff0000, v114
    v_lshlrev_b32 v150, 16, v115
    v_and_b32 v151, 0xffff0000, v115
    v_lshlrev_b32 v152, 16, v116
    v_and_b32 v153, 0xffff0000, v116
    v_lshlrev_b32 v154, 16, v117
    v_and_b32 v155, 0xffff0000, v117
    v_lshlrev_b32 v156, 16, v118
    v_and_b32 v157, 0xffff0000, v118
    v_lshlrev_b32 v158, 16, v119
    v_and_b32 v159, 0xffff0000, v119
    v_lshlrev_b32 v160, 16, v120
    v_and_b32 v161, 0xffff0000, v120
    v_lshlrev_b32 v162, 16, v121
    v_and_b32 v163, 0xffff0000, v121
    v_lshlrev_b32 v164, 16, v122
    v_and_b32 v165, 0xffff0000, v122
    v_lshlrev_b32 v166, 16, v123
    v_and_b32 v167, 0xffff0000, v123
    v_lshlrev_b32 v168, 16, v124
    v_and_b32 v169, 0xffff0000, v124
    v_lshlrev_b32 v170, 16, v125
    v_and_b32 v171, 0xffff0000, v125
    v_lshlrev_b32 v172, 16, v126
    v_and_b32 v173, 0xffff0000, v126
    v_lshlrev_b32 v174, 16, v127
    v_and_b32 v175, 0xffff0000, v127
    s_waitcnt lgkmcnt(0)
    v_lshlrev_b32 v128, 16, v48
    v_and_b32 v129, 0xffff0000, v48
    v_lshlrev_b32 v130, 16, v49
    v_and_b32 v131, 0xffff0000, v49
    v_pk_add_f32 v[144:145], v[144:145], v[128:129]
    v_pk_add_f32 v[146:147], v[146:147], v[130:131]
    v_lshlrev_b32 v132, 16, v52
    v_and_b32 v133, 0xffff0000, v52
    v_lshlrev_b32 v134, 16, v53
    v_and_b32 v135, 0xffff0000, v53
    v_pk_add_f32 v[148:149], v[148:149], v[132:133]
    v_pk_add_f32 v[150:151], v[150:151], v[134:135]
    v_lshlrev_b32 v128, 16, v50
    v_and_b32 v129, 0xffff0000, v50
    v_lshlrev_b32 v130, 16, v51
    v_and_b32 v131, 0xffff0000, v51
    v_pk_add_f32 v[152:153], v[152:153], v[128:129]
    v_pk_add_f32 v[154:155], v[154:155], v[130:131]
    v_lshlrev_b32 v132, 16, v54
    v_and_b32 v133, 0xffff0000, v54
    v_lshlrev_b32 v134, 16, v55
    v_and_b32 v135, 0xffff0000, v55
    v_pk_add_f32 v[156:157], v[156:157], v[132:133]
    v_pk_add_f32 v[158:159], v[158:159], v[134:135]
    v_lshlrev_b32 v128, 16, v56
    v_and_b32 v129, 0xffff0000, v56
    v_lshlrev_b32 v130, 16, v57
    v_and_b32 v131, 0xffff0000, v57
    v_pk_add_f32 v[160:161], v[160:161], v[128:129]
    v_pk_add_f32 v[162:163], v[162:163], v[130:131]
    v_lshlrev_b32 v132, 16, v60
    v_and_b32 v133, 0xffff0000, v60
    v_lshlrev_b32 v134, 16, v61
    v_and_b32 v135, 0xffff0000, v61
    v_pk_add_f32 v[164:165], v[164:165], v[132:133]
    v_pk_add_f32 v[166:167], v[166:167], v[134:135]
    v_lshlrev_b32 v128, 16, v58
    v_and_b32 v129, 0xffff0000, v58
    v_lshlrev_b32 v130, 16, v59
    v_and_b32 v131, 0xffff0000, v59
    v_pk_add_f32 v[168:169], v[168:169], v[128:129]
    v_pk_add_f32 v[170:171], v[170:171], v[130:131]
    v_lshlrev_b32 v132, 16, v62
    v_and_b32 v133, 0xffff0000, v62
    v_lshlrev_b32 v134, 16, v63
    v_and_b32 v135, 0xffff0000, v63
    v_pk_add_f32 v[172:173], v[172:173], v[132:133]
    v_pk_add_f32 v[174:175], v[174:175], v[134:135]
    s_waitcnt vmcnt(8)
    v_lshlrev_b32 v128, 16, v64
    v_and_b32 v129, 0xffff0000, v64
    v_lshlrev_b32 v130, 16, v65
    v_and_b32 v131, 0xffff0000, v65
    v_pk_add_f32 v[144:145], v[144:145], v[128:129]
    v_pk_add_f32 v[146:147], v[146:147], v[130:131]
    v_lshlrev_b32 v132, 16, v68
    v_and_b32 v133, 0xffff0000, v68
    v_lshlrev_b32 v134, 16, v69
    v_and_b32 v135, 0xffff0000, v69
    v_pk_add_f32 v[148:149], v[148:149], v[132:133]
    v_pk_add_f32 v[150:151], v[150:151], v[134:135]
    v_lshlrev_b32 v128, 16, v66
    v_and_b32 v129, 0xffff0000, v66
    v_lshlrev_b32 v130, 16, v67
    v_and_b32 v131, 0xffff0000, v67
    v_pk_add_f32 v[152:153], v[152:153], v[128:129]
    v_pk_add_f32 v[154:155], v[154:155], v[130:131]
    v_lshlrev_b32 v132, 16, v70
    v_and_b32 v133, 0xffff0000, v70
    v_lshlrev_b32 v134, 16, v71
    v_and_b32 v135, 0xffff0000, v71
    v_pk_add_f32 v[156:157], v[156:157], v[132:133]
    v_pk_add_f32 v[158:159], v[158:159], v[134:135]
    v_lshlrev_b32 v128, 16, v72
    v_and_b32 v129, 0xffff0000, v72
    v_lshlrev_b32 v130, 16, v73
    v_and_b32 v131, 0xffff0000, v73
    v_pk_add_f32 v[160:161], v[160:161], v[128:129]
    v_pk_add_f32 v[162:163], v[162:163], v[130:131]
    v_lshlrev_b32 v132, 16, v76
    v_and_b32 v133, 0xffff0000, v76
    v_lshlrev_b32 v134, 16, v77
    v_and_b32 v135, 0xffff0000, v77
    v_pk_add_f32 v[164:165], v[164:165], v[132:133]
    v_pk_add_f32 v[166:167], v[166:167], v[134:135]
    v_lshlrev_b32 v128, 16, v74
    v_and_b32 v129, 0xffff0000, v74
    v_lshlrev_b32 v130, 16, v75
    v_and_b32 v131, 0xffff0000, v75
    v_pk_add_f32 v[168:169], v[168:169], v[128:129]
    v_pk_add_f32 v[170:171], v[170:171], v[130:131]
    v_lshlrev_b32 v132, 16, v78
    v_and_b32 v133, 0xffff0000, v78
    v_lshlrev_b32 v134, 16, v79
    v_and_b32 v135, 0xffff0000, v79
    v_pk_add_f32 v[172:173], v[172:173], v[132:133]
    v_pk_add_f32 v[174:175], v[174:175], v[134:135]
    s_waitcnt vmcnt(4)
    v_lshlrev_b32 v128, 16, v80
    v_and_b32 v129, 0xffff0000, v80
    v_lshlrev_b32 v130, 16, v81
    v_and_b32 v131, 0xffff0000, v81
    v_pk_add_f32 v[144:145], v[144:145], v[128:129]
    v_pk_add_f32 v[146:147], v[146:147], v[130:131]
    v_lshlrev_b32 v132, 16, v84
    v_and_b32 v133, 0xffff0000, v84
    v_lshlrev_b32 v134, 16, v85
    v_and_b32 v135, 0xffff0000, v85
    v_pk_add_f32 v[148:149], v[148:149], v[132:133]
    v_pk_add_f32 v[150:151], v[150:151], v[134:135]
    v_lshlrev_b32 v128, 16, v82
    v_and_b32 v129, 0xffff0000, v82
    v_lshlrev_b32 v130, 16, v83
    v_and_b32 v131, 0xffff0000, v83
    v_pk_add_f32 v[152:153], v[152:153], v[128:129]
    v_pk_add_f32 v[154:155], v[154:155], v[130:131]
    v_lshlrev_b32 v132, 16, v86
    v_and_b32 v133, 0xffff0000, v86
    v_lshlrev_b32 v134, 16, v87
    v_and_b32 v135, 0xffff0000, v87
    v_pk_add_f32 v[156:157], v[156:157], v[132:133]
    v_pk_add_f32 v[158:159], v[158:159], v[134:135]
    v_lshlrev_b32 v128, 16, v88
    v_and_b32 v129, 0xffff0000, v88
    v_lshlrev_b32 v130, 16, v89
    v_and_b32 v131, 0xffff0000, v89
    v_pk_add_f32 v[160:161], v[160:161], v[128:129]
    v_pk_add_f32 v[162:163], v[162:163], v[130:131]
    v_lshlrev_b32 v132, 16, v92
    v_and_b32 v133, 0xffff0000, v92
    v_lshlrev_b32 v134, 16, v93
    v_and_b32 v135, 0xffff0000, v93
    v_pk_add_f32 v[164:165], v[164:165], v[132:133]
    v_pk_add_f32 v[166:167], v[166:167], v[134:135]
    v_lshlrev_b32 v128, 16, v90
    v_and_b32 v129, 0xffff0000, v90
    v_lshlrev_b32 v130, 16, v91
    v_and_b32 v131, 0xffff0000, v91
    v_pk_add_f32 v[168:169], v[168:169], v[128:129]
    v_pk_add_f32 v[170:171], v[170:171], v[130:131]
    v_lshlrev_b32 v132, 16, v94
    v_and_b32 v133, 0xffff0000, v94
    v_lshlrev_b32 v134, 16, v95
    v_and_b32 v135, 0xffff0000, v95
    v_pk_add_f32 v[172:173], v[172:173], v[132:133]
    v_pk_add_f32 v[174:175], v[174:175], v[134:135]
    s_waitcnt vmcnt(0)
    v_lshlrev_b32 v128, 16, v96
    v_and_b32 v129, 0xffff0000, v96
    v_lshlrev_b32 v130, 16, v97
    v_and_b32 v131, 0xffff0000, v97
    v_pk_add_f32 v[144:145], v[144:145], v[128:129]
    v_pk_add_f32 v[146:147], v[146:147], v[130:131]
    v_lshlrev_b32 v132, 16, v100
    v_and_b32 v133, 0xffff0000, v100
    v_lshlrev_b32 v134, 16, v101
    v_and_b32 v135, 0xffff0000, v101
    v_pk_add_f32 v[148:149], v[148:149], v[132:133]
    v_pk_add_f32 v[150:151], v[150:151], v[134:135]
    v_lshlrev_b32 v128, 16, v98
    v_and_b32 v129, 0xffff0000, v98
    v_lshlrev_b32 v130, 16, v99
    v_and_b32 v131, 0xffff0000, v99
    v_pk_add_f32 v[152:153], v[152:153], v[128:129]
    v_pk_add_f32 v[154:155], v[154:155], v[130:131]
    v_lshlrev_b32 v132, 16, v102
    v_and_b32 v133, 0xffff0000, v102
    v_lshlrev_b32 v134, 16, v103
    v_and_b32 v135, 0xffff0000, v103
    v_pk_add_f32 v[156:157], v[156:157], v[132:133]
    v_pk_add_f32 v[158:159], v[158:159], v[134:135]
    v_lshlrev_b32 v128, 16, v104
    v_and_b32 v129, 0xffff0000, v104
    v_lshlrev_b32 v130, 16, v105
    v_and_b32 v131, 0xffff0000, v105
    v_pk_add_f32 v[160:161], v[160:161], v[128:129]
    v_pk_add_f32 v[162:163], v[162:163], v[130:131]
    v_lshlrev_b32 v132, 16, v108
    v_and_b32 v133, 0xffff0000, v108
    v_lshlrev_b32 v134, 16, v109
    v_and_b32 v135, 0xffff0000, v109
    v_pk_add_f32 v[164:165], v[164:165], v[132:133]
    v_pk_add_f32 v[166:167], v[166:167], v[134:135]
    v_lshlrev_b32 v128, 16, v106
    v_and_b32 v129, 0xffff0000, v106
    v_lshlrev_b32 v130, 16, v107
    v_and_b32 v131, 0xffff0000, v107
    v_pk_add_f32 v[168:169], v[168:169], v[128:129]
    v_pk_add_f32 v[170:171], v[170:171], v[130:131]
    v_lshlrev_b32 v132, 16, v110
    v_and_b32 v133, 0xffff0000, v110
    v_lshlrev_b32 v134, 16, v111
    v_and_b32 v135, 0xffff0000, v111
    v_pk_add_f32 v[172:173], v[172:173], v[132:133]
    v_pk_add_f32 v[174:175], v[174:175], v[134:135]
    v_pk_mul_f32 v[112:113], v[144:145], s[36:37]
    v_pk_mul_f32 v[114:115], v[146:147], s[36:37]
    v_pk_mul_f32 v[116:117], v[148:149], s[36:37]
    v_pk_mul_f32 v[118:119], v[150:151], s[36:37]
    v_pk_mul_f32 v[120:121], v[152:153], s[36:37]
    v_pk_mul_f32 v[122:123], v[154:155], s[36:37]
    v_pk_mul_f32 v[124:125], v[156:157], s[36:37]
    v_pk_mul_f32 v[126:127], v[158:159], s[36:37]
    v_exp_f32 v112, v112
    v_exp_f32 v113, v113
    v_exp_f32 v114, v114
    v_exp_f32 v115, v115
    v_exp_f32 v116, v116
    v_exp_f32 v117, v117
    v_exp_f32 v118, v118
    v_exp_f32 v119, v119
    v_exp_f32 v120, v120
    v_exp_f32 v121, v121
    v_exp_f32 v122, v122
    v_exp_f32 v123, v123
    v_exp_f32 v124, v124
    v_exp_f32 v125, v125
    v_exp_f32 v126, v126
    v_exp_f32 v127, v127
    v_pk_add_f32 v[112:113], v[112:113], 1.0 op_sel_hi:[1,0]
    v_pk_add_f32 v[114:115], v[114:115], 1.0 op_sel_hi:[1,0]
    v_pk_add_f32 v[116:117], v[116:117], 1.0 op_sel_hi:[1,0]
    v_pk_add_f32 v[118:119], v[118:119], 1.0 op_sel_hi:[1,0]
    v_pk_add_f32 v[120:121], v[120:121], 1.0 op_sel_hi:[1,0]
    v_pk_add_f32 v[122:123], v[122:123], 1.0 op_sel_hi:[1,0]
    v_pk_add_f32 v[124:125], v[124:125], 1.0 op_sel_hi:[1,0]
    v_pk_add_f32 v[126:127], v[126:127], 1.0 op_sel_hi:[1,0]
    v_rcp_f32 v112, v112
    v_rcp_f32 v113, v113
    v_rcp_f32 v114, v114
    v_rcp_f32 v115, v115
    v_rcp_f32 v116, v116
    v_rcp_f32 v117, v117
    v_rcp_f32 v118, v118
    v_rcp_f32 v119, v119
    v_rcp_f32 v120, v120
    v_rcp_f32 v121, v121
    v_rcp_f32 v122, v122
    v_rcp_f32 v123, v123
    v_rcp_f32 v124, v124
    v_rcp_f32 v125, v125
    v_rcp_f32 v126, v126
    v_rcp_f32 v127, v127
    v_pk_mul_f32 v[144:145], v[144:145], v[112:113]
    v_pk_mul_f32 v[146:147], v[146:147], v[114:115]
    v_pk_mul_f32 v[148:149], v[148:149], v[116:117]
    v_pk_mul_f32 v[150:151], v[150:151], v[118:119]
    v_pk_mul_f32 v[152:153], v[152:153], v[120:121]
    v_pk_mul_f32 v[154:155], v[154:155], v[122:123]
    v_pk_mul_f32 v[156:157], v[156:157], v[124:125]
    v_pk_mul_f32 v[158:159], v[158:159], v[126:127]
    v_pk_mul_f32 v[112:113], v[160:161], s[36:37]
    v_pk_mul_f32 v[114:115], v[162:163], s[36:37]
    v_pk_mul_f32 v[116:117], v[164:165], s[36:37]
    v_pk_mul_f32 v[118:119], v[166:167], s[36:37]
    v_pk_mul_f32 v[120:121], v[168:169], s[36:37]
    v_pk_mul_f32 v[122:123], v[170:171], s[36:37]
    v_pk_mul_f32 v[124:125], v[172:173], s[36:37]
    v_pk_mul_f32 v[126:127], v[174:175], s[36:37]
    v_exp_f32 v112, v112
    v_exp_f32 v113, v113
    v_exp_f32 v114, v114
    v_exp_f32 v115, v115
    v_exp_f32 v116, v116
    v_exp_f32 v117, v117
    v_exp_f32 v118, v118
    v_exp_f32 v119, v119
    v_exp_f32 v120, v120
    v_exp_f32 v121, v121
    v_exp_f32 v122, v122
    v_exp_f32 v123, v123
    v_exp_f32 v124, v124
    v_exp_f32 v125, v125
    v_exp_f32 v126, v126
    v_exp_f32 v127, v127
    v_pk_add_f32 v[112:113], v[112:113], 1.0 op_sel_hi:[1,0]
    v_pk_add_f32 v[114:115], v[114:115], 1.0 op_sel_hi:[1,0]
    v_pk_add_f32 v[116:117], v[116:117], 1.0 op_sel_hi:[1,0]
    v_pk_add_f32 v[118:119], v[118:119], 1.0 op_sel_hi:[1,0]
    v_pk_add_f32 v[120:121], v[120:121], 1.0 op_sel_hi:[1,0]
    v_pk_add_f32 v[122:123], v[122:123], 1.0 op_sel_hi:[1,0]
    v_pk_add_f32 v[124:125], v[124:125], 1.0 op_sel_hi:[1,0]
    v_pk_add_f32 v[126:127], v[126:127], 1.0 op_sel_hi:[1,0]
    v_rcp_f32 v112, v112
    v_rcp_f32 v113, v113
    v_rcp_f32 v114, v114
    v_rcp_f32 v115, v115
    v_rcp_f32 v116, v116
    v_rcp_f32 v117, v117
    v_rcp_f32 v118, v118
    v_rcp_f32 v119, v119
    v_rcp_f32 v120, v120
    v_rcp_f32 v121, v121
    v_rcp_f32 v122, v122
    v_rcp_f32 v123, v123
    v_rcp_f32 v124, v124
    v_rcp_f32 v125, v125
    v_rcp_f32 v126, v126
    v_rcp_f32 v127, v127
    v_pk_mul_f32 v[160:161], v[160:161], v[112:113]
    v_pk_mul_f32 v[162:163], v[162:163], v[114:115]
    v_pk_mul_f32 v[164:165], v[164:165], v[116:117]
    v_pk_mul_f32 v[166:167], v[166:167], v[118:119]
    v_pk_mul_f32 v[168:169], v[168:169], v[120:121]
    v_pk_mul_f32 v[170:171], v[170:171], v[122:123]
    v_pk_mul_f32 v[172:173], v[172:173], v[124:125]
    v_pk_mul_f32 v[174:175], v[174:175], v[126:127]
    s_nop 7
    s_nop 3
    v_pk_mul_f32 v[16:17], v[16:17], v[144:145]
    v_pk_mul_f32 v[18:19], v[18:19], v[146:147]
    ds_write_b128 v12, v[16:19] offset:0
    v_pk_mul_f32 v[20:21], v[20:21], v[148:149]
    v_pk_mul_f32 v[22:23], v[22:23], v[150:151]
    ds_write_b128 v12, v[20:23] offset:32
    v_pk_mul_f32 v[24:25], v[24:25], v[152:153]
    v_pk_mul_f32 v[26:27], v[26:27], v[154:155]
    ds_write_b128 v12, v[24:27] offset:64
    v_pk_mul_f32 v[28:29], v[28:29], v[156:157]
    v_pk_mul_f32 v[30:31], v[30:31], v[158:159]
    ds_write_b128 v12, v[28:31] offset:96
    v_pk_mul_f32 v[32:33], v[32:33], v[160:161]
    v_pk_mul_f32 v[34:35], v[34:35], v[162:163]
    ds_write_b128 v12, v[32:35] offset:128
    v_pk_mul_f32 v[36:37], v[36:37], v[164:165]
    v_pk_mul_f32 v[38:39], v[38:39], v[166:167]
    ds_write_b128 v12, v[36:39] offset:160
    v_pk_mul_f32 v[40:41], v[40:41], v[168:169]
    v_pk_mul_f32 v[42:43], v[42:43], v[170:171]
    ds_write_b128 v12, v[40:43] offset:192
    v_pk_mul_f32 v[44:45], v[44:45], v[172:173]
    v_pk_mul_f32 v[46:47], v[46:47], v[174:175]
    ds_write_b128 v12, v[44:47] offset:224
    s_waitcnt lgkmcnt(0)
    ds_read_b128 v[80:83], v13 offset:0
    ds_read_b128 v[84:87], v13 offset:16
    ds_read_b128 v[88:91], v13 offset:2176
    ds_read_b128 v[92:95], v13 offset:2192
    ds_read_b128 v[96:99], v13 offset:4352
    ds_read_b128 v[100:103], v13 offset:4368
    ds_read_b128 v[104:107], v13 offset:6528
    ds_read_b128 v[108:111], v13 offset:6544
    s_waitcnt lgkmcnt(6)
    v_lshlrev_b32 v72, 16, v208
    v_and_b32 v73, 0xffff0000, v208
    v_pk_add_f32 v[80:81], v[80:81], v[72:73]
    v_lshlrev_b32 v74, 16, v209
    v_and_b32 v75, 0xffff0000, v209
    v_pk_add_f32 v[82:83], v[82:83], v[74:75]
    v_lshlrev_b32 v72, 16, v210
    v_and_b32 v73, 0xffff0000, v210
    v_pk_add_f32 v[84:85], v[84:85], v[72:73]
    v_lshlrev_b32 v74, 16, v211
    v_and_b32 v75, 0xffff0000, v211
    v_pk_add_f32 v[86:87], v[86:87], v[74:75]
    v_cvt_pk_bf16_f32 v208, v80, v81
    v_cvt_pk_bf16_f32 v209, v82, v83
    v_cvt_pk_bf16_f32 v210, v84, v85
    v_cvt_pk_bf16_f32 v211, v86, v87
    s_add_u32 s35, s87, 0
    buffer_store_dwordx4 v[208:211], v252, s[12:15], s35 offen
    s_waitcnt lgkmcnt(4)
    v_lshlrev_b32 v72, 16, v212
    v_and_b32 v73, 0xffff0000, v212
    v_pk_add_f32 v[88:89], v[88:89], v[72:73]
    v_lshlrev_b32 v74, 16, v213
    v_and_b32 v75, 0xffff0000, v213
    v_pk_add_f32 v[90:91], v[90:91], v[74:75]
    v_lshlrev_b32 v72, 16, v214
    v_and_b32 v73, 0xffff0000, v214
    v_pk_add_f32 v[92:93], v[92:93], v[72:73]
    v_lshlrev_b32 v74, 16, v215
    v_and_b32 v75, 0xffff0000, v215
    v_pk_add_f32 v[94:95], v[94:95], v[74:75]
    v_cvt_pk_bf16_f32 v212, v88, v89
    v_cvt_pk_bf16_f32 v213, v90, v91
    v_cvt_pk_bf16_f32 v214, v92, v93
    v_cvt_pk_bf16_f32 v215, v94, v95
    s_add_u32 s35, s87, 16384
    buffer_store_dwordx4 v[212:215], v252, s[12:15], s35 offen
    s_waitcnt lgkmcnt(2)
    v_lshlrev_b32 v72, 16, v216
    v_and_b32 v73, 0xffff0000, v216
    v_pk_add_f32 v[96:97], v[96:97], v[72:73]
    v_lshlrev_b32 v74, 16, v217
    v_and_b32 v75, 0xffff0000, v217
    v_pk_add_f32 v[98:99], v[98:99], v[74:75]
    v_lshlrev_b32 v72, 16, v218
    v_and_b32 v73, 0xffff0000, v218
    v_pk_add_f32 v[100:101], v[100:101], v[72:73]
    v_lshlrev_b32 v74, 16, v219
    v_and_b32 v75, 0xffff0000, v219
    v_pk_add_f32 v[102:103], v[102:103], v[74:75]
    v_cvt_pk_bf16_f32 v216, v96, v97
    v_cvt_pk_bf16_f32 v217, v98, v99
    v_cvt_pk_bf16_f32 v218, v100, v101
    v_cvt_pk_bf16_f32 v219, v102, v103
    s_add_u32 s35, s87, 32768
    buffer_store_dwordx4 v[216:219], v252, s[12:15], s35 offen
    s_waitcnt lgkmcnt(0)
    v_lshlrev_b32 v72, 16, v220
    v_and_b32 v73, 0xffff0000, v220
    v_pk_add_f32 v[104:105], v[104:105], v[72:73]
    v_lshlrev_b32 v74, 16, v221
    v_and_b32 v75, 0xffff0000, v221
    v_pk_add_f32 v[106:107], v[106:107], v[74:75]
    v_lshlrev_b32 v72, 16, v222
    v_and_b32 v73, 0xffff0000, v222
    v_pk_add_f32 v[108:109], v[108:109], v[72:73]
    v_lshlrev_b32 v74, 16, v223
    v_and_b32 v75, 0xffff0000, v223
    v_pk_add_f32 v[110:111], v[110:111], v[74:75]
    v_cvt_pk_bf16_f32 v220, v104, v105
    v_cvt_pk_bf16_f32 v221, v106, v107
    v_cvt_pk_bf16_f32 v222, v108, v109
    v_cvt_pk_bf16_f32 v223, v110, v111
    s_add_u32 s35, s87, 49152
    buffer_store_dwordx4 v[220:223], v252, s[12:15], s35 offen
L_mega_end:
    s_endpgm
.section .rodata,"a"
.p2align 6
.amdhsa_kernel mega_kernel
  .amdhsa_next_free_vgpr 512
  .amdhsa_next_free_sgpr 102
  .amdhsa_accum_offset 256
  .amdhsa_group_segment_fixed_size 0
  .amdhsa_kernarg_size 88
  .amdhsa_user_sgpr_count 2
  .amdhsa_user_sgpr_kernarg_segment_ptr 1
  .amdhsa_system_sgpr_workgroup_id_x 1
  .amdhsa_float_denorm_mode_32 3
.end_amdhsa_kernel
```
